```python
import torch

def _softmax(x, axis=-1):
    return torch.softmax(x, dim=axis)
def _gelu(x):
    return torch.nn.functional.gelu(x, approximate="tanh")
def _silu(x):
    return torch.nn.functional.silu(x)
def _sigmoid(x):
    return torch.sigmoid(x)
def _layernorm(x, axis=-1, eps=1e-5):
    m = x.mean(dim=axis, keepdim=True)
    v = x.var(dim=axis, keepdim=True, unbiased=False)
    return (x - m) / torch.sqrt(v + eps)
def _scatter_add(tgt, idx, src, axis=0):
    return tgt.clone().index_add_(axis, idx, src)
def _segment_sum(src, seg, n):
    out = torch.zeros((n,) + src.shape[1:], dtype=src.dtype)
    return out.index_add_(0, seg, src)
def _pad(x, pw):
    flat = tuple(v for pair in reversed(pw) for v in pair)
    return torch.nn.functional.pad(x, flat)

kernel_name = 'recurrent_scan__ssm_conv_s4d__glu_gated_glu__prompt'

def setup_inputs():

    _w = (lambda a: (lambda t: t.to(torch.bfloat16) if t.is_floating_point() else t)(torch.as_tensor(a)))
    def _A_setup():
        Bsz, L, D, N = 1, 2048, 640, 128
        return {
            "u": _w((lambda *s: torch.randn(*s, dtype=torch.bfloat16) * 0.05)(Bsz, L, D)),
            "log_A_real": _w((lambda *s: torch.randn(*s, dtype=torch.bfloat16) * 6.4)(D, N) * 0.5),
            "A_imag": _w((lambda *s: torch.randn(*s, dtype=torch.bfloat16) * 0.05)(D, N) * 3.14),
            "C_real": _w((lambda *s: torch.randn(*s, dtype=torch.bfloat16) * 0.05)(D, N) / N ** 0.5),
            "C_imag": _w((lambda *s: torch.randn(*s, dtype=torch.bfloat16) * 0.05)(D, N) / N ** 0.5),
            "log_dt": _w((lambda *s: torch.randn(*s, dtype=torch.bfloat16) * 0.05)(D) * 0.5 - 4.0),
            "D_skip": _w((lambda *s: torch.randn(*s, dtype=torch.bfloat16) * 0.05)(D)),
        }
    _A_in = _A_setup()

    def _B_setup():
        B, S, D, F = 1, 2048, 640, 1728
        return {
            "x": _w((lambda *s: torch.randn(*s, dtype=torch.bfloat16) * 0.05)(B, S, D)),
            "w_gate": _w((lambda *s: torch.randn(*s, dtype=torch.bfloat16) * 0.05)(D, F)),
            "w_up": _w((lambda *s: torch.randn(*s, dtype=torch.bfloat16) * 0.05)(D, F)),
            "w_down": _w((lambda *s: torch.randn(*s, dtype=torch.bfloat16) * 0.05)(F, D)),
        }
    _B_in = _B_setup()

    return {
        "A_u": _A_in["u"],
        "A_log_A_real": _A_in["log_A_real"],
        "A_A_imag": _A_in["A_imag"],
        "A_C_real": _A_in["C_real"],
        "A_C_imag": _A_in["C_imag"],
        "A_log_dt": _A_in["log_dt"],
        "A_D_skip": _A_in["D_skip"],
        "B_x": _B_in["x"],
        "B_w_gate": _B_in["w_gate"],
        "B_w_up": _B_in["w_up"],
        "B_w_down": _B_in["w_down"],
    }

def reference(A_u, A_log_A_real, A_A_imag, A_C_real, A_C_imag, A_log_dt, A_D_skip, B_x, B_w_gate, B_w_up, B_w_down):
    def _A_ref(u, log_A_real, A_imag, C_real, C_imag, log_dt, D_skip):
        L = u.shape[1]
        dt = torch.exp(log_dt)
        A = -torch.exp(log_A_real) + 1j * A_imag
        C = (C_real + 1j * C_imag) * dt[:, None]
        pos = (lambda x, dt: x.to(dt))(torch.arange(L), log_dt.dtype)
        P = torch.exp((A * dt[:, None])[:, :, None] * pos[None, None, :])
        K = 2.0 * torch.einsum("dn,dnl->dl", C, P).real
        L2 = 2 * L
        u_t = (lambda x, *d: x.permute(*d))(u, 0, 2, 1)
        Kf = (lambda x, *a, **k: torch.fft.rfft(x.float(), *a, **k))(K, L2)
        Uf = (lambda x, *a, **k: torch.fft.rfft(x.float(), *a, **k))(u_t, L2)
        y = (lambda x, *a, **k: torch.fft.irfft(x, *a, **k).to(torch.bfloat16))(Uf * Kf[None, :, :], L2)[:, :, :L]
        y = (lambda x, *d: x.permute(*d))(y, 0, 2, 1)
        return y + u * D_skip[None, None, :]

    def _B_ref(x, w_gate, w_up, w_down):
        g = torch.einsum("bsd,df->bsf", x, w_gate)
        u = torch.einsum("bsd,df->bsf", x, w_up)
        h = _sigmoid(g) * u
        return torch.einsum("bsf,fd->bsd", h, w_down)

    x = A_u
    xn = _layernorm(x, axis=-1)
    s = _A_ref(xn, A_log_A_real, A_A_imag, A_C_real, A_C_imag, A_log_dt, A_D_skip)
    g = _silu(_B_ref(xn, B_w_gate, B_w_up, B_w_down))
    return x + s * g
```

```asm
; @launch grid=(256,1,1) block=(256,1,1) lds=163840
.amdgcn_target "amdgcn-amd-amdhsa--gfx950"
.text
.p2align 8
.globl recurrent_scan__ssm_conv_s4d__glu_gated_glu__prompt_kernel
.type recurrent_scan__ssm_conv_s4d__glu_gated_glu__prompt_kernel,@function
recurrent_scan__ssm_conv_s4d__glu_gated_glu__prompt_kernel:
    s_cmp_ge_u32 s2, 256
    s_cbranch_scc1 k_end
    s_load_dwordx16 s[4:19], s[0:1], 0
    s_load_dwordx8 s[20:27], s[0:1], 64
    s_load_dwordx4 s[28:31], s[0:1], 96
    s_lshr_b32 s41, s2, 3
    s_getpc_b64 s[74:75]
pc_here:
    s_lshl_b32 s72, s41, 11
    v_lshrrev_b32 v7, 4, v0
    v_lshl_add_u32 v7, v7, 7, s72
    v_min_u32 v7, k_end-pc_here, v7
    global_load_dword v24, v7, s[74:75]
    s_and_b32 s72, s2, 7
    s_lshl_b32 s72, s72, 5
    s_add_u32 s45, s72, s41
    v_lshrrev_b32 v2, 5, v0
    v_and_b32 v5, 31, v0
    v_lshl_add_u32 v4, s45, 3, v2
    v_mul_u32_u24 v4, 1280, v4
    v_lshl_add_u32 v3, v5, 4, v4
    s_waitcnt lgkmcnt(0)
    global_load_dwordx4 v[128:131], v3, s[4:5]
    global_load_dwordx4 v[132:135], v3, s[4:5] offset:512
    v_lshrrev_b32 v6, 6, v0
    v_and_b32 v1, 63, v0
    v_readfirstlane_b32 s3, v6
    v_lshlrev_b32 v8, 4, v1
    s_and_b32 s40, s2, 7
    s_load_dword s47, s[30:31], 0
    s_lshr_b32 s44, s41, 2
    s_lshl_b32 s44, s44, 3
    s_add_u32 s44, s44, s40
    s_lshl_b32 s44, s44, 2
    s_and_b32 s77, s41, 3
    s_add_u32 s44, s44, s77
    s_lshr_b32 s72, s40, 1
    s_mul_i32 s72, s72, 28
    s_add_u32 s72, s72, s41
    s_lshr_b32 s43, s72, 2
    s_cmp_ge_u32 s41, 28
    s_cselect_b32 s43, 27, s43
    s_and_b32 s79, s72, 3
    s_lshl_b32 s72, s40, 2
    s_and_b32 s72, s72, 7
    s_add_u32 s72, s72, s79
    s_lshl2_add_u32 s42, s72, s3
    s_lshr_b32 s72, s41, 3
    s_lshl2_add_u32 s50, s40, s72
    s_and_b32 s51, s41, 7
    s_mov_b32 s32, s30
    s_mov_b32 s33, s31
    s_mov_b32 s34, 14876672
    s_mov_b32 s35, 0x20000
    s_mov_b32 s38, 2211840
    s_mov_b32 s39, 0x20000
    s_mul_i32 s83, s3, 16384
    s_bitcmp1_b32 s3, 0
    s_cselect_b32 s36, s22, s20
    s_cselect_b32 s37, s23, s21
    s_lshl_b32 s82, s43, 7
    s_lshr_b32 s73, s3, 1
    v_lshrrev_b32 v6, 3, v1
    v_bfe_u32 v7, v1, 4, 1
    v_bfe_u32 v15, v0, 7, 1
    v_lshl_add_u32 v7, v15, 1, v7
    v_lshlrev_b32 v7, 5, v7
    v_and_b32 v15, 0x70, v8
    v_xor_b32 v7, v7, v15
    v_mul_u32_u24 v6, 3456, v6
    v_add_u32 v15, v6, v7
    s_mul_i32 s73, s73, 27648
    s_add_u32 s82, s82, s73
    s_lshl_b32 s79, s3, 10
    s_cmp_ge_u32 s43, 27
    s_cselect_b32 s82, 134217728, s82
    s_cselect_b32 s79, 98304, s79
    s_and_b32 s0, s41, 3
    s_cmp_lt_u32 s0, 1
    s_cselect_b32 s1, 1, 0
    s_cmp_lt_u32 s0, 2
    s_cselect_b32 s28, 2, 1
    s_cmp_lt_u32 s0, 3
    s_cselect_b32 s29, 3, 2
    v_lshl_add_u32 v3, v5, 3, v4
    global_load_dwordx2 v[136:137], v3, s[4:5] offset:1024
    global_load_ushort v172, v4, s[4:5]
    s_lshl_b32 s76, s44, 9
    s_lshl_b32 s75, s44, 2
    v_lshl_add_u32 v28, v0, 1, s76
    global_load_ushort v52, v28, s[6:7]
    global_load_ushort v53, v28, s[8:9]
    global_load_ushort v54, v28, s[10:11]
    global_load_ushort v55, v28, s[12:13]
    s_load_dword s48, s[14:15], s75
    s_load_dword s49, s[16:17], s75
    v_lshrrev_b32 v6, 3, v5
    v_mul_u32_u24 v6, 16384, v6
    v_and_b32 v7, 7, v1
    v_mul_u32_u24 v3, 144, v7
    v_add_u32 v6, v6, v3
    v_lshl_add_u32 v174, v2, 4, v6
    v_lshrrev_b32 v6, 4, v5
    v_mul_u32_u24 v6, 16384, v6
    v_bfe_u32 v3, v5, 1, 3
    v_mul_u32_u24 v3, 144, v3
    v_add_u32 v6, v6, v3
    v_and_b32 v3, 1, v5
    v_lshl_add_u32 v6, v3, 3, v6
    v_lshl_add_u32 v177, v2, 4, v6
    s_mov_b32 s62, 0x3f80
    s_mov_b32 s63, 0x3f800000
    v_lshrrev_b32 v6, 3, v1
    v_mul_u32_u24 v3, 144, v6
    v_lshl_add_u32 v3, v7, 4, v3
    v_add_u32 v175, s83, v3
    v_lshrrev_b32 v6, 3, v0
    v_lshlrev_b32 v6, 9, v6
    v_lshl_add_u32 v176, v7, 4, v6
    s_lshr_b32 s72, s45, 2
    s_mul_i32 s72, s72, 40960
    s_and_b32 s73, s45, 3
    s_lshl_b32 s73, s73, 7
    s_add_u32 s72, s72, s73
    s_add_u32 s70, s72, 65536
    s_add_u32 s71, s70, 16384
    s_add_u32 s72, s70, 32768
    s_cmp_ge_u32 s3, 2
    s_cselect_b32 s69, 134217728, s72
    s_lshr_b32 s77, s43, 2
    s_lshl_b32 s46, s42, 6
    s_add_u32 s46, s46, s77
    s_and_b32 s77, s43, 3
    s_lshl_b32 s77, s77, 3
    s_sub_u32 s61, s46, s77
    s_add_u32 s46, s46, s77
    s_lshl_b32 s46, s46, 6
    s_add_u32 s46, s46, 14614528
    s_add_u32 s61, s61, 56
    s_lshl_b32 s61, s61, 6
    s_add_u32 s61, s61, 14614528
    s_mov_b32 s18, 134217728
    s_mul_i32 s58, s42, 81920
    s_add_u32 s58, s58, 65536
    s_mul_i32 s59, s42, 221184
    s_lshl_b32 s72, s43, 13
    s_add_u32 s59, s59, s72
    s_add_u32 s59, s59, 7520256
    s_add_u32 s60, s59, 4096
    v_lshrrev_b32 v2, 4, v1
    v_lshl_add_u32 v14, v2, 8, v8
    v_add_u32 v9, 40960, v14
    v_lshlrev_b32 v2, 11, v2
    v_bfe_u32 v3, v1, 2, 2
    v_lshl_add_u32 v2, v3, 7, v2
    v_and_b32 v3, 3, v1
    s_add_u32 s66, s82, 0
    s_mov_b32 s67, s79
    s_add_u32 m0, s67, 65536
    s_nop 0
    buffer_load_dwordx4 v15, s[36:39], s66 offen lds
    s_mov_b32 m0, s83
    v_lshl_add_u32 v2, v3, 3, v2
    v_bfe_u32 v3, v1, 3, 2
    v_lshlrev_b32 v3, 5, v3
    s_mov_b32 s72, 65536
    v_xor_b32 v4, 0, v3
    v_add3_u32 v10, v2, v4, s72
    v_xor_b32 v4, 32, v3
    v_add3_u32 v11, v2, v4, s72
    v_xor_b32 v4, 64, v3
    v_add3_u32 v12, v2, v4, s72
    s_add_u32 m0, s67, 69632
    s_add_u32 s66, s66, 55296
    buffer_load_dwordx4 v15, s[36:39], s66 offen lds
    s_mov_b32 m0, s83
    v_xor_b32 v4, 96, v3
    v_add3_u32 v13, v2, v4, s72
    s_add_u32 m0, s67, 73728
    s_add_u32 s66, s66, 55296
    buffer_load_dwordx4 v15, s[36:39], s66 offen lds
    s_mov_b32 m0, s83
    s_add_u32 m0, s67, 77824
    s_add_u32 s66, s66, 55296
    buffer_load_dwordx4 v15, s[36:39], s66 offen lds
    s_mov_b32 m0, s83
    s_mul_i32 s66, s0, 276480
    s_add_u32 s66, s66, s82
    s_add_u32 s66, s66, 221184
    s_mul_i32 s67, s0, 20480
    s_add_u32 s67, s67, s79
    s_add_u32 m0, s67, 81920
    s_nop 0
    buffer_load_dwordx4 v15, s[36:39], s66 offen lds
    s_mov_b32 m0, s83
    s_add_u32 m0, s67, 86016
    s_add_u32 s66, s66, 55296
    buffer_load_dwordx4 v15, s[36:39], s66 offen lds
    s_mov_b32 m0, s83
    s_add_u32 m0, s67, 90112
    s_add_u32 s66, s66, 55296
    buffer_load_dwordx4 v15, s[36:39], s66 offen lds
    s_mov_b32 m0, s83
    s_lshl_b32 s73, s50, 2
    s_add_u32 s73, s73, s3
    s_mul_i32 s73, s73, 20480
    s_mul_i32 s74, s51, 160
    s_add_u32 s73, s73, s74
    s_lshl_b32 s74, s3, 12
    s_add_u32 s74, s74, 94208
    v_add_u32 v2, 0, v1
    v_min_u32 v2, 159, v2
    v_mul_u32_u24 v5, 6554, v2
    v_lshrrev_b32 v5, 16, v5
    v_add_lshl_u32 v2, v2, v5, 4
    v_mul_u32_u24 v30, 1104, v5
    v_add_u32 v5, s74, v2
    v_add3_u32 v2, v2, v30, s73
    v_add_u32 v3, 64, v1
    v_min_u32 v3, 159, v3
    v_mul_u32_u24 v6, 6554, v3
    v_lshrrev_b32 v6, 16, v6
    v_add_lshl_u32 v3, v3, v6, 4
    v_mul_u32_u24 v30, 1104, v6
    v_add_u32 v6, s74, v3
    v_add3_u32 v3, v3, v30, s73
    v_add_u32 v4, 128, v1
    v_min_u32 v4, 159, v4
    v_mul_u32_u24 v7, 6554, v4
    v_lshrrev_b32 v7, 16, v7
    v_add_lshl_u32 v4, v4, v7, 4
    v_mul_u32_u24 v30, 1104, v7
    v_add_u32 v7, s74, v4
    v_add3_u32 v4, v4, v30, s73
    s_waitcnt vmcnt(11)
    v_lshlrev_b32 v172, 16, v172
    s_add_u32 m0, s67, 94208
    s_add_u32 s66, s66, 55296
    buffer_load_dwordx4 v15, s[36:39], s66 offen lds
    s_mov_b32 m0, s83
    v_lshlrev_b32 v140, 16, v128
    v_and_b32 v141, 0xffff0000, v128
    v_pk_add_f32 v[140:141], v[140:141], v[172:173] op_sel_hi:[1,0] neg_lo:[0,1] neg_hi:[0,1]
    v_lshlrev_b32 v142, 16, v129
    v_and_b32 v143, 0xffff0000, v129
    v_pk_add_f32 v[142:143], v[142:143], v[172:173] op_sel_hi:[1,0] neg_lo:[0,1] neg_hi:[0,1]
    v_lshlrev_b32 v144, 16, v130
    v_and_b32 v145, 0xffff0000, v130
    v_pk_add_f32 v[144:145], v[144:145], v[172:173] op_sel_hi:[1,0] neg_lo:[0,1] neg_hi:[0,1]
    v_pk_mul_f32 v[166:167], v[140:141], v[140:141]
    v_lshlrev_b32 v146, 16, v131
    v_and_b32 v147, 0xffff0000, v131
    v_pk_add_f32 v[146:147], v[146:147], v[172:173] op_sel_hi:[1,0] neg_lo:[0,1] neg_hi:[0,1]
    v_pk_add_f32 v[164:165], v[140:141], v[142:143]
    v_pk_fma_f32 v[166:167], v[142:143], v[142:143], v[166:167]
    v_lshlrev_b32 v148, 16, v132
    v_and_b32 v149, 0xffff0000, v132
    v_pk_add_f32 v[148:149], v[148:149], v[172:173] op_sel_hi:[1,0] neg_lo:[0,1] neg_hi:[0,1]
    v_pk_add_f32 v[164:165], v[164:165], v[144:145]
    v_pk_fma_f32 v[166:167], v[144:145], v[144:145], v[166:167]
    v_lshlrev_b32 v150, 16, v133
    v_and_b32 v151, 0xffff0000, v133
    v_pk_add_f32 v[150:151], v[150:151], v[172:173] op_sel_hi:[1,0] neg_lo:[0,1] neg_hi:[0,1]
    v_pk_add_f32 v[164:165], v[164:165], v[146:147]
    v_pk_fma_f32 v[166:167], v[146:147], v[146:147], v[166:167]
    v_lshlrev_b32 v152, 16, v134
    v_and_b32 v153, 0xffff0000, v134
    v_pk_add_f32 v[152:153], v[152:153], v[172:173] op_sel_hi:[1,0] neg_lo:[0,1] neg_hi:[0,1]
    v_pk_add_f32 v[164:165], v[164:165], v[148:149]
    v_pk_fma_f32 v[166:167], v[148:149], v[148:149], v[166:167]
    v_lshlrev_b32 v154, 16, v135
    v_and_b32 v155, 0xffff0000, v135
    v_pk_add_f32 v[154:155], v[154:155], v[172:173] op_sel_hi:[1,0] neg_lo:[0,1] neg_hi:[0,1]
    v_pk_add_f32 v[164:165], v[164:165], v[150:151]
    v_pk_fma_f32 v[166:167], v[150:151], v[150:151], v[166:167]
    v_lshlrev_b32 v156, 16, v136
    v_and_b32 v157, 0xffff0000, v136
    v_pk_add_f32 v[156:157], v[156:157], v[172:173] op_sel_hi:[1,0] neg_lo:[0,1] neg_hi:[0,1]
    v_pk_add_f32 v[164:165], v[164:165], v[152:153]
    v_pk_fma_f32 v[166:167], v[152:153], v[152:153], v[166:167]
    v_lshlrev_b32 v158, 16, v137
    v_and_b32 v159, 0xffff0000, v137
    v_pk_add_f32 v[158:159], v[158:159], v[172:173] op_sel_hi:[1,0] neg_lo:[0,1] neg_hi:[0,1]
    v_pk_add_f32 v[164:165], v[164:165], v[154:155]
    v_pk_fma_f32 v[166:167], v[154:155], v[154:155], v[166:167]
    v_pk_add_f32 v[164:165], v[164:165], v[156:157]
    v_pk_fma_f32 v[166:167], v[156:157], v[156:157], v[166:167]
    v_pk_add_f32 v[164:165], v[164:165], v[158:159]
    v_pk_fma_f32 v[166:167], v[158:159], v[158:159], v[166:167]
    v_add_f32 v164, v164, v165
    v_add_f32 v166, v166, v167
    s_waitcnt lgkmcnt(0)
    s_mul_i32 s47, s47, 1664525
    s_add_u32 s47, s47, 1013904223
    v_permlane16_swap_b32 v164, v166
    v_add_f32 v164, v164, v166
    v_mov_b32 v25, s47
    s_nop 0
    v_add_f32_dpp v164, v164, v164 row_ror:8 row_mask:0xf bank_mask:0xf
    s_nop 1
    v_add_f32_dpp v164, v164, v164 row_ror:4 row_mask:0xf bank_mask:0xf
    s_nop 1
    v_add_f32_dpp v164, v164, v164 row_ror:2 row_mask:0xf bank_mask:0xf
    s_nop 1
    v_add_f32_dpp v164, v164, v164 row_ror:1 row_mask:0xf bank_mask:0xf
    v_mul_f32 v168, 0x3acccccd, v164
    v_mul_f32 v164, 0x3acccccd, v164
    s_nop 1
    v_permlane16_swap_b32 v164, v168
    v_fma_f32 v168, -v164, v164, v168
    v_add_f32 v164, v164, v172
    v_max_f32 v168, 0, v168
    v_cvt_pk_bf16_f32 v168, v168, v168
    v_lshlrev_b32 v168, 16, v168
    v_add_f32 v168, 0x3727c5ac, v168
    v_cvt_pk_bf16_f32 v168, v168, v168
    v_lshlrev_b32 v168, 16, v168
    v_sqrt_f32 v168, v168
    v_cvt_pk_bf16_f32 v164, v164, v164
    v_lshlrev_b32 v164, 16, v164
    v_cvt_pk_bf16_f32 v168, v168, v168
    v_lshlrev_b32 v168, 16, v168
    v_rcp_f32 v166, v168
    v_sub_f32 v164, v164, v172
    v_mul_f32 v167, v164, v166
    v_pk_fma_f32 v[140:141], v[140:141], v[166:167], v[166:167] op_sel:[0,0,1] op_sel_hi:[1,0,1] neg_lo:[0,0,1] neg_hi:[0,0,1]
    v_pk_fma_f32 v[142:143], v[142:143], v[166:167], v[166:167] op_sel:[0,0,1] op_sel_hi:[1,0,1] neg_lo:[0,0,1] neg_hi:[0,0,1]
    v_pk_fma_f32 v[144:145], v[144:145], v[166:167], v[166:167] op_sel:[0,0,1] op_sel_hi:[1,0,1] neg_lo:[0,0,1] neg_hi:[0,0,1]
    v_pk_fma_f32 v[146:147], v[146:147], v[166:167], v[166:167] op_sel:[0,0,1] op_sel_hi:[1,0,1] neg_lo:[0,0,1] neg_hi:[0,0,1]
    v_cvt_pk_bf16_f32 v140, v140, v141
    v_cvt_pk_bf16_f32 v141, v142, v143
    v_cvt_pk_bf16_f32 v142, v144, v145
    v_cvt_pk_bf16_f32 v143, v146, v147
    ds_write_b128 v174, v[140:143] offset:0
    v_pk_fma_f32 v[148:149], v[148:149], v[166:167], v[166:167] op_sel:[0,0,1] op_sel_hi:[1,0,1] neg_lo:[0,0,1] neg_hi:[0,0,1]
    v_pk_fma_f32 v[150:151], v[150:151], v[166:167], v[166:167] op_sel:[0,0,1] op_sel_hi:[1,0,1] neg_lo:[0,0,1] neg_hi:[0,0,1]
    v_pk_fma_f32 v[152:153], v[152:153], v[166:167], v[166:167] op_sel:[0,0,1] op_sel_hi:[1,0,1] neg_lo:[0,0,1] neg_hi:[0,0,1]
    v_pk_fma_f32 v[154:155], v[154:155], v[166:167], v[166:167] op_sel:[0,0,1] op_sel_hi:[1,0,1] neg_lo:[0,0,1] neg_hi:[0,0,1]
    v_cvt_pk_bf16_f32 v148, v148, v149
    v_cvt_pk_bf16_f32 v149, v150, v151
    v_cvt_pk_bf16_f32 v150, v152, v153
    v_cvt_pk_bf16_f32 v151, v154, v155
    ds_write_b128 v174, v[148:151] offset:1152
    v_pk_fma_f32 v[156:157], v[156:157], v[166:167], v[166:167] op_sel:[0,0,1] op_sel_hi:[1,0,1] neg_lo:[0,0,1] neg_hi:[0,0,1]
    v_pk_fma_f32 v[158:159], v[158:159], v[166:167], v[166:167] op_sel:[0,0,1] op_sel_hi:[1,0,1] neg_lo:[0,0,1] neg_hi:[0,0,1]
    v_cvt_pk_bf16_f32 v156, v156, v157
    v_cvt_pk_bf16_f32 v157, v158, v159
    ds_write_b64 v177, v[156:157] offset:2304
    s_waitcnt lgkmcnt(0)
    s_barrier
    ds_read_b128 v[128:131], v175 offset:0
    ds_read_b128 v[132:135], v175 offset:1152
    ds_read_b128 v[136:139], v175 offset:2304
    s_waitcnt lgkmcnt(2)
    buffer_store_dwordx4 v[128:131], v176, s[32:35], s70 offen sc1
    s_waitcnt lgkmcnt(1)
    buffer_store_dwordx4 v[132:135], v176, s[32:35], s71 offen sc1
    s_waitcnt lgkmcnt(0)
    buffer_store_dwordx4 v[136:139], v176, s[32:35], s69 offen sc1
    s_cmp_ge_u32 s43, 27
    s_cbranch_scc1 role_spare
    s_bitcmp1_b32 s3, 1
    s_cselect_b32 s76, 0, 16
    s_lshl_b32 s77, s48, s76
    s_and_b32 s77, s77, 0xffff0000
    s_mov_b32 m0, s83
    v_mov_b32 v6, 0x3fb8aa3b
    v_mul_f32 v7, s77, v6
    s_waitcnt vmcnt(14)
    v_lshlrev_b32 v52, 16, v52
    v_exp_f32 v7, v7
    v_mul_f32 v52, v52, v6
    s_waitcnt vmcnt(13)
    v_lshlrev_b32 v53, 16, v53
    v_exp_f32 v52, v52
    v_cvt_pk_bf16_f32 v7, v7, v7
    s_waitcnt vmcnt(12)
    v_lshlrev_b32 v54, 16, v54
    v_lshlrev_b32 v7, 16, v7
    v_cvt_pk_bf16_f32 v52, v52, v52
    s_waitcnt vmcnt(11)
    v_lshlrev_b32 v55, 16, v55
    v_lshlrev_b32 v52, 16, v52
    v_mul_f32 v53, v53, v7
    v_mul_f32 v52, v52, v7
    v_add_f32 v7, v7, v7
    v_mul_f32 v53, 0.15915494, v53
    v_mul_f32 v52, 0xbfb8aa3b, v52
    v_mul_f32 v192, v54, v7
    v_mul_f32 v193, v55, v7
    v_mul_f32 v186, 0x41000000, v52
    v_mul_f32 v187, 0x41000000, v53
    v_mul_f32 v188, 0x42800000, v52
    v_mul_f32 v189, 0x42800000, v53
    v_mul_f32 v190, 0x43800000, v52
    v_mul_f32 v191, 0x43800000, v53
    v_fract_f32 v185, v53
    v_fract_f32 v187, v187
    v_fract_f32 v189, v189
    v_fract_f32 v191, v191
    v_exp_f32 v184, v52
    v_cos_f32 v176, v185
    v_sin_f32 v177, v185
    v_exp_f32 v186, v186
    v_cos_f32 v178, v187
    v_sin_f32 v179, v187
    v_exp_f32 v188, v188
    v_cos_f32 v180, v189
    v_sin_f32 v181, v189
    v_exp_f32 v190, v190
    v_cos_f32 v182, v191
    v_sin_f32 v183, v191
    v_mov_b32 v212, 1.0
    v_mov_b32 v213, 0
    v_pk_mul_f32 v[176:177], v[176:177], v[184:185] op_sel_hi:[1,0]
    v_pk_mul_f32 v[178:179], v[178:179], v[186:187] op_sel_hi:[1,0]
    v_pk_mul_f32 v[180:181], v[180:181], v[188:189] op_sel_hi:[1,0]
    v_pk_mul_f32 v[182:183], v[182:183], v[190:191] op_sel_hi:[1,0]
    v_cvt_pk_bf16_f32 v236, v192, -v193
    v_cvt_pk_bf16_f32 v240, v212, v213
    v_pk_mul_f32 v[228:229], v[192:193], v[176:177] op_sel_hi:[0,1]
    v_cvt_pk_bf16_f32 v241, v178, v179
    ds_write_addtid_b32 v236 offset:0
    ds_write_addtid_b32 v240 offset:7616
    v_pk_fma_f32 v[194:195], v[192:193], v[176:177], v[228:229] op_sel:[1,1,0] op_sel_hi:[1,0,1] neg_lo:[1,0,0]
    v_pk_mul_f32 v[232:233], v[178:179], v[178:179] op_sel_hi:[0,1]
    v_cvt_pk_bf16_f32 v237, v194, -v195
    global_load_dwordx4 v[100:103], v2, s[4:5]
    v_pk_fma_f32 v[216:217], v[178:179], v[178:179], v[232:233] op_sel:[1,1,0] op_sel_hi:[1,0,1] neg_lo:[1,0,0]
    v_pk_mul_f32 v[230:231], v[194:195], v[176:177] op_sel_hi:[0,1]
    v_cvt_pk_bf16_f32 v242, v216, v217
    ds_write_addtid_b32 v241 offset:7888
    ds_write_addtid_b32 v237 offset:272
    v_pk_fma_f32 v[196:197], v[194:195], v[176:177], v[230:231] op_sel:[1,1,0] op_sel_hi:[1,0,1] neg_lo:[1,0,0]
    v_pk_mul_f32 v[234:235], v[216:217], v[178:179] op_sel_hi:[0,1]
    v_cvt_pk_bf16_f32 v238, v196, -v197
    v_pk_fma_f32 v[218:219], v[216:217], v[178:179], v[234:235] op_sel:[1,1,0] op_sel_hi:[1,0,1] neg_lo:[1,0,0]
    v_pk_mul_f32 v[228:229], v[196:197], v[176:177] op_sel_hi:[0,1]
    v_cvt_pk_bf16_f32 v243, v218, v219
    ds_write_addtid_b32 v242 offset:8160
    ds_write_addtid_b32 v238 offset:544
    v_pk_fma_f32 v[198:199], v[196:197], v[176:177], v[228:229] op_sel:[1,1,0] op_sel_hi:[1,0,1] neg_lo:[1,0,0]
    v_pk_mul_f32 v[232:233], v[218:219], v[178:179] op_sel_hi:[0,1]
    v_cvt_pk_bf16_f32 v239, v198, -v199
    v_pk_fma_f32 v[220:221], v[218:219], v[178:179], v[232:233] op_sel:[1,1,0] op_sel_hi:[1,0,1] neg_lo:[1,0,0]
    v_pk_mul_f32 v[230:231], v[198:199], v[176:177] op_sel_hi:[0,1]
    v_cvt_pk_bf16_f32 v240, v220, v221
    ds_write_addtid_b32 v243 offset:8432
    ds_write_addtid_b32 v239 offset:816
    v_pk_fma_f32 v[200:201], v[198:199], v[176:177], v[230:231] op_sel:[1,1,0] op_sel_hi:[1,0,1] neg_lo:[1,0,0]
    v_pk_mul_f32 v[234:235], v[220:221], v[178:179] op_sel_hi:[0,1]
    global_load_dwordx4 v[104:107], v3, s[4:5]
    v_cvt_pk_bf16_f32 v236, v200, -v201
    v_pk_fma_f32 v[222:223], v[220:221], v[178:179], v[234:235] op_sel:[1,1,0] op_sel_hi:[1,0,1] neg_lo:[1,0,0]
    v_pk_mul_f32 v[228:229], v[200:201], v[176:177] op_sel_hi:[0,1]
    v_cvt_pk_bf16_f32 v241, v222, v223
    ds_write_addtid_b32 v240 offset:8704
    ds_write_addtid_b32 v236 offset:2176
    v_pk_fma_f32 v[202:203], v[200:201], v[176:177], v[228:229] op_sel:[1,1,0] op_sel_hi:[1,0,1] neg_lo:[1,0,0]
    v_pk_mul_f32 v[232:233], v[222:223], v[178:179] op_sel_hi:[0,1]
    v_cvt_pk_bf16_f32 v237, v202, -v203
    v_pk_fma_f32 v[224:225], v[222:223], v[178:179], v[232:233] op_sel:[1,1,0] op_sel_hi:[1,0,1] neg_lo:[1,0,0]
    v_pk_mul_f32 v[230:231], v[202:203], v[176:177] op_sel_hi:[0,1]
    v_cvt_pk_bf16_f32 v242, v224, v225
    ds_write_addtid_b32 v241 offset:8976
    ds_write_addtid_b32 v237 offset:2448
    v_pk_fma_f32 v[204:205], v[202:203], v[176:177], v[230:231] op_sel:[1,1,0] op_sel_hi:[1,0,1] neg_lo:[1,0,0]
    v_pk_mul_f32 v[234:235], v[224:225], v[178:179] op_sel_hi:[0,1]
    v_cvt_pk_bf16_f32 v238, v204, -v205
    v_pk_fma_f32 v[226:227], v[224:225], v[178:179], v[234:235] op_sel:[1,1,0] op_sel_hi:[1,0,1] neg_lo:[1,0,0]
    v_pk_mul_f32 v[228:229], v[204:205], v[176:177] op_sel_hi:[0,1]
    v_cvt_pk_bf16_f32 v243, v226, v227
    ds_write_addtid_b32 v242 offset:9248
    ds_write_addtid_b32 v238 offset:2720
    v_pk_fma_f32 v[206:207], v[204:205], v[176:177], v[228:229] op_sel:[1,1,0] op_sel_hi:[1,0,1] neg_lo:[1,0,0]
    global_load_dwordx4 v[108:111], v4, s[4:5]
    v_cvt_pk_bf16_f32 v240, v180, v181
    v_cvt_pk_bf16_f32 v239, v206, -v207
    v_pk_mul_f32 v[234:235], v[178:179], v[180:181] op_sel_hi:[0,1]
    ds_write_addtid_b32 v243 offset:9520
    ds_write_addtid_b32 v240 offset:9792
    v_pk_mul_f32 v[230:231], v[206:207], v[176:177] op_sel_hi:[0,1]
    v_pk_fma_f32 v[214:215], v[178:179], v[180:181], v[234:235] op_sel:[1,1,0] op_sel_hi:[1,0,1] neg_lo:[1,0,0]
    v_pk_fma_f32 v[208:209], v[206:207], v[176:177], v[230:231] op_sel:[1,1,0] op_sel_hi:[1,0,1] neg_lo:[1,0,0]
    v_cvt_pk_bf16_f32 v241, v214, v215
    v_cvt_pk_bf16_f32 v236, v208, -v209
    v_pk_mul_f32 v[232:233], v[216:217], v[180:181] op_sel_hi:[0,1]
    ds_write_addtid_b32 v239 offset:2992
    ds_write_addtid_b32 v241 offset:10064
    v_pk_mul_f32 v[228:229], v[192:193], v[182:183] op_sel_hi:[0,1]
    v_pk_fma_f32 v[216:217], v[216:217], v[180:181], v[232:233] op_sel:[1,1,0] op_sel_hi:[1,0,1] neg_lo:[1,0,0]
    v_pk_fma_f32 v[192:193], v[192:193], v[182:183], v[228:229] op_sel:[1,1,0] op_sel_hi:[1,0,1] neg_lo:[1,0,0]
    v_cvt_pk_bf16_f32 v242, v216, v217
    v_cvt_pk_bf16_f32 v237, v192, -v193
    v_pk_mul_f32 v[234:235], v[218:219], v[180:181] op_sel_hi:[0,1]
    ds_write_addtid_b32 v236 offset:4352
    ds_write_addtid_b32 v242 offset:10336
    v_pk_mul_f32 v[230:231], v[196:197], v[182:183] op_sel_hi:[0,1]
    v_pk_fma_f32 v[218:219], v[218:219], v[180:181], v[234:235] op_sel:[1,1,0] op_sel_hi:[1,0,1] neg_lo:[1,0,0]
    s_add_u32 m0, s67, 98304
    s_add_u32 s66, s66, 55296
    buffer_load_dwordx4 v15, s[36:39], s66 offen lds
    s_mov_b32 m0, s83
    s_nop 0
    ds_write_addtid_b32 v237 offset:1088
    ds_write_addtid_b32 v237 offset:1360
    v_pk_fma_f32 v[196:197], v[196:197], v[182:183], v[230:231] op_sel:[1,1,0] op_sel_hi:[1,0,1] neg_lo:[1,0,0]
    v_cvt_pk_bf16_f32 v243, v218, v219
    v_cvt_pk_bf16_f32 v238, v196, -v197
    v_pk_mul_f32 v[232:233], v[220:221], v[180:181] op_sel_hi:[0,1]
    v_pk_mul_f32 v[228:229], v[200:201], v[182:183] op_sel_hi:[0,1]
    v_pk_fma_f32 v[220:221], v[220:221], v[180:181], v[232:233] op_sel:[1,1,0] op_sel_hi:[1,0,1] neg_lo:[1,0,0]
    ds_write_addtid_b32 v243 offset:10608
    ds_write_addtid_b32 v238 offset:1632
    v_pk_fma_f32 v[200:201], v[200:201], v[182:183], v[228:229] op_sel:[1,1,0] op_sel_hi:[1,0,1] neg_lo:[1,0,0]
    v_cvt_pk_bf16_f32 v240, v220, v221
    v_cvt_pk_bf16_f32 v239, v200, -v201
    v_pk_mul_f32 v[234:235], v[222:223], v[180:181] op_sel_hi:[0,1]
    v_pk_mul_f32 v[230:231], v[204:205], v[182:183] op_sel_hi:[0,1]
    s_mul_i32 s64, s0, 221184
    s_add_u32 s64, s64, s82
    s_add_u32 s64, s64, 1327104
    buffer_load_dwordx4 a[192:195], v15, s[36:39], s64 offen
    v_pk_fma_f32 v[222:223], v[222:223], v[180:181], v[234:235] op_sel:[1,1,0] op_sel_hi:[1,0,1] neg_lo:[1,0,0]
    ds_write_addtid_b32 v240 offset:10880
    ds_write_addtid_b32 v239 offset:1904
    ds_write_addtid_b32 v239 offset:3264
    ds_write_addtid_b32 v239 offset:3536
    v_pk_fma_f32 v[204:205], v[204:205], v[182:183], v[230:231] op_sel:[1,1,0] op_sel_hi:[1,0,1] neg_lo:[1,0,0]
    v_cvt_pk_bf16_f32 v241, v222, v223
    v_cvt_pk_bf16_f32 v236, v204, -v205
    v_pk_mul_f32 v[232:233], v[224:225], v[180:181] op_sel_hi:[0,1]
    v_pk_mul_f32 v[228:229], v[208:209], v[182:183] op_sel_hi:[0,1]
    v_pk_fma_f32 v[224:225], v[224:225], v[180:181], v[232:233] op_sel:[1,1,0] op_sel_hi:[1,0,1] neg_lo:[1,0,0]
    ds_write_addtid_b32 v241 offset:11152
    s_lshl_b32 s68, s45, 5
    s_add_u32 s68, s68, 4096
    s_cmp_lg_u32 s3, 0
    s_cselect_b32 s68, 134217728, s68
    s_waitcnt vmcnt(5)
    s_barrier
    s_mov_b64 exec, 1
    buffer_store_dword v25, off, s[32:35], s68 sc1
    s_mov_b64 exec, -1
    ds_write_addtid_b32 v236 offset:7072
    v_pk_fma_f32 v[208:209], v[208:209], v[182:183], v[228:229] op_sel:[1,1,0] op_sel_hi:[1,0,1] neg_lo:[1,0,0]
    v_cvt_pk_bf16_f32 v242, v224, v225
    v_cvt_pk_bf16_f32 v237, v208, -v209
    v_pk_mul_f32 v[234:235], v[226:227], v[180:181] op_sel_hi:[0,1]
    s_add_u32 s64, s64, 55296
    buffer_load_dwordx4 a[196:199], v15, s[36:39], s64 offen
    v_pk_mul_f32 v[230:231], v[192:193], v[182:183] op_sel_hi:[0,1]
    v_pk_fma_f32 v[226:227], v[226:227], v[180:181], v[234:235] op_sel:[1,1,0] op_sel_hi:[1,0,1] neg_lo:[1,0,0]
    ds_write_addtid_b32 v242 offset:11424
    ds_write_addtid_b32 v237 offset:7344
    ds_write_addtid_b32 v237 offset:5440
    v_pk_fma_f32 v[192:193], v[192:193], v[182:183], v[230:231] op_sel:[1,1,0] op_sel_hi:[1,0,1] neg_lo:[1,0,0]
    v_cvt_pk_bf16_f32 v243, v226, v227
    v_cvt_pk_bf16_f32 v238, v192, -v193
    v_pk_mul_f32 v[232:233], v[180:181], v[180:181] op_sel_hi:[0,1]
    v_pk_mul_f32 v[228:229], v[200:201], v[182:183] op_sel_hi:[0,1]
    v_pk_fma_f32 v[212:213], v[180:181], v[180:181], v[232:233] op_sel:[1,1,0] op_sel_hi:[1,0,1] neg_lo:[1,0,0]
    ds_write_addtid_b32 v243 offset:11696
    ds_write_addtid_b32 v238 offset:4624
    v_pk_fma_f32 v[200:201], v[200:201], v[182:183], v[228:229] op_sel:[1,1,0] op_sel_hi:[1,0,1] neg_lo:[1,0,0]
    v_cvt_pk_bf16_f32 v240, v212, v213
    v_cvt_pk_bf16_f32 v239, v200, -v201
    s_add_u32 s64, s64, 55296
    buffer_load_dwordx4 a[200:203], v15, s[36:39], s64 offen
    v_pk_mul_f32 v[234:235], v[214:215], v[180:181] op_sel_hi:[0,1]
    v_pk_mul_f32 v[230:231], v[208:209], v[182:183] op_sel_hi:[0,1]
    v_pk_fma_f32 v[214:215], v[214:215], v[180:181], v[234:235] op_sel:[1,1,0] op_sel_hi:[1,0,1] neg_lo:[1,0,0]
    ds_write_addtid_b32 v240 offset:11968
    ds_write_addtid_b32 v239 offset:4896
    v_pk_fma_f32 v[208:209], v[208:209], v[182:183], v[230:231] op_sel:[1,1,0] op_sel_hi:[1,0,1] neg_lo:[1,0,0]
    v_cvt_pk_bf16_f32 v241, v214, v215
    v_cvt_pk_bf16_f32 v236, v208, -v209
    v_pk_mul_f32 v[232:233], v[216:217], v[180:181] op_sel_hi:[0,1]
    v_pk_mul_f32 v[228:229], v[192:193], v[182:183] op_sel_hi:[0,1]
    v_pk_fma_f32 v[216:217], v[216:217], v[180:181], v[232:233] op_sel:[1,1,0] op_sel_hi:[1,0,1] neg_lo:[1,0,0]
    ds_write_addtid_b32 v241 offset:12240
    ds_write_addtid_b32 v236 offset:5168
    v_pk_fma_f32 v[192:193], v[192:193], v[182:183], v[228:229] op_sel:[1,1,0] op_sel_hi:[1,0,1] neg_lo:[1,0,0]
    v_cvt_pk_bf16_f32 v242, v216, v217
    v_cvt_pk_bf16_f32 v237, v192, -v193
    v_pk_mul_f32 v[234:235], v[218:219], v[180:181] op_sel_hi:[0,1]
    s_add_u32 s64, s64, 55296
    buffer_load_dwordx4 a[204:207], v15, s[36:39], s64 offen
    v_pk_mul_f32 v[230:231], v[200:201], v[182:183] op_sel_hi:[0,1]
    v_pk_fma_f32 v[218:219], v[218:219], v[180:181], v[234:235] op_sel:[1,1,0] op_sel_hi:[1,0,1] neg_lo:[1,0,0]
    ds_write_addtid_b32 v242 offset:12512
    ds_write_addtid_b32 v237 offset:5712
    v_pk_fma_f32 v[200:201], v[200:201], v[182:183], v[230:231] op_sel:[1,1,0] op_sel_hi:[1,0,1] neg_lo:[1,0,0]
    v_cvt_pk_bf16_f32 v243, v218, v219
    v_cvt_pk_bf16_f32 v238, v200, -v201
    v_pk_mul_f32 v[232:233], v[220:221], v[180:181] op_sel_hi:[0,1]
    v_pk_mul_f32 v[228:229], v[208:209], v[182:183] op_sel_hi:[0,1]
    v_pk_fma_f32 v[220:221], v[220:221], v[180:181], v[232:233] op_sel:[1,1,0] op_sel_hi:[1,0,1] neg_lo:[1,0,0]
    ds_write_addtid_b32 v243 offset:12784
    ds_write_addtid_b32 v238 offset:5984
    v_pk_fma_f32 v[208:209], v[208:209], v[182:183], v[228:229] op_sel:[1,1,0] op_sel_hi:[1,0,1] neg_lo:[1,0,0]
    v_cvt_pk_bf16_f32 v240, v220, v221
    v_cvt_pk_bf16_f32 v239, v208, -v209
    v_pk_mul_f32 v[234:235], v[222:223], v[180:181] op_sel_hi:[0,1]
    v_pk_mul_f32 v[230:231], v[208:209], v[182:183] op_sel_hi:[0,1]
    s_mul_i32 s66, s1, 276480
    s_add_u32 s66, s66, s82
    s_add_u32 s66, s66, 221184
    s_mul_i32 s67, s1, 20480
    s_add_u32 s67, s67, s79
    s_add_u32 m0, s67, 81920
    s_nop 0
    buffer_load_dwordx4 v15, s[36:39], s66 offen lds
    s_mov_b32 m0, s83
    v_pk_fma_f32 v[222:223], v[222:223], v[180:181], v[234:235] op_sel:[1,1,0] op_sel_hi:[1,0,1] neg_lo:[1,0,0]
    ds_write_addtid_b32 v240 offset:13056
    ds_write_addtid_b32 v239 offset:6256
    v_pk_fma_f32 v[208:209], v[208:209], v[182:183], v[230:231] op_sel:[1,1,0] op_sel_hi:[1,0,1] neg_lo:[1,0,0]
    v_cvt_pk_bf16_f32 v241, v222, v223
    v_cvt_pk_bf16_f32 v236, v208, -v209
    v_pk_mul_f32 v[232:233], v[224:225], v[180:181] op_sel_hi:[0,1]
    v_pk_mul_f32 v[228:229], v[208:209], v[182:183] op_sel_hi:[0,1]
    v_pk_fma_f32 v[224:225], v[224:225], v[180:181], v[232:233] op_sel:[1,1,0] op_sel_hi:[1,0,1] neg_lo:[1,0,0]
    ds_write_addtid_b32 v241 offset:13328
    ds_write_addtid_b32 v236 offset:6528
    s_add_u32 m0, s67, 86016
    s_add_u32 s66, s66, 55296
    buffer_load_dwordx4 v15, s[36:39], s66 offen lds
    s_mov_b32 m0, s83
    v_pk_fma_f32 v[208:209], v[208:209], v[182:183], v[228:229] op_sel:[1,1,0] op_sel_hi:[1,0,1] neg_lo:[1,0,0]
    v_cvt_pk_bf16_f32 v242, v224, v225
    v_cvt_pk_bf16_f32 v237, v208, -v209
    v_pk_mul_f32 v[234:235], v[226:227], v[180:181] op_sel_hi:[0,1]
    v_pk_mul_f32 v[230:231], v[208:209], v[182:183] op_sel_hi:[0,1]
    v_pk_fma_f32 v[226:227], v[226:227], v[180:181], v[234:235] op_sel:[1,1,0] op_sel_hi:[1,0,1] neg_lo:[1,0,0]
    ds_write_addtid_b32 v242 offset:13600
    ds_write_addtid_b32 v237 offset:3808
    v_pk_fma_f32 v[208:209], v[208:209], v[182:183], v[230:231] op_sel:[1,1,0] op_sel_hi:[1,0,1] neg_lo:[1,0,0]
    v_cvt_pk_bf16_f32 v243, v226, v227
    v_cvt_pk_bf16_f32 v238, v208, -v209
    v_pk_mul_f32 v[232:233], v[212:213], v[180:181] op_sel_hi:[0,1]
    v_pk_mul_f32 v[228:229], v[208:209], v[182:183] op_sel_hi:[0,1]
    v_pk_fma_f32 v[212:213], v[212:213], v[180:181], v[232:233] op_sel:[1,1,0] op_sel_hi:[1,0,1] neg_lo:[1,0,0]
    ds_write_addtid_b32 v243 offset:13872
    ds_write_addtid_b32 v238 offset:6800
    s_add_u32 m0, s67, 90112
    s_add_u32 s66, s66, 55296
    buffer_load_dwordx4 v15, s[36:39], s66 offen lds
    s_mov_b32 m0, s83
    v_pk_fma_f32 v[208:209], v[208:209], v[182:183], v[228:229] op_sel:[1,1,0] op_sel_hi:[1,0,1] neg_lo:[1,0,0]
    v_cvt_pk_bf16_f32 v240, v212, v213
    v_cvt_pk_bf16_f32 v239, v208, -v209
    v_pk_mul_f32 v[234:235], v[214:215], v[180:181] op_sel_hi:[0,1]
    v_pk_fma_f32 v[214:215], v[214:215], v[180:181], v[234:235] op_sel:[1,1,0] op_sel_hi:[1,0,1] neg_lo:[1,0,0]
    ds_write_addtid_b32 v240 offset:14144
    ds_write_addtid_b32 v239 offset:4080
    v_cvt_pk_bf16_f32 v241, v214, v215
    v_pk_mul_f32 v[232:233], v[216:217], v[180:181] op_sel_hi:[0,1]
    v_pk_fma_f32 v[216:217], v[216:217], v[180:181], v[232:233] op_sel:[1,1,0] op_sel_hi:[1,0,1] neg_lo:[1,0,0]
    v_cvt_pk_bf16_f32 v242, v216, v217
    v_pk_mul_f32 v[234:235], v[218:219], v[180:181] op_sel_hi:[0,1]
    ds_write_addtid_b32 v241 offset:14416
    ds_write_addtid_b32 v242 offset:14688
    v_pk_fma_f32 v[218:219], v[218:219], v[180:181], v[234:235] op_sel:[1,1,0] op_sel_hi:[1,0,1] neg_lo:[1,0,0]
    s_add_u32 m0, s67, 94208
    s_add_u32 s66, s66, 55296
    buffer_load_dwordx4 v15, s[36:39], s66 offen lds
    s_mov_b32 m0, s83
    v_cvt_pk_bf16_f32 v243, v218, v219
    v_pk_mul_f32 v[232:233], v[220:221], v[180:181] op_sel_hi:[0,1]
    v_pk_fma_f32 v[220:221], v[220:221], v[180:181], v[232:233] op_sel:[1,1,0] op_sel_hi:[1,0,1] neg_lo:[1,0,0]
    v_cvt_pk_bf16_f32 v240, v220, v221
    v_pk_mul_f32 v[234:235], v[222:223], v[180:181] op_sel_hi:[0,1]
    ds_write_addtid_b32 v243 offset:14960
    ds_write_addtid_b32 v240 offset:15232
    v_pk_fma_f32 v[222:223], v[222:223], v[180:181], v[234:235] op_sel:[1,1,0] op_sel_hi:[1,0,1] neg_lo:[1,0,0]
    v_cvt_pk_bf16_f32 v241, v222, v223
    v_pk_mul_f32 v[232:233], v[224:225], v[180:181] op_sel_hi:[0,1]
    v_pk_fma_f32 v[224:225], v[224:225], v[180:181], v[232:233] op_sel:[1,1,0] op_sel_hi:[1,0,1] neg_lo:[1,0,0]
    v_cvt_pk_bf16_f32 v242, v224, v225
    v_pk_mul_f32 v[234:235], v[226:227], v[180:181] op_sel_hi:[0,1]
    ds_write_addtid_b32 v241 offset:15504
    s_lshl_b32 s65, s42, 8
    s_add_u32 s65, s65, 4096
    v_min_u32 v28, 7, v1
    v_lshlrev_b32 v28, 5, v28
    s_add_u32 m0, s67, 98304
    s_add_u32 s66, s66, 55296
    buffer_load_dwordx4 v15, s[36:39], s66 offen lds
    s_mov_b32 m0, s83
    s_nop 0
    ds_write_addtid_b32 v242 offset:15776
    v_pk_fma_f32 v[226:227], v[226:227], v[180:181], v[234:235] op_sel:[1,1,0] op_sel_hi:[1,0,1] neg_lo:[1,0,0]
    v_cvt_pk_bf16_f32 v243, v226, v227
    ds_write_addtid_b32 v243 offset:16048
    v_and_b32 v6, 31, v1
    v_mul_u32_u24 v6, 272, v6
    v_lshrrev_b32 v7, 5, v1
    v_lshl_add_u32 v6, v7, 4, v6
    s_lshr_b32 s76, s3, 1
    s_mul_i32 s76, s76, 32768
    v_add_u32 v6, s76, v6
    s_mov_b32 vcc_lo, 0xc000
    s_mov_b32 vcc_hi, vcc_lo
    v_add_u32 v7, 3264, v6
    v_cndmask_b32 v7, v6, v7, vcc
    s_mov_b32 exec_lo, 0x30000000
    s_mov_b32 exec_hi, exec_lo
    v_subrev_u32 v7, 3808, v6
    s_lshl_b64 exec, exec, 2
    v_subrev_u32 v7, 4352, v6
    s_mov_b64 exec, -1
    s_waitcnt lgkmcnt(0)
    s_barrier
    ds_read_b128 v[176:179], v7 offset:0
    ds_read_b128 v[180:183], v6 offset:7616
    ds_read_b128 v[184:187], v7 offset:32
    ds_read_b128 v[188:191], v6 offset:7648
    ds_read_b128 v[192:195], v7 offset:64
    ds_read_b128 v[196:199], v6 offset:7680
    ds_read_b128 v[200:203], v7 offset:96
    ds_read_b128 v[204:207], v6 offset:7712
    ds_read_b128 v[208:211], v7 offset:128
    ds_read_b128 v[212:215], v6 offset:7744
    ds_read_b128 v[216:219], v7 offset:160
    ds_read_b128 v[220:223], v6 offset:7776
    ds_read_b128 v[224:227], v7 offset:192
    ds_read_b128 v[228:231], v6 offset:7808
    s_waitcnt lgkmcnt(12)
    v_mfma_f32_32x32x16_bf16 v[112:127], v[176:179], v[180:183], 0
    ds_read_b128 v[232:235], v7 offset:224
    ds_read_b128 v[236:239], v6 offset:7840
    s_mul_i32 s66, s28, 276480
    s_add_u32 s66, s66, s82
    s_add_u32 s66, s66, 221184
    s_waitcnt lgkmcnt(12)
    v_mfma_f32_32x32x16_bf16 v[112:127], v[184:187], v[188:191], v[112:127]
    ds_read_b128 v[176:179], v7 offset:16384
    ds_read_b128 v[180:183], v6 offset:24000
    s_mul_i32 s67, s28, 20480
    s_add_u32 s67, s67, s79
    s_add_u32 m0, s67, 81920
    s_waitcnt lgkmcnt(12)
    v_mfma_f32_32x32x16_bf16 v[112:127], v[192:195], v[196:199], v[112:127]
    ds_read_b128 v[184:187], v7 offset:16416
    ds_read_b128 v[188:191], v6 offset:24032
    buffer_load_dwordx4 v15, s[36:39], s66 offen lds
    s_mov_b32 m0, s83
    s_add_u32 m0, s67, 86016
    s_waitcnt lgkmcnt(12)
    v_mfma_f32_32x32x16_bf16 v[112:127], v[200:203], v[204:207], v[112:127]
    ds_read_b128 v[192:195], v7 offset:16448
    ds_read_b128 v[196:199], v6 offset:24064
    s_add_u32 s66, s66, 55296
    s_waitcnt lgkmcnt(12)
    v_mfma_f32_32x32x16_bf16 v[112:127], v[208:211], v[212:215], v[112:127]
    ds_read_b128 v[200:203], v7 offset:16480
    ds_read_b128 v[204:207], v6 offset:24096
    buffer_load_dwordx4 v15, s[36:39], s66 offen lds
    s_mov_b32 m0, s83
    s_add_u32 m0, s67, 90112
    s_waitcnt lgkmcnt(12)
    v_mfma_f32_32x32x16_bf16 v[112:127], v[216:219], v[220:223], v[112:127]
    ds_read_b128 v[208:211], v7 offset:16512
    ds_read_b128 v[212:215], v6 offset:24128
    s_add_u32 s66, s66, 55296
    s_waitcnt lgkmcnt(12)
    v_mfma_f32_32x32x16_bf16 v[112:127], v[224:227], v[228:231], v[112:127]
    ds_read_b128 v[216:219], v7 offset:16544
    ds_read_b128 v[220:223], v6 offset:24160
    buffer_load_dwordx4 v15, s[36:39], s66 offen lds
    s_mov_b32 m0, s83
    s_add_u32 m0, s67, 94208
    s_waitcnt lgkmcnt(12)
    v_mfma_f32_32x32x16_bf16 v[112:127], v[232:235], v[236:239], v[112:127]
    ds_read_b128 v[224:227], v7 offset:16576
    ds_read_b128 v[228:231], v6 offset:24192
    s_add_u32 s66, s66, 55296
    s_waitcnt lgkmcnt(12)
    v_mfma_f32_32x32x16_bf16 v[112:127], v[176:179], v[180:183], v[112:127]
    ds_read_b128 v[232:235], v7 offset:16608
    ds_read_b128 v[236:239], v6 offset:24224
    s_waitcnt lgkmcnt(12)
    v_mfma_f32_32x32x16_bf16 v[112:127], v[184:187], v[188:191], v[112:127]
    buffer_load_dwordx4 v15, s[36:39], s66 offen lds
    s_mov_b32 m0, s83
    buffer_load_dword v24, v28, s[32:35], s65 offen sc1
    s_add_u32 m0, s67, 98304
    s_waitcnt lgkmcnt(10)
    v_mfma_f32_32x32x16_bf16 v[112:127], v[192:195], v[196:199], v[112:127]
    s_add_u32 s66, s66, 55296
    s_waitcnt lgkmcnt(8)
    v_mfma_f32_32x32x16_bf16 v[112:127], v[200:203], v[204:207], v[112:127]
    s_waitcnt lgkmcnt(6)
    v_mfma_f32_32x32x16_bf16 v[112:127], v[208:211], v[212:215], v[112:127]
    buffer_load_dwordx4 v15, s[36:39], s66 offen lds
    s_mov_b32 m0, s83
    s_mul_i32 s66, s29, 276480
    s_add_u32 s66, s66, s82
    s_add_u32 s66, s66, 221184
    s_waitcnt lgkmcnt(4)
    v_mfma_f32_32x32x16_bf16 v[112:127], v[216:219], v[220:223], v[112:127]
    s_mul_i32 s67, s29, 20480
    s_add_u32 s67, s67, s79
    s_add_u32 m0, s67, 81920
    s_waitcnt lgkmcnt(2)
    v_mfma_f32_32x32x16_bf16 v[112:127], v[224:227], v[228:231], v[112:127]
    buffer_load_dwordx4 v15, s[36:39], s66 offen lds
    s_mov_b32 m0, s83
    s_add_u32 m0, s67, 86016
    s_add_u32 s66, s66, 55296
    s_waitcnt lgkmcnt(0)
    v_mfma_f32_32x32x16_bf16 v[112:127], v[232:235], v[236:239], v[112:127]
    v_and_b32 v2, 15, v1
    buffer_load_dwordx4 v15, s[36:39], s66 offen lds
    v_lshrrev_b32 v3, 4, v1
    v_mul_u32_u24 v26, 176, v2
    v_mul_u32_u24 v27, 40, v3
    s_lshl_b32 s72, s3, 12
    s_add_u32 s72, s72, 94208
    v_add3_u32 v26, v26, v27, s72
    v_mul_u32_u24 v3, 81920, v3
    v_lshl_add_u32 v27, v2, 2, v3
    s_lshr_b32 s72, s3, 1
    s_mul_i32 s72, s72, 13312
    s_and_b32 s73, s3, 1
    s_mov_b32 m0, s83
    s_add_u32 m0, s67, 90112
    s_add_u32 s66, s66, 55296
    buffer_load_dwordx4 v15, s[36:39], s66 offen lds
    s_lshl_b32 s73, s73, 8
    s_sub_u32 s72, s72, s73
    s_add_u32 s73, s72, 74112
    s_add_u32 s72, s72, 65822
    v_and_b32 v2, 15, v1
    v_lshrrev_b32 v3, 4, v1
    v_and_b32 v4, 1, v1
    v_xor_b32 v4, 1, v4
    v_mul_u32_u24 v4, 4162, v4
    v_lshlrev_b32 v5, 4, v3
    v_add3_u32 v4, v4, v5, s72
    s_mov_b32 m0, s83
    s_add_u32 m0, s67, 94208
    s_add_u32 s66, s66, 55296
    buffer_load_dwordx4 v15, s[36:39], s66 offen lds
    v_lshlrev_b32 v20, 1, v2
    v_sub_u32 v19, v4, v20
    v_add_u32 v18, 1024, v19
    v_add_u32 v17, 2048, v19
    v_add_u32 v16, 3072, v19
    s_sub_u32 s74, s73, 704
    v_mov_b32 v4, s74
    s_bitcmp1_b32 s3, 0
    s_cselect_b64 vcc, -1, 0
    s_cselect_b32 s74, 192, 0
    v_cndmask_b32 v18, v18, v4, vcc
    s_mov_b32 m0, s83
    s_add_u32 m0, s67, 98304
    s_add_u32 s66, s66, 55296
    buffer_load_dwordx4 v15, s[36:39], s66 offen lds
    s_add_u32 s74, s74, s73
    s_sub_u32 s74, s74, 8460
    v_lshl_add_u32 v4, v2, 2, s74
    v_sub_u32 v19, v4, v5
    v_lshl_add_u32 v5, v2, 5, v5
    v_add_u32 v20, s73, v5
    v_mul_u32_u24 v3, 320, v3
    v_lshl_add_u32 v3, v2, 4, v3
    s_mul_i32 s72, s3, 10240
    s_add_u32 s72, s72, 92160
    v_add_u32 v21, s72, v3
    s_mov_b32 m0, s83
    s_waitcnt vmcnt(6)
    v_cmp_ne_u32 vcc, v25, v24
    s_cbranch_vccnz c1_slow
c1_ok:
    s_add_u32 s64, s58, 0
    buffer_load_dwordx4 a[0:3], v14, s[32:35], s64 offen offset:0 sc1
    v_and_b32 v3, 3, v1
    v_mul_u32_u24 v3, 320, v3
    v_lshrrev_b32 v2, 2, v1
    v_lshl_add_u32 v3, v2, 4, v3
    s_mul_i32 s72, s3, 2560
    s_add_u32 s72, s72, 92160
    v_add_u32 v22, s72, v3
    v_lshrrev_b32 v2, 5, v1
    v_mul_u32_u24 v2, 40960, v2
    v_and_b32 v3, 0x1f0, v8
    v_add_u32 v29, v2, v3
    buffer_load_dwordx4 a[4:7], v14, s[32:35], s64 offen offset:256 sc1
    s_mul_i32 s72, s50, 221184
    s_add_u32 s72, s72, 7520256
    s_mul_i32 s73, s51, 276480
    s_add_u32 s73, s73, 2686976
    s_lshl_b32 s74, s3, 13
    s_add_u32 s52, s72, s74
    s_sub_u32 s53, s72, s74
    s_add_u32 s53, s53, 28672
    s_mul_i32 s74, s3, 10240
    s_add_u32 s54, s73, s74
    s_sub_u32 s55, s73, s74
    buffer_load_dwordx4 a[8:11], v9, s[32:35], s64 offen offset:0 sc1
    s_add_u32 s55, s55, 35840
    s_cmp_eq_u32 s3, 3
    s_cselect_b32 s56, 134217728, 0
    s_cmp_eq_u32 s3, 0
    s_cselect_b32 s57, 134217728, 0
    s_add_u32 s22, s52, 196608
    s_or_b32 s22, s22, s56
    s_add_u32 s23, s53, 196608
    s_or_b32 s23, s23, s57
    s_mov_b32 s62, 0xbfb8aa3b
    s_mov_b32 s63, 0xbfb8aa3b
    buffer_load_dwordx4 a[12:15], v9, s[32:35], s64 offen offset:256 sc1
    s_mul_i32 s77, s44, 1639
    s_lshr_b32 s77, s77, 16
    s_mul_i32 s77, s77, 96
    s_lshl_b32 s19, s44, 2
    s_add_u32 s19, s19, s77
    s_lshl_b32 s77, s3, 11
    s_add_u32 s19, s19, s77
    s_lshl_b32 s19, s19, 3
    s_add_u32 s19, s19, 14745600
    v_and_b32 v96, 15, v1
    v_lshrrev_b32 v97, 1, v1
    buffer_load_dwordx4 a[16:19], v14, s[32:35], s64 offen offset:2048 sc1
    v_and_b32 v97, 24, v97
    v_mov_b32 v98, 4064
    v_lshlrev_b32 v98, v96, v98
    v_lshrrev_b32 v98, v97, v98
    v_bfe_u32 v99, v98, 0, 2
    v_mul_u32_u24 v99, 0x8001, v99
    v_and_b32 v99, 0x10001, v99
    v_mul_u32_u24 v40, 0x3f80, v99
    v_bfe_u32 v99, v98, 2, 2
    v_mul_u32_u24 v99, 0x8001, v99
    v_and_b32 v99, 0x10001, v99
    buffer_load_dwordx4 a[20:23], v14, s[32:35], s64 offen offset:2304 sc1
    v_mul_u32_u24 v41, 0x3f80, v99
    v_bfe_u32 v99, v98, 4, 2
    v_mul_u32_u24 v99, 0x8001, v99
    v_and_b32 v99, 0x10001, v99
    v_mul_u32_u24 v42, 0x3f80, v99
    v_bfe_u32 v99, v98, 6, 2
    v_mul_u32_u24 v99, 0x8001, v99
    v_and_b32 v99, 0x10001, v99
    v_mul_u32_u24 v43, 0x3f80, v99
    v_mov_b32 v98, 8176
    v_lshlrev_b32 v98, v96, v98
    buffer_load_dwordx4 a[24:27], v9, s[32:35], s64 offen offset:2048 sc1
    v_lshrrev_b32 v98, v97, v98
    v_bfe_u32 v99, v98, 0, 2
    v_mul_u32_u24 v99, 0x8001, v99
    v_and_b32 v99, 0x10001, v99
    v_mul_u32_u24 v44, 0x3f80, v99
    v_bfe_u32 v99, v98, 2, 2
    v_mul_u32_u24 v99, 0x8001, v99
    v_and_b32 v99, 0x10001, v99
    v_mul_u32_u24 v45, 0x3f80, v99
    v_bfe_u32 v99, v98, 4, 2
    v_mul_u32_u24 v99, 0x8001, v99
    buffer_load_dwordx4 a[28:31], v9, s[32:35], s64 offen offset:2304 sc1
    v_and_b32 v99, 0x10001, v99
    v_mul_u32_u24 v46, 0x3f80, v99
    v_bfe_u32 v99, v98, 6, 2
    v_mul_u32_u24 v99, 0x8001, v99
    v_and_b32 v99, 0x10001, v99
    v_mul_u32_u24 v47, 0x3f80, v99
    s_add_u32 s65, s58, 4096
    buffer_load_dwordx4 a[32:35], v14, s[32:35], s65 offen offset:0 sc1
    buffer_load_dwordx4 a[36:39], v14, s[32:35], s65 offen offset:256 sc1
    s_waitcnt vmcnt(10)
    s_barrier
    ds_read_b64_tr_b16 a[160:161], v10 offset:0
    ds_read_b64_tr_b16 a[162:163], v10 offset:512
    ds_read_b64_tr_b16 a[164:165], v10 offset:1024
    ds_read_b64_tr_b16 a[166:167], v10 offset:1536
    ds_read_b64_tr_b16 a[168:169], v12 offset:0
    ds_read_b64_tr_b16 a[170:171], v12 offset:512
    ds_read_b64_tr_b16 a[172:173], v12 offset:1024
    ds_read_b64_tr_b16 a[174:175], v12 offset:1536
    s_waitcnt vmcnt(9) lgkmcnt(6)
    v_mfma_f32_16x16x32_bf16 v[128:131], a[160:163], a[0:3], 0
    ds_read_b64_tr_b16 a[176:177], v11 offset:0
    buffer_load_dwordx4 a[40:43], v9, s[32:35], s65 offen offset:0 sc1
    s_waitcnt vmcnt(9)
    v_mfma_f32_16x16x32_bf16 v[144:147], a[160:163], a[4:7], 0
    s_lshl_b32 s68, s3, 11
    s_lshl_b32 s76, s0, 14
    v_lshl_add_u32 v6, v0, 4, s76
    s_waitcnt vmcnt(8)
    v_mfma_f32_16x16x32_bf16 v[160:163], a[160:163], a[8:11], 0
    ds_read_b64_tr_b16 a[178:179], v11 offset:512
    s_add_u32 s68, s68, 4096
    s_waitcnt vmcnt(7)
    v_mfma_f32_16x16x32_bf16 v[176:179], a[160:163], a[12:15], 0
    s_nop 0
    v_min_u32 v28, 63, v1
    v_lshlrev_b32 v28, 5, v28
    s_waitcnt lgkmcnt(6)
    v_mfma_f32_16x16x32_bf16 v[184:187], a[164:167], a[12:15], 0
    ds_read_b64_tr_b16 a[180:181], v11 offset:1024
    buffer_load_dword v24, v28, s[32:35], s68 offen sc1
    v_mfma_f32_16x16x32_bf16 v[168:171], a[164:167], a[8:11], 0
    v_mfma_f32_16x16x32_bf16 v[152:155], a[164:167], a[4:7], 0
    ds_read_b64_tr_b16 a[182:183], v11 offset:1536
    buffer_load_dwordx4 a[44:47], v9, s[32:35], s65 offen offset:256 sc1
    v_mfma_f32_16x16x32_bf16 v[136:139], a[164:167], a[0:3], 0
    s_waitcnt lgkmcnt(4)
    v_mfma_f32_16x16x32_bf16 v[192:195], a[168:171], a[0:3], 0
    ds_read_b64_tr_b16 a[184:185], v13 offset:0
    v_mfma_f32_16x16x32_bf16 v[208:211], a[168:171], a[4:7], 0
    v_mfma_f32_16x16x32_bf16 v[224:227], a[168:171], a[8:11], 0
    ds_read_b64_tr_b16 a[186:187], v13 offset:512
    v_mfma_f32_16x16x32_bf16 v[240:243], a[168:171], a[12:15], 0
    buffer_load_dwordx4 a[48:51], v14, s[32:35], s65 offen offset:2048 sc1
    v_mfma_f32_16x16x32_bf16 v[248:251], a[172:175], a[12:15], 0
    ds_read_b64_tr_b16 a[188:189], v13 offset:1024
    v_mfma_f32_16x16x32_bf16 v[232:235], a[172:175], a[8:11], 0
    v_mfma_f32_16x16x32_bf16 v[216:219], a[172:175], a[4:7], 0
    ds_read_b64_tr_b16 a[190:191], v13 offset:1536
    v_mfma_f32_16x16x32_bf16 v[200:203], a[172:175], a[0:3], 0
    s_waitcnt lgkmcnt(4)
    buffer_load_dwordx4 a[52:55], v14, s[32:35], s65 offen offset:2304 sc1
    v_mfma_f32_16x16x32_bf16 v[132:135], a[176:179], a[0:3], 0
    ds_read_b64_tr_b16 a[160:161], v10 offset:8192
    v_mfma_f32_16x16x32_bf16 v[148:151], a[176:179], a[4:7], 0
    v_mfma_f32_16x16x32_bf16 v[164:167], a[176:179], a[8:11], 0
    ds_read_b64_tr_b16 a[162:163], v10 offset:8704
    v_mfma_f32_16x16x32_bf16 v[180:183], a[176:179], a[12:15], 0
    v_mfma_f32_16x16x32_bf16 v[188:191], a[180:183], a[12:15], 0
    ds_read_b64_tr_b16 a[164:165], v10 offset:9216
    buffer_load_dwordx4 a[56:59], v9, s[32:35], s65 offen offset:2048 sc1
    v_mfma_f32_16x16x32_bf16 v[172:175], a[180:183], a[8:11], 0
    v_mfma_f32_16x16x32_bf16 v[156:159], a[180:183], a[4:7], 0
    ds_read_b64_tr_b16 a[166:167], v10 offset:9728
    v_mfma_f32_16x16x32_bf16 v[140:143], a[180:183], a[0:3], 0
    s_waitcnt lgkmcnt(4)
    v_mfma_f32_16x16x32_bf16 v[196:199], a[184:187], a[0:3], 0
    ds_read_b64_tr_b16 a[168:169], v12 offset:8192
    buffer_load_dwordx4 a[60:63], v9, s[32:35], s65 offen offset:2304 sc1
    v_mfma_f32_16x16x32_bf16 v[212:215], a[184:187], a[4:7], 0
    s_add_u32 s64, s58, 8192
    v_mfma_f32_16x16x32_bf16 v[228:231], a[184:187], a[8:11], 0
    ds_read_b64_tr_b16 a[170:171], v12 offset:8704
    v_mfma_f32_16x16x32_bf16 v[244:247], a[184:187], a[12:15], 0
    ds_write_b128 v6, a[192:195] offset:0
    v_mfma_f32_16x16x32_bf16 v[252:255], a[188:191], a[12:15], 0
    ds_read_b64_tr_b16 a[172:173], v12 offset:9216
    buffer_load_dwordx4 a[64:67], v14, s[32:35], s64 offen offset:0 sc1
    v_mfma_f32_16x16x32_bf16 v[236:239], a[188:191], a[8:11], 0
    v_mfma_f32_16x16x32_bf16 v[220:223], a[188:191], a[4:7], 0
    ds_read_b64_tr_b16 a[174:175], v12 offset:9728
    v_mfma_f32_16x16x32_bf16 v[204:207], a[188:191], a[0:3], 0
    s_waitcnt vmcnt(10) lgkmcnt(5)
    v_mfma_f32_16x16x32_bf16 v[128:131], a[160:163], a[16:19], v[128:131]
    ds_read_b64_tr_b16 a[176:177], v11 offset:8192
    buffer_load_dwordx4 a[68:71], v14, s[32:35], s64 offen offset:256 sc1
    v_mfma_f32_16x16x32_bf16 v[144:147], a[160:163], a[20:23], v[144:147]
    ds_write_b128 v6, a[196:199] offset:4096
    v_mfma_f32_16x16x32_bf16 v[160:163], a[160:163], a[24:27], v[160:163]
    ds_read_b64_tr_b16 a[178:179], v11 offset:8704
    v_mfma_f32_16x16x32_bf16 v[176:179], a[160:163], a[28:31], v[176:179]
    v_mfma_f32_16x16x32_bf16 v[184:187], a[164:167], a[28:31], v[184:187]
    ds_read_b64_tr_b16 a[180:181], v11 offset:9216
    buffer_load_dwordx4 a[72:75], v9, s[32:35], s64 offen offset:0 sc1
    v_mfma_f32_16x16x32_bf16 v[168:171], a[164:167], a[24:27], v[168:171]
    ds_write_b128 v6, a[200:203] offset:8192
    v_mfma_f32_16x16x32_bf16 v[152:155], a[164:167], a[20:23], v[152:155]
    ds_read_b64_tr_b16 a[182:183], v11 offset:9728
    v_mfma_f32_16x16x32_bf16 v[136:139], a[164:167], a[16:19], v[136:139]
    s_waitcnt lgkmcnt(6)
    v_mfma_f32_16x16x32_bf16 v[192:195], a[168:171], a[16:19], v[192:195]
    ds_read_b64_tr_b16 a[184:185], v10 offset:16384
    buffer_load_dwordx4 a[76:79], v9, s[32:35], s64 offen offset:256 sc1
    v_mfma_f32_16x16x32_bf16 v[208:211], a[168:171], a[20:23], v[208:211]
    ds_write_b128 v6, a[204:207] offset:12288
    v_mfma_f32_16x16x32_bf16 v[224:227], a[168:171], a[24:27], v[224:227]
    ds_read_b64_tr_b16 a[186:187], v10 offset:16896
    s_nop 0
    v_mfma_f32_16x16x32_bf16 v[240:243], a[168:171], a[28:31], v[240:243]
    v_mfma_f32_16x16x32_bf16 v[248:251], a[172:175], a[28:31], v[248:251]
    ds_read_b64_tr_b16 a[188:189], v10 offset:17408
    buffer_load_dwordx4 a[80:83], v14, s[32:35], s64 offen offset:2048 sc1
    v_mfma_f32_16x16x32_bf16 v[232:235], a[172:175], a[24:27], v[232:235]
    v_mfma_f32_16x16x32_bf16 v[216:219], a[172:175], a[20:23], v[216:219]
    ds_read_b64_tr_b16 a[190:191], v10 offset:17920
    v_mfma_f32_16x16x32_bf16 v[200:203], a[172:175], a[16:19], v[200:203]
    s_waitcnt lgkmcnt(5)
    v_mfma_f32_16x16x32_bf16 v[132:135], a[176:179], a[16:19], v[132:135]
    ds_read_b64_tr_b16 a[160:161], v13 offset:8192
    buffer_load_dwordx4 a[84:87], v14, s[32:35], s64 offen offset:2304 sc1
    v_mfma_f32_16x16x32_bf16 v[148:151], a[176:179], a[20:23], v[148:151]
    v_mfma_f32_16x16x32_bf16 v[164:167], a[176:179], a[24:27], v[164:167]
    ds_read_b64_tr_b16 a[162:163], v13 offset:8704
    v_mfma_f32_16x16x32_bf16 v[180:183], a[176:179], a[28:31], v[180:183]
    v_mfma_f32_16x16x32_bf16 v[188:191], a[180:183], a[28:31], v[188:191]
    ds_read_b64_tr_b16 a[164:165], v13 offset:9216
    v_mfma_f32_16x16x32_bf16 v[172:175], a[180:183], a[24:27], v[172:175]
    buffer_load_dwordx4 a[88:91], v9, s[32:35], s64 offen offset:2048 sc1
    v_mfma_f32_16x16x32_bf16 v[156:159], a[180:183], a[20:23], v[156:159]
    ds_read_b64_tr_b16 a[166:167], v13 offset:9728
    v_mfma_f32_16x16x32_bf16 v[140:143], a[180:183], a[16:19], v[140:143]
    s_waitcnt vmcnt(11) lgkmcnt(4)
    v_mfma_f32_16x16x32_bf16 v[128:131], a[184:187], a[32:35], v[128:131]
    ds_read_b64_tr_b16 a[168:169], v11 offset:16384
    v_mfma_f32_16x16x32_bf16 v[144:147], a[184:187], a[36:39], v[144:147]
    buffer_load_dwordx4 a[92:95], v9, s[32:35], s64 offen offset:2304 sc1
    s_add_u32 s65, s58, 12288
    v_mfma_f32_16x16x32_bf16 v[160:163], a[184:187], a[40:43], v[160:163]
    ds_read_b64_tr_b16 a[170:171], v11 offset:16896
    v_mfma_f32_16x16x32_bf16 v[176:179], a[184:187], a[44:47], v[176:179]
    v_mfma_f32_16x16x32_bf16 v[184:187], a[188:191], a[44:47], v[184:187]
    ds_read_b64_tr_b16 a[172:173], v11 offset:17408
    v_mfma_f32_16x16x32_bf16 v[168:171], a[188:191], a[40:43], v[168:171]
    v_mfma_f32_16x16x32_bf16 v[152:155], a[188:191], a[36:39], v[152:155]
    ds_read_b64_tr_b16 a[174:175], v11 offset:17920
    buffer_load_dwordx4 a[96:99], v14, s[32:35], s65 offen offset:0 sc1
    v_mfma_f32_16x16x32_bf16 v[136:139], a[188:191], a[32:35], v[136:139]
    s_waitcnt lgkmcnt(4)
    v_mfma_f32_16x16x32_bf16 v[196:199], a[160:163], a[16:19], v[196:199]
    ds_read_b64_tr_b16 a[176:177], v12 offset:16384
    v_mfma_f32_16x16x32_bf16 v[212:215], a[160:163], a[20:23], v[212:215]
    v_mfma_f32_16x16x32_bf16 v[228:231], a[160:163], a[24:27], v[228:231]
    ds_read_b64_tr_b16 a[178:179], v12 offset:16896
    buffer_load_dwordx4 a[100:103], v14, s[32:35], s65 offen offset:256 sc1
    v_mfma_f32_16x16x32_bf16 v[244:247], a[160:163], a[28:31], v[244:247]
    v_mfma_f32_16x16x32_bf16 v[252:255], a[164:167], a[28:31], v[252:255]
    ds_read_b64_tr_b16 a[180:181], v12 offset:17408
    v_mfma_f32_16x16x32_bf16 v[236:239], a[164:167], a[24:27], v[236:239]
    v_mfma_f32_16x16x32_bf16 v[220:223], a[164:167], a[20:23], v[220:223]
    ds_read_b64_tr_b16 a[182:183], v12 offset:17920
    v_mfma_f32_16x16x32_bf16 v[204:207], a[164:167], a[16:19], v[204:207]
    s_waitcnt lgkmcnt(4)
    buffer_load_dwordx4 a[104:107], v9, s[32:35], s65 offen offset:0 sc1
    v_mfma_f32_16x16x32_bf16 v[132:135], a[168:171], a[32:35], v[132:135]
    ds_read_b64_tr_b16 a[184:185], v10 offset:24576
    v_mfma_f32_16x16x32_bf16 v[148:151], a[168:171], a[36:39], v[148:151]
    v_mfma_f32_16x16x32_bf16 v[164:167], a[168:171], a[40:43], v[164:167]
    ds_read_b64_tr_b16 a[186:187], v10 offset:25088
    v_mfma_f32_16x16x32_bf16 v[180:183], a[168:171], a[44:47], v[180:183]
    buffer_load_dwordx4 a[108:111], v9, s[32:35], s65 offen offset:256 sc1
    v_mfma_f32_16x16x32_bf16 v[188:191], a[172:175], a[44:47], v[188:191]
    ds_read_b64_tr_b16 a[188:189], v10 offset:25600
    v_cmp_ne_u32 vcc, v25, v24
    s_cbranch_vccnz c2_slow
c2_ok:
    v_mfma_f32_16x16x32_bf16 v[172:175], a[172:175], a[40:43], v[172:175]
    v_mfma_f32_16x16x32_bf16 v[156:159], a[172:175], a[36:39], v[156:159]
    ds_read_b64_tr_b16 a[190:191], v10 offset:26112
    s_lshr_b32 s69, s44, 2
    s_mul_i32 s69, s69, 496
    s_lshl_b32 s77, s44, 2
    s_add_u32 s69, s69, s77
    s_mul_i32 s77, s3, 655360
    s_add_u32 s69, s69, s77
    s_add_u32 s69, s69, 65536
    v_mfma_f32_16x16x32_bf16 v[140:143], a[172:175], a[32:35], v[140:143]
    s_waitcnt lgkmcnt(4)
    buffer_load_dwordx4 a[112:115], v14, s[32:35], s65 offen offset:2048 sc1
    v_mfma_f32_16x16x32_bf16 v[192:195], a[176:179], a[32:35], v[192:195]
    ds_read_b64_tr_b16 a[160:161], v11 offset:24576
    v_mfma_f32_16x16x32_bf16 v[208:211], a[176:179], a[36:39], v[208:211]
    v_mfma_f32_16x16x32_bf16 v[224:227], a[176:179], a[40:43], v[224:227]
    ds_read_b64_tr_b16 a[162:163], v11 offset:25088
    v_mfma_f32_16x16x32_bf16 v[240:243], a[176:179], a[44:47], v[240:243]
    buffer_load_dwordx4 a[116:119], v14, s[32:35], s65 offen offset:2304 sc1
    v_mfma_f32_16x16x32_bf16 v[248:251], a[180:183], a[44:47], v[248:251]
    ds_read_b64_tr_b16 a[164:165], v11 offset:25600
    v_mfma_f32_16x16x32_bf16 v[232:235], a[180:183], a[40:43], v[232:235]
    v_mfma_f32_16x16x32_bf16 v[216:219], a[180:183], a[36:39], v[216:219]
    ds_read_b64_tr_b16 a[166:167], v11 offset:26112
    v_mfma_f32_16x16x32_bf16 v[200:203], a[180:183], a[32:35], v[200:203]
    s_waitcnt vmcnt(14) lgkmcnt(4)
    v_mfma_f32_16x16x32_bf16 v[128:131], a[184:187], a[48:51], v[128:131]
    ds_read_b64_tr_b16 a[168:169], v13 offset:16384
    buffer_load_dwordx4 a[120:123], v9, s[32:35], s65 offen offset:2048 sc1
    v_mfma_f32_16x16x32_bf16 v[144:147], a[184:187], a[52:55], v[144:147]
    v_mfma_f32_16x16x32_bf16 v[160:163], a[184:187], a[56:59], v[160:163]
    ds_read_b64_tr_b16 a[170:171], v13 offset:16896
    v_mfma_f32_16x16x32_bf16 v[176:179], a[184:187], a[60:63], v[176:179]
    v_mfma_f32_16x16x32_bf16 v[184:187], a[188:191], a[60:63], v[184:187]
    ds_read_b64_tr_b16 a[172:173], v13 offset:17408
    buffer_load_dwordx4 a[124:127], v9, s[32:35], s65 offen offset:2304 sc1
    v_mfma_f32_16x16x32_bf16 v[168:171], a[188:191], a[56:59], v[168:171]
    v_mfma_f32_16x16x32_bf16 v[152:155], a[188:191], a[52:55], v[152:155]
    ds_read_b64_tr_b16 a[174:175], v13 offset:17920
    v_mfma_f32_16x16x32_bf16 v[136:139], a[188:191], a[48:51], v[136:139]
    s_waitcnt lgkmcnt(4)
    v_mfma_f32_16x16x32_bf16 v[132:135], a[160:163], a[48:51], v[132:135]
    ds_read_b64_tr_b16 a[176:177], v10 offset:32768
    s_add_u32 s64, s58, 16384
    v_mfma_f32_16x16x32_bf16 v[148:151], a[160:163], a[52:55], v[148:151]
    buffer_load_dwordx4 a[128:131], v14, s[32:35], s64 offen offset:0 sc1
    s_mul_i32 s66, s1, 221184
    v_mfma_f32_16x16x32_bf16 v[164:167], a[160:163], a[56:59], v[164:167]
    ds_read_b64_tr_b16 a[178:179], v10 offset:33280
    s_add_u32 s66, s66, s82
    v_mfma_f32_16x16x32_bf16 v[180:183], a[160:163], a[60:63], v[180:183]
    s_add_u32 s66, s66, 1327104
    s_mul_i32 s67, s1, 16384
    s_add_u32 s67, s67, s79
    v_mfma_f32_16x16x32_bf16 v[188:191], a[164:167], a[60:63], v[188:191]
    ds_read_b64_tr_b16 a[180:181], v10 offset:33792
    s_add_u32 m0, s67, 0
    v_mfma_f32_16x16x32_bf16 v[172:175], a[164:167], a[56:59], v[172:175]
    buffer_load_dwordx4 a[132:135], v14, s[32:35], s64 offen offset:256 sc1
    v_mfma_f32_16x16x32_bf16 v[156:159], a[164:167], a[52:55], v[156:159]
    ds_read_b64_tr_b16 a[182:183], v10 offset:34304
    v_mfma_f32_16x16x32_bf16 v[140:143], a[164:167], a[48:51], v[140:143]
    s_waitcnt lgkmcnt(4)
    v_mfma_f32_16x16x32_bf16 v[196:199], a[168:171], a[32:35], v[196:199]
    ds_read_b64_tr_b16 a[184:185], v12 offset:24576
    v_mfma_f32_16x16x32_bf16 v[212:215], a[168:171], a[36:39], v[212:215]
    v_mfma_f32_16x16x32_bf16 v[228:231], a[168:171], a[40:43], v[228:231]
    ds_read_b64_tr_b16 a[186:187], v12 offset:25088
    buffer_load_dwordx4 v15, s[36:39], s66 offen lds
    v_mfma_f32_16x16x32_bf16 v[244:247], a[168:171], a[44:47], v[244:247]
    s_add_u32 m0, s67, 4096
    s_add_u32 s66, s66, 55296
    v_mfma_f32_16x16x32_bf16 v[252:255], a[172:175], a[44:47], v[252:255]
    ds_read_b64_tr_b16 a[188:189], v12 offset:25600
    v_mfma_f32_16x16x32_bf16 v[236:239], a[172:175], a[40:43], v[236:239]
    v_mfma_f32_16x16x32_bf16 v[220:223], a[172:175], a[36:39], v[220:223]
    ds_read_b64_tr_b16 a[190:191], v12 offset:26112
    buffer_load_dwordx4 v15, s[36:39], s66 offen lds
    v_mfma_f32_16x16x32_bf16 v[204:207], a[172:175], a[32:35], v[204:207]
    s_waitcnt vmcnt(16) lgkmcnt(4)
    s_add_u32 m0, s67, 8192
    s_add_u32 s66, s66, 55296
    v_mfma_f32_16x16x32_bf16 v[128:131], a[176:179], a[64:67], v[128:131]
    ds_read_b64_tr_b16 a[160:161], v11 offset:32768
    v_mfma_f32_16x16x32_bf16 v[144:147], a[176:179], a[68:71], v[144:147]
    v_mfma_f32_16x16x32_bf16 v[160:163], a[176:179], a[72:75], v[160:163]
    ds_read_b64_tr_b16 a[162:163], v11 offset:33280
    v_mfma_f32_16x16x32_bf16 v[176:179], a[176:179], a[76:79], v[176:179]
    buffer_load_dwordx4 a[136:139], v9, s[32:35], s64 offen offset:0 sc1
    v_mfma_f32_16x16x32_bf16 v[184:187], a[180:183], a[76:79], v[184:187]
    ds_read_b64_tr_b16 a[164:165], v11 offset:33792
    v_mfma_f32_16x16x32_bf16 v[168:171], a[180:183], a[72:75], v[168:171]
    v_mfma_f32_16x16x32_bf16 v[152:155], a[180:183], a[68:71], v[152:155]
    ds_read_b64_tr_b16 a[166:167], v11 offset:34304
    v_mfma_f32_16x16x32_bf16 v[136:139], a[180:183], a[64:67], v[136:139]
    s_waitcnt lgkmcnt(4)
    buffer_load_dwordx4 a[140:143], v9, s[32:35], s64 offen offset:256 sc1
    v_mfma_f32_16x16x32_bf16 v[192:195], a[184:187], a[48:51], v[192:195]
    ds_read_b64_tr_b16 a[168:169], v10 offset:40960
    v_mfma_f32_16x16x32_bf16 v[208:211], a[184:187], a[52:55], v[208:211]
    v_mfma_f32_16x16x32_bf16 v[224:227], a[184:187], a[56:59], v[224:227]
    ds_read_b64_tr_b16 a[170:171], v10 offset:41472
    v_mfma_f32_16x16x32_bf16 v[240:243], a[184:187], a[60:63], v[240:243]
    v_mfma_f32_16x16x32_bf16 v[248:251], a[188:191], a[60:63], v[248:251]
    ds_read_b64_tr_b16 a[172:173], v10 offset:41984
    buffer_load_dwordx4 v15, s[36:39], s66 offen lds
    v_mfma_f32_16x16x32_bf16 v[232:235], a[188:191], a[56:59], v[232:235]
    s_add_u32 m0, s67, 12288
    s_add_u32 s66, s66, 55296
    v_mfma_f32_16x16x32_bf16 v[216:219], a[188:191], a[52:55], v[216:219]
    ds_read_b64_tr_b16 a[174:175], v10 offset:42496
    v_mfma_f32_16x16x32_bf16 v[200:203], a[188:191], a[48:51], v[200:203]
    s_waitcnt lgkmcnt(4)
    v_mfma_f32_16x16x32_bf16 v[132:135], a[160:163], a[64:67], v[132:135]
    ds_read_b64_tr_b16 a[176:177], v13 offset:24576
    buffer_load_dwordx4 a[144:147], v14, s[32:35], s64 offen offset:2048 sc1
    v_mfma_f32_16x16x32_bf16 v[148:151], a[160:163], a[68:71], v[148:151]
    v_mfma_f32_16x16x32_bf16 v[164:167], a[160:163], a[72:75], v[164:167]
    ds_read_b64_tr_b16 a[178:179], v13 offset:25088
    v_mfma_f32_16x16x32_bf16 v[180:183], a[160:163], a[76:79], v[180:183]
    v_mfma_f32_16x16x32_bf16 v[188:191], a[164:167], a[76:79], v[188:191]
    ds_read_b64_tr_b16 a[180:181], v13 offset:25600
    v_mfma_f32_16x16x32_bf16 v[172:175], a[164:167], a[72:75], v[172:175]
    buffer_load_dwordx4 a[148:151], v14, s[32:35], s64 offen offset:2304 sc1
    v_mfma_f32_16x16x32_bf16 v[156:159], a[164:167], a[68:71], v[156:159]
    ds_read_b64_tr_b16 a[182:183], v13 offset:26112
    v_mfma_f32_16x16x32_bf16 v[140:143], a[164:167], a[64:67], v[140:143]
    s_waitcnt vmcnt(17) lgkmcnt(4)
    v_mfma_f32_16x16x32_bf16 v[128:131], a[168:171], a[80:83], v[128:131]
    ds_read_b64_tr_b16 a[184:185], v11 offset:40960
    v_mfma_f32_16x16x32_bf16 v[144:147], a[168:171], a[84:87], v[144:147]
    buffer_load_dwordx4 a[152:155], v9, s[32:35], s64 offen offset:2048 sc1
    v_mfma_f32_16x16x32_bf16 v[160:163], a[168:171], a[88:91], v[160:163]
    ds_read_b64_tr_b16 a[186:187], v11 offset:41472
    v_mfma_f32_16x16x32_bf16 v[176:179], a[168:171], a[92:95], v[176:179]
    v_mfma_f32_16x16x32_bf16 v[184:187], a[172:175], a[92:95], v[184:187]
    ds_read_b64_tr_b16 a[188:189], v11 offset:41984
    v_mfma_f32_16x16x32_bf16 v[168:171], a[172:175], a[88:91], v[168:171]
    v_mfma_f32_16x16x32_bf16 v[152:155], a[172:175], a[84:87], v[152:155]
    ds_read_b64_tr_b16 a[190:191], v11 offset:42496
    buffer_load_dwordx4 a[156:159], v9, s[32:35], s64 offen offset:2304 sc1
    v_mfma_f32_16x16x32_bf16 v[136:139], a[172:175], a[80:83], v[136:139]
    s_waitcnt lgkmcnt(4)
    v_mfma_f32_16x16x32_bf16 v[196:199], a[176:179], a[48:51], v[196:199]
    ds_read_b64_tr_b16 a[160:161], v12 offset:32768
    v_mfma_f32_16x16x32_bf16 v[212:215], a[176:179], a[52:55], v[212:215]
    v_mfma_f32_16x16x32_bf16 v[228:231], a[176:179], a[56:59], v[228:231]
    ds_read_b64_tr_b16 a[162:163], v12 offset:33280
    buffer_load_dwordx4 v15, s[36:39], s66 offen lds
    v_mfma_f32_16x16x32_bf16 v[244:247], a[176:179], a[60:63], v[244:247]
    s_mul_i32 s66, s28, 221184
    s_add_u32 s66, s66, s82
    s_add_u32 s66, s66, 1327104
    v_mfma_f32_16x16x32_bf16 v[252:255], a[180:183], a[60:63], v[252:255]
    ds_read_b64_tr_b16 a[164:165], v12 offset:33792
    s_mul_i32 s67, s28, 16384
    v_mfma_f32_16x16x32_bf16 v[236:239], a[180:183], a[56:59], v[236:239]
    s_add_u32 s67, s67, s79
    s_add_u32 m0, s67, 0
    v_mfma_f32_16x16x32_bf16 v[220:223], a[180:183], a[52:55], v[220:223]
    ds_read_b64_tr_b16 a[166:167], v12 offset:34304
    v_mfma_f32_16x16x32_bf16 v[204:207], a[180:183], a[48:51], v[204:207]
    s_waitcnt lgkmcnt(4)
    buffer_load_dwordx4 v15, s[36:39], s66 offen lds
    v_mfma_f32_16x16x32_bf16 v[132:135], a[184:187], a[80:83], v[132:135]
    ds_read_b64_tr_b16 a[168:169], v10 offset:49152
    s_add_u32 s65, s58, 20480
    v_mfma_f32_16x16x32_bf16 v[148:151], a[184:187], a[84:87], v[148:151]
    s_add_u32 m0, s67, 4096
    s_add_u32 s66, s66, 55296
    v_mfma_f32_16x16x32_bf16 v[164:167], a[184:187], a[88:91], v[164:167]
    ds_read_b64_tr_b16 a[170:171], v10 offset:49664
    v_mfma_f32_16x16x32_bf16 v[180:183], a[184:187], a[92:95], v[180:183]
    buffer_load_dwordx4 a[0:3], v14, s[32:35], s65 offen offset:0 sc1
    v_mfma_f32_16x16x32_bf16 v[188:191], a[188:191], a[92:95], v[188:191]
    ds_read_b64_tr_b16 a[172:173], v10 offset:50176
    v_mfma_f32_16x16x32_bf16 v[172:175], a[188:191], a[88:91], v[172:175]
    v_mfma_f32_16x16x32_bf16 v[156:159], a[188:191], a[84:87], v[156:159]
    ds_read_b64_tr_b16 a[174:175], v10 offset:50688
    v_mfma_f32_16x16x32_bf16 v[140:143], a[188:191], a[80:83], v[140:143]
    s_waitcnt lgkmcnt(4)
    v_mfma_f32_16x16x32_bf16 v[192:195], a[160:163], a[64:67], v[192:195]
    ds_read_b64_tr_b16 a[176:177], v11 offset:49152
    buffer_load_dwordx4 a[4:7], v14, s[32:35], s65 offen offset:256 sc1
    v_mfma_f32_16x16x32_bf16 v[208:211], a[160:163], a[68:71], v[208:211]
    v_mfma_f32_16x16x32_bf16 v[224:227], a[160:163], a[72:75], v[224:227]
    ds_read_b64_tr_b16 a[178:179], v11 offset:49664
    v_mfma_f32_16x16x32_bf16 v[240:243], a[160:163], a[76:79], v[240:243]
    v_mfma_f32_16x16x32_bf16 v[248:251], a[164:167], a[76:79], v[248:251]
    ds_read_b64_tr_b16 a[180:181], v11 offset:50176
    buffer_load_dwordx4 v15, s[36:39], s66 offen lds
    v_mfma_f32_16x16x32_bf16 v[232:235], a[164:167], a[72:75], v[232:235]
    s_add_u32 m0, s67, 8192
    s_add_u32 s66, s66, 55296
    v_mfma_f32_16x16x32_bf16 v[216:219], a[164:167], a[68:71], v[216:219]
    ds_read_b64_tr_b16 a[182:183], v11 offset:50688
    v_mfma_f32_16x16x32_bf16 v[200:203], a[164:167], a[64:67], v[200:203]
    s_waitcnt vmcnt(20) lgkmcnt(4)
    v_mfma_f32_16x16x32_bf16 v[128:131], a[168:171], a[96:99], v[128:131]
    ds_read_b64_tr_b16 a[184:185], v13 offset:32768
    v_mfma_f32_16x16x32_bf16 v[144:147], a[168:171], a[100:103], v[144:147]
    buffer_load_dwordx4 a[8:11], v9, s[32:35], s65 offen offset:0 sc1
    v_mfma_f32_16x16x32_bf16 v[160:163], a[168:171], a[104:107], v[160:163]
    ds_read_b64_tr_b16 a[186:187], v13 offset:33280
    v_mfma_f32_16x16x32_bf16 v[176:179], a[168:171], a[108:111], v[176:179]
    v_mfma_f32_16x16x32_bf16 v[184:187], a[172:175], a[108:111], v[184:187]
    ds_read_b64_tr_b16 a[188:189], v13 offset:33792
    v_mfma_f32_16x16x32_bf16 v[168:171], a[172:175], a[104:107], v[168:171]
    buffer_load_dwordx4 a[12:15], v9, s[32:35], s65 offen offset:256 sc1
    v_mfma_f32_16x16x32_bf16 v[152:155], a[172:175], a[100:103], v[152:155]
    ds_read_b64_tr_b16 a[190:191], v13 offset:34304
    v_mfma_f32_16x16x32_bf16 v[136:139], a[172:175], a[96:99], v[136:139]
    s_waitcnt lgkmcnt(4)
    v_mfma_f32_16x16x32_bf16 v[132:135], a[176:179], a[96:99], v[132:135]
    ds_read_b64_tr_b16 a[160:161], v10 offset:57344
    v_mfma_f32_16x16x32_bf16 v[148:151], a[176:179], a[100:103], v[148:151]
    v_mfma_f32_16x16x32_bf16 v[164:167], a[176:179], a[104:107], v[164:167]
    ds_read_b64_tr_b16 a[162:163], v10 offset:57856
    buffer_load_dwordx4 a[16:19], v14, s[32:35], s65 offen offset:2048 sc1
    v_mfma_f32_16x16x32_bf16 v[180:183], a[176:179], a[108:111], v[180:183]
    v_mfma_f32_16x16x32_bf16 v[188:191], a[180:183], a[108:111], v[188:191]
    ds_read_b64_tr_b16 a[164:165], v10 offset:58368
    v_mfma_f32_16x16x32_bf16 v[172:175], a[180:183], a[104:107], v[172:175]
    v_mfma_f32_16x16x32_bf16 v[156:159], a[180:183], a[100:103], v[156:159]
    ds_read_b64_tr_b16 a[166:167], v10 offset:58880
    buffer_load_dwordx4 a[20:23], v14, s[32:35], s65 offen offset:2304 sc1
    v_mfma_f32_16x16x32_bf16 v[140:143], a[180:183], a[96:99], v[140:143]
    s_waitcnt lgkmcnt(4)
    v_mfma_f32_16x16x32_bf16 v[196:199], a[184:187], a[64:67], v[196:199]
    ds_read_b64_tr_b16 a[168:169], v12 offset:40960
    v_mfma_f32_16x16x32_bf16 v[212:215], a[184:187], a[68:71], v[212:215]
    v_mfma_f32_16x16x32_bf16 v[228:231], a[184:187], a[72:75], v[228:231]
    ds_read_b64_tr_b16 a[170:171], v12 offset:41472
    v_mfma_f32_16x16x32_bf16 v[244:247], a[184:187], a[76:79], v[244:247]
    buffer_load_dwordx4 v15, s[36:39], s66 offen lds
    s_add_u32 m0, s67, 12288
    v_mfma_f32_16x16x32_bf16 v[252:255], a[188:191], a[76:79], v[252:255]
    ds_read_b64_tr_b16 a[172:173], v12 offset:41984
    s_add_u32 s66, s66, 55296
    v_mfma_f32_16x16x32_bf16 v[236:239], a[188:191], a[72:75], v[236:239]
    v_mfma_f32_16x16x32_bf16 v[220:223], a[188:191], a[68:71], v[220:223]
    ds_read_b64_tr_b16 a[174:175], v12 offset:42496
    v_mfma_f32_16x16x32_bf16 v[204:207], a[188:191], a[64:67], v[204:207]
    s_waitcnt vmcnt(21) lgkmcnt(4)
    buffer_load_dwordx4 v15, s[36:39], s66 offen lds
    v_mfma_f32_16x16x32_bf16 v[128:131], a[160:163], a[112:115], v[128:131]
    ds_read_b64_tr_b16 a[176:177], v11 offset:57344
    s_mul_i32 s66, s29, 221184
    v_mfma_f32_16x16x32_bf16 v[144:147], a[160:163], a[116:119], v[144:147]
    s_add_u32 s66, s66, s82
    s_add_u32 s66, s66, 1327104
    s_mul_i32 s67, s29, 16384
    v_mfma_f32_16x16x32_bf16 v[160:163], a[160:163], a[120:123], v[160:163]
    ds_read_b64_tr_b16 a[178:179], v11 offset:57856
    s_add_u32 s67, s67, s79
    v_mfma_f32_16x16x32_bf16 v[176:179], a[160:163], a[124:127], v[176:179]
    s_add_u32 m0, s67, 0
    v_mfma_f32_16x16x32_bf16 v[184:187], a[164:167], a[124:127], v[184:187]
    ds_read_b64_tr_b16 a[180:181], v11 offset:58368
    buffer_load_dwordx4 a[24:27], v9, s[32:35], s65 offen offset:2048 sc1
    v_mfma_f32_16x16x32_bf16 v[168:171], a[164:167], a[120:123], v[168:171]
    v_mfma_f32_16x16x32_bf16 v[152:155], a[164:167], a[116:119], v[152:155]
    ds_read_b64_tr_b16 a[182:183], v11 offset:58880
    v_mfma_f32_16x16x32_bf16 v[136:139], a[164:167], a[112:115], v[136:139]
    s_waitcnt lgkmcnt(4)
    v_mfma_f32_16x16x32_bf16 v[192:195], a[168:171], a[80:83], v[192:195]
    v_add_u32 v10, 0x10000, v10
    ds_read_b64_tr_b16 a[184:185], v10 offset:0
    buffer_load_dwordx4 a[28:31], v9, s[32:35], s65 offen offset:2304 sc1
    v_mfma_f32_16x16x32_bf16 v[208:211], a[168:171], a[84:87], v[208:211]
    v_mfma_f32_16x16x32_bf16 v[224:227], a[168:171], a[88:91], v[224:227]
    ds_read_b64_tr_b16 a[186:187], v10 offset:512
    v_mfma_f32_16x16x32_bf16 v[240:243], a[168:171], a[92:95], v[240:243]
    v_mfma_f32_16x16x32_bf16 v[248:251], a[172:175], a[92:95], v[248:251]
    ds_read_b64_tr_b16 a[188:189], v10 offset:1024
    buffer_load_dwordx4 v15, s[36:39], s66 offen lds
    v_mfma_f32_16x16x32_bf16 v[232:235], a[172:175], a[88:91], v[232:235]
    s_add_u32 m0, s67, 4096
    s_add_u32 s66, s66, 55296
    v_mfma_f32_16x16x32_bf16 v[216:219], a[172:175], a[84:87], v[216:219]
    ds_read_b64_tr_b16 a[190:191], v10 offset:1536
    v_mfma_f32_16x16x32_bf16 v[200:203], a[172:175], a[80:83], v[200:203]
    s_waitcnt lgkmcnt(4)
    v_mfma_f32_16x16x32_bf16 v[132:135], a[176:179], a[112:115], v[132:135]
    ds_read_b64_tr_b16 a[160:161], v13 offset:40960
    buffer_load_dwordx4 v15, s[36:39], s66 offen lds
    v_mfma_f32_16x16x32_bf16 v[148:151], a[176:179], a[116:119], v[148:151]
    s_add_u32 s64, s58, 24576
    s_add_u32 m0, s67, 8192
    s_add_u32 s66, s66, 55296
    v_mfma_f32_16x16x32_bf16 v[164:167], a[176:179], a[120:123], v[164:167]
    ds_read_b64_tr_b16 a[162:163], v13 offset:41472
    v_mfma_f32_16x16x32_bf16 v[180:183], a[176:179], a[124:127], v[180:183]
    v_mfma_f32_16x16x32_bf16 v[188:191], a[180:183], a[124:127], v[188:191]
    ds_read_b64_tr_b16 a[164:165], v13 offset:41984
    v_mfma_f32_16x16x32_bf16 v[172:175], a[180:183], a[120:123], v[172:175]
    buffer_load_dwordx4 a[32:35], v14, s[32:35], s64 offen offset:0 sc1
    v_mfma_f32_16x16x32_bf16 v[156:159], a[180:183], a[116:119], v[156:159]
    ds_read_b64_tr_b16 a[166:167], v13 offset:42496
    v_mfma_f32_16x16x32_bf16 v[140:143], a[180:183], a[112:115], v[140:143]
    s_waitcnt vmcnt(21) lgkmcnt(4)
    v_mfma_f32_16x16x32_bf16 v[128:131], a[184:187], a[128:131], v[128:131]
    v_add_u32 v11, 0x10000, v11
    ds_read_b64_tr_b16 a[168:169], v11 offset:0
    v_mfma_f32_16x16x32_bf16 v[144:147], a[184:187], a[132:135], v[144:147]
    buffer_load_dwordx4 a[36:39], v14, s[32:35], s64 offen offset:256 sc1
    v_mfma_f32_16x16x32_bf16 v[160:163], a[184:187], a[136:139], v[160:163]
    ds_read_b64_tr_b16 a[170:171], v11 offset:512
    v_mfma_f32_16x16x32_bf16 v[176:179], a[184:187], a[140:143], v[176:179]
    v_mfma_f32_16x16x32_bf16 v[184:187], a[188:191], a[140:143], v[184:187]
    ds_read_b64_tr_b16 a[172:173], v11 offset:1024
    v_mfma_f32_16x16x32_bf16 v[168:171], a[188:191], a[136:139], v[168:171]
    buffer_load_dwordx4 a[40:43], v9, s[32:35], s64 offen offset:0 sc1
    v_mfma_f32_16x16x32_bf16 v[152:155], a[188:191], a[132:135], v[152:155]
    ds_read_b64_tr_b16 a[174:175], v11 offset:1536
    v_mfma_f32_16x16x32_bf16 v[136:139], a[188:191], a[128:131], v[136:139]
    s_waitcnt lgkmcnt(4)
    v_mfma_f32_16x16x32_bf16 v[196:199], a[160:163], a[80:83], v[196:199]
    ds_read_b64_tr_b16 a[176:177], v12 offset:49152
    v_mfma_f32_16x16x32_bf16 v[212:215], a[160:163], a[84:87], v[212:215]
    v_mfma_f32_16x16x32_bf16 v[228:231], a[160:163], a[88:91], v[228:231]
    ds_read_b64_tr_b16 a[178:179], v12 offset:49664
    buffer_load_dwordx4 a[44:47], v9, s[32:35], s64 offen offset:256 sc1
    v_mfma_f32_16x16x32_bf16 v[244:247], a[160:163], a[92:95], v[244:247]
    v_mfma_f32_16x16x32_bf16 v[252:255], a[164:167], a[92:95], v[252:255]
    ds_read_b64_tr_b16 a[180:181], v12 offset:50176
    v_mfma_f32_16x16x32_bf16 v[236:239], a[164:167], a[88:91], v[236:239]
    v_mfma_f32_16x16x32_bf16 v[220:223], a[164:167], a[84:87], v[220:223]
    ds_read_b64_tr_b16 a[182:183], v12 offset:50688
    buffer_load_dwordx4 v15, s[36:39], s66 offen lds
    v_mfma_f32_16x16x32_bf16 v[204:207], a[164:167], a[80:83], v[204:207]
    s_waitcnt lgkmcnt(4)
    s_add_u32 m0, s67, 12288
    s_add_u32 s66, s66, 55296
    v_mfma_f32_16x16x32_bf16 v[132:135], a[168:171], a[128:131], v[132:135]
    ds_read_b64_tr_b16 a[184:185], v10 offset:8192
    v_mfma_f32_16x16x32_bf16 v[148:151], a[168:171], a[132:135], v[148:151]
    v_mfma_f32_16x16x32_bf16 v[164:167], a[168:171], a[136:139], v[164:167]
    ds_read_b64_tr_b16 a[186:187], v10 offset:8704
    v_mfma_f32_16x16x32_bf16 v[180:183], a[168:171], a[140:143], v[180:183]
    buffer_load_dwordx4 a[48:51], v14, s[32:35], s64 offen offset:2048 sc1
    v_mfma_f32_16x16x32_bf16 v[188:191], a[172:175], a[140:143], v[188:191]
    ds_read_b64_tr_b16 a[188:189], v10 offset:9216
    v_mfma_f32_16x16x32_bf16 v[172:175], a[172:175], a[136:139], v[172:175]
    v_mfma_f32_16x16x32_bf16 v[156:159], a[172:175], a[132:135], v[156:159]
    ds_read_b64_tr_b16 a[190:191], v10 offset:9728
    v_mfma_f32_16x16x32_bf16 v[140:143], a[172:175], a[128:131], v[140:143]
    s_waitcnt lgkmcnt(4)
    buffer_load_dwordx4 a[52:55], v14, s[32:35], s64 offen offset:2304 sc1
    v_mfma_f32_16x16x32_bf16 v[192:195], a[176:179], a[96:99], v[192:195]
    ds_read_b64_tr_b16 a[160:161], v11 offset:8192
    v_mfma_f32_16x16x32_bf16 v[208:211], a[176:179], a[100:103], v[208:211]
    v_mfma_f32_16x16x32_bf16 v[224:227], a[176:179], a[104:107], v[224:227]
    ds_read_b64_tr_b16 a[162:163], v11 offset:8704
    v_mfma_f32_16x16x32_bf16 v[240:243], a[176:179], a[108:111], v[240:243]
    v_mfma_f32_16x16x32_bf16 v[248:251], a[180:183], a[108:111], v[248:251]
    ds_read_b64_tr_b16 a[164:165], v11 offset:9216
    buffer_load_dwordx4 v15, s[36:39], s66 offen lds
    v_mfma_f32_16x16x32_bf16 v[232:235], a[180:183], a[104:107], v[232:235]
    v_mfma_f32_16x16x32_bf16 v[216:219], a[180:183], a[100:103], v[216:219]
    ds_read_b64_tr_b16 a[166:167], v11 offset:9728
    v_mfma_f32_16x16x32_bf16 v[200:203], a[180:183], a[96:99], v[200:203]
    s_waitcnt vmcnt(23) lgkmcnt(4)
    v_mfma_f32_16x16x32_bf16 v[128:131], a[184:187], a[144:147], v[128:131]
    ds_read_b64_tr_b16 a[168:169], v13 offset:49152
    buffer_load_dwordx4 a[56:59], v9, s[32:35], s64 offen offset:2048 sc1
    v_mfma_f32_16x16x32_bf16 v[144:147], a[184:187], a[148:151], v[144:147]
    v_mfma_f32_16x16x32_bf16 v[160:163], a[184:187], a[152:155], v[160:163]
    ds_read_b64_tr_b16 a[170:171], v13 offset:49664
    v_mfma_f32_16x16x32_bf16 v[176:179], a[184:187], a[156:159], v[176:179]
    v_mfma_f32_16x16x32_bf16 v[184:187], a[188:191], a[156:159], v[184:187]
    ds_read_b64_tr_b16 a[172:173], v13 offset:50176
    v_mfma_f32_16x16x32_bf16 v[168:171], a[188:191], a[152:155], v[168:171]
    buffer_load_dwordx4 a[60:63], v9, s[32:35], s64 offen offset:2304 sc1
    v_mfma_f32_16x16x32_bf16 v[152:155], a[188:191], a[148:151], v[152:155]
    ds_read_b64_tr_b16 a[174:175], v13 offset:50688
    v_mfma_f32_16x16x32_bf16 v[136:139], a[188:191], a[144:147], v[136:139]
    s_waitcnt lgkmcnt(4)
    v_mfma_f32_16x16x32_bf16 v[132:135], a[160:163], a[144:147], v[132:135]
    ds_read_b64_tr_b16 a[176:177], v10 offset:16384
    s_add_u32 s65, s58, 28672
    v_mfma_f32_16x16x32_bf16 v[148:151], a[160:163], a[148:151], v[148:151]
    buffer_load_dwordx4 a[64:67], v14, s[32:35], s65 offen offset:0 sc1
    v_mfma_f32_16x16x32_bf16 v[164:167], a[160:163], a[152:155], v[164:167]
    ds_read_b64_tr_b16 a[178:179], v10 offset:16896
    v_mfma_f32_16x16x32_bf16 v[180:183], a[160:163], a[156:159], v[180:183]
    v_mfma_f32_16x16x32_bf16 v[188:191], a[164:167], a[156:159], v[188:191]
    ds_read_b64_tr_b16 a[180:181], v10 offset:17408
    v_mfma_f32_16x16x32_bf16 v[172:175], a[164:167], a[152:155], v[172:175]
    v_mfma_f32_16x16x32_bf16 v[156:159], a[164:167], a[148:151], v[156:159]
    ds_read_b64_tr_b16 a[182:183], v10 offset:17920
    buffer_load_dwordx4 a[68:71], v14, s[32:35], s65 offen offset:256 sc1
    v_mfma_f32_16x16x32_bf16 v[140:143], a[164:167], a[144:147], v[140:143]
    s_waitcnt lgkmcnt(4)
    v_mfma_f32_16x16x32_bf16 v[196:199], a[168:171], a[96:99], v[196:199]
    ds_read_b64_tr_b16 a[184:185], v12 offset:57344
    v_mfma_f32_16x16x32_bf16 v[212:215], a[168:171], a[100:103], v[212:215]
    v_mfma_f32_16x16x32_bf16 v[228:231], a[168:171], a[104:107], v[228:231]
    ds_read_b64_tr_b16 a[186:187], v12 offset:57856
    buffer_load_dwordx4 v[56:59], v29, s[32:35], s69 offen sc1
    v_mfma_f32_16x16x32_bf16 v[244:247], a[168:171], a[108:111], v[244:247]
    s_add_u32 s69, s69, 81920
    v_mfma_f32_16x16x32_bf16 v[252:255], a[172:175], a[108:111], v[252:255]
    ds_read_b64_tr_b16 a[188:189], v12 offset:58368
    v_mfma_f32_16x16x32_bf16 v[236:239], a[172:175], a[104:107], v[236:239]
    v_mfma_f32_16x16x32_bf16 v[220:223], a[172:175], a[100:103], v[220:223]
    ds_read_b64_tr_b16 a[190:191], v12 offset:58880
    v_mfma_f32_16x16x32_bf16 v[204:207], a[172:175], a[96:99], v[204:207]
    s_waitcnt vmcnt(21) lgkmcnt(4)
    buffer_load_dwordx4 v[60:63], v29, s[32:35], s69 offen sc1
    v_mfma_f32_16x16x32_bf16 v[128:131], a[176:179], a[0:3], v[128:131]
    ds_read_b64_tr_b16 a[160:161], v11 offset:16384
    s_add_u32 s69, s69, 81920
    v_mfma_f32_16x16x32_bf16 v[144:147], a[176:179], a[4:7], v[144:147]
    v_mfma_f32_16x16x32_bf16 v[160:163], a[176:179], a[8:11], v[160:163]
    ds_read_b64_tr_b16 a[162:163], v11 offset:16896
    v_mfma_f32_16x16x32_bf16 v[176:179], a[176:179], a[12:15], v[176:179]
    buffer_load_dwordx4 a[72:75], v9, s[32:35], s65 offen offset:0 sc1
    v_mfma_f32_16x16x32_bf16 v[184:187], a[180:183], a[12:15], v[184:187]
    ds_read_b64_tr_b16 a[164:165], v11 offset:17408
    v_mfma_f32_16x16x32_bf16 v[168:171], a[180:183], a[8:11], v[168:171]
    v_mfma_f32_16x16x32_bf16 v[152:155], a[180:183], a[4:7], v[152:155]
    ds_read_b64_tr_b16 a[166:167], v11 offset:17920
    v_mfma_f32_16x16x32_bf16 v[136:139], a[180:183], a[0:3], v[136:139]
    s_waitcnt lgkmcnt(4)
    v_mfma_f32_16x16x32_bf16 v[192:195], a[184:187], a[112:115], v[192:195]
    ds_read_b64_tr_b16 a[168:169], v10 offset:24576
    buffer_load_dwordx4 a[76:79], v9, s[32:35], s65 offen offset:256 sc1
    v_mfma_f32_16x16x32_bf16 v[208:211], a[184:187], a[116:119], v[208:211]
    v_mfma_f32_16x16x32_bf16 v[224:227], a[184:187], a[120:123], v[224:227]
    ds_read_b64_tr_b16 a[170:171], v10 offset:25088
    v_mfma_f32_16x16x32_bf16 v[240:243], a[184:187], a[124:127], v[240:243]
    v_mfma_f32_16x16x32_bf16 v[248:251], a[188:191], a[124:127], v[248:251]
    ds_read_b64_tr_b16 a[172:173], v10 offset:25600
    buffer_load_dwordx4 v[64:67], v29, s[32:35], s69 offen sc1
    v_mfma_f32_16x16x32_bf16 v[232:235], a[188:191], a[120:123], v[232:235]
    s_add_u32 s69, s69, 81920
    v_mfma_f32_16x16x32_bf16 v[216:219], a[188:191], a[116:119], v[216:219]
    ds_read_b64_tr_b16 a[174:175], v10 offset:26112
    v_mfma_f32_16x16x32_bf16 v[200:203], a[188:191], a[112:115], v[200:203]
    s_waitcnt lgkmcnt(4)
    v_mfma_f32_16x16x32_bf16 v[132:135], a[160:163], a[0:3], v[132:135]
    ds_read_b64_tr_b16 a[176:177], v13 offset:57344
    v_mfma_f32_16x16x32_bf16 v[148:151], a[160:163], a[4:7], v[148:151]
    buffer_load_dwordx4 a[80:83], v14, s[32:35], s65 offen offset:2048 sc1
    v_mfma_f32_16x16x32_bf16 v[164:167], a[160:163], a[8:11], v[164:167]
    ds_read_b64_tr_b16 a[178:179], v13 offset:57856
    v_mfma_f32_16x16x32_bf16 v[180:183], a[160:163], a[12:15], v[180:183]
    v_mfma_f32_16x16x32_bf16 v[188:191], a[164:167], a[12:15], v[188:191]
    ds_read_b64_tr_b16 a[180:181], v13 offset:58368
    v_mfma_f32_16x16x32_bf16 v[172:175], a[164:167], a[8:11], v[172:175]
    buffer_load_dwordx4 a[84:87], v14, s[32:35], s65 offen offset:2304 sc1
    v_mfma_f32_16x16x32_bf16 v[156:159], a[164:167], a[4:7], v[156:159]
    ds_read_b64_tr_b16 a[182:183], v13 offset:58880
    v_mfma_f32_16x16x32_bf16 v[140:143], a[164:167], a[0:3], v[140:143]
    s_waitcnt vmcnt(21) lgkmcnt(4)
    v_mfma_f32_16x16x32_bf16 v[128:131], a[168:171], a[16:19], v[128:131]
    ds_read_b64_tr_b16 a[184:185], v11 offset:24576
    v_mfma_f32_16x16x32_bf16 v[144:147], a[168:171], a[20:23], v[144:147]
    v_mfma_f32_16x16x32_bf16 v[160:163], a[168:171], a[24:27], v[160:163]
    ds_read_b64_tr_b16 a[186:187], v11 offset:25088
    buffer_load_dwordx4 a[88:91], v9, s[32:35], s65 offen offset:2048 sc1
    v_mfma_f32_16x16x32_bf16 v[176:179], a[168:171], a[28:31], v[176:179]
    v_mfma_f32_16x16x32_bf16 v[184:187], a[172:175], a[28:31], v[184:187]
    ds_read_b64_tr_b16 a[188:189], v11 offset:25600
    s_lshl_b32 s68, s51, 10
    v_mfma_f32_16x16x32_bf16 v[168:171], a[172:175], a[24:27], v[168:171]
    s_add_u32 s68, s68, 32768
    v_min_u32 v28, 53, v1
    v_lshlrev_b32 v28, 4, v28
    v_mfma_f32_16x16x32_bf16 v[152:155], a[172:175], a[20:23], v[152:155]
    ds_read_b64_tr_b16 a[190:191], v11 offset:26112
    buffer_load_dwordx4 a[92:95], v9, s[32:35], s65 offen offset:2304 sc1
    v_mfma_f32_16x16x32_bf16 v[136:139], a[172:175], a[16:19], v[136:139]
    s_waitcnt lgkmcnt(4)
    buffer_load_dword v24, v28, s[32:35], s68 offen sc1
    v_mfma_f32_16x16x32_bf16 v[196:199], a[176:179], a[112:115], v[196:199]
    v_add_u32 v12, 0x10000, v12
    ds_read_b64_tr_b16 a[160:161], v12 offset:0
    v_mfma_f32_16x16x32_bf16 v[212:215], a[176:179], a[116:119], v[212:215]
    v_mfma_f32_16x16x32_bf16 v[228:231], a[176:179], a[120:123], v[228:231]
    ds_read_b64_tr_b16 a[162:163], v12 offset:512
    v_mfma_f32_16x16x32_bf16 v[244:247], a[176:179], a[124:127], v[244:247]
    v_mfma_f32_16x16x32_bf16 v[252:255], a[180:183], a[124:127], v[252:255]
    ds_read_b64_tr_b16 a[164:165], v12 offset:1024
    buffer_load_dwordx4 v[68:71], v29, s[32:35], s69 offen sc1
    v_mfma_f32_16x16x32_bf16 v[236:239], a[180:183], a[120:123], v[236:239]
    s_add_u32 s69, s69, 81920
    v_mfma_f32_16x16x32_bf16 v[220:223], a[180:183], a[116:119], v[220:223]
    ds_read_b64_tr_b16 a[166:167], v12 offset:1536
    v_mfma_f32_16x16x32_bf16 v[204:207], a[180:183], a[112:115], v[204:207]
    s_waitcnt lgkmcnt(4)
    v_mfma_f32_16x16x32_bf16 v[132:135], a[184:187], a[16:19], v[132:135]
    s_waitcnt vmcnt(15)
    s_barrier
    v_add_u32 v10, 0xfffe0000, v10
    ds_read_b64_tr_b16 a[168:169], v10 offset:0
    v_mfma_f32_16x16x32_bf16 v[148:151], a[184:187], a[20:23], v[148:151]
    buffer_load_dwordx4 v[72:75], v29, s[32:35], s69 offen sc1
    s_add_u32 s64, s58, 32768
    v_mfma_f32_16x16x32_bf16 v[164:167], a[184:187], a[24:27], v[164:167]
    ds_read_b64_tr_b16 a[170:171], v10 offset:512
    s_add_u32 s69, s69, 81920
    v_mfma_f32_16x16x32_bf16 v[180:183], a[184:187], a[28:31], v[180:183]
    s_or_b32 s77, s2, s3
    s_cselect_b32 s77, 134217728, 0
    s_mov_b64 exec, 1
    buffer_store_dword v25, off, s[32:35], s77 sc1
    s_mov_b64 exec, -1
    v_mfma_f32_16x16x32_bf16 v[188:191], a[188:191], a[28:31], v[188:191]
    ds_read_b64_tr_b16 a[172:173], v10 offset:1024
    s_lshl_b32 s73, s50, 2
    v_mfma_f32_16x16x32_bf16 v[172:175], a[188:191], a[24:27], v[172:175]
    s_add_u32 s73, s73, s3
    s_mul_i32 s73, s73, 20480
    s_mul_i32 s74, s51, 160
    v_mfma_f32_16x16x32_bf16 v[156:159], a[188:191], a[20:23], v[156:159]
    ds_read_b64_tr_b16 a[174:175], v10 offset:1536
    buffer_load_dwordx4 a[96:99], v14, s[32:35], s64 offen offset:0 sc1
    v_mfma_f32_16x16x32_bf16 v[140:143], a[188:191], a[16:19], v[140:143]
    s_waitcnt lgkmcnt(4)
    s_add_u32 s73, s73, s74
    s_lshl_b32 s74, s3, 12
    v_mfma_f32_16x16x32_bf16 v[192:195], a[160:163], a[128:131], v[192:195]
    s_add_u32 s74, s74, 94208
    v_add_u32 v11, 0xfffe0000, v11
    ds_read_b64_tr_b16 a[176:177], v11 offset:0
    v_mfma_f32_16x16x32_bf16 v[208:211], a[160:163], a[132:135], v[208:211]
    v_add_u32 v2, 0, v1
    v_min_u32 v2, 159, v2
    v_mfma_f32_16x16x32_bf16 v[224:227], a[160:163], a[136:139], v[224:227]
    ds_read_b64_tr_b16 a[178:179], v11 offset:512
    buffer_load_dwordx4 a[100:103], v14, s[32:35], s64 offen offset:256 sc1
    v_mfma_f32_16x16x32_bf16 v[240:243], a[160:163], a[140:143], v[240:243]
    v_mul_u32_u24 v5, 6554, v2
    v_lshrrev_b32 v5, 16, v5
    v_mfma_f32_16x16x32_bf16 v[248:251], a[164:167], a[140:143], v[248:251]
    ds_read_b64_tr_b16 a[180:181], v11 offset:1024
    v_add_lshl_u32 v2, v2, v5, 4
    v_mfma_f32_16x16x32_bf16 v[232:235], a[164:167], a[136:139], v[232:235]
    v_mul_u32_u24 v30, 1104, v5
    v_add_u32 v5, s74, v2
    v_mfma_f32_16x16x32_bf16 v[216:219], a[164:167], a[132:135], v[216:219]
    ds_read_b64_tr_b16 a[182:183], v11 offset:1536
    buffer_load_dwordx4 v[76:79], v29, s[32:35], s69 offen sc1
    v_mfma_f32_16x16x32_bf16 v[200:203], a[164:167], a[128:131], v[200:203]
    s_waitcnt lgkmcnt(4)
    v_add3_u32 v2, v2, v30, s73
    s_add_u32 s69, s69, 81920
    v_mfma_f32_16x16x32_bf16 v[128:131], a[168:171], a[32:35], v[128:131]
    v_add_u32 v13, 0x10000, v13
    ds_read_b64_tr_b16 a[184:185], v13 offset:0
    v_mfma_f32_16x16x32_bf16 v[144:147], a[168:171], a[36:39], v[144:147]
    v_add_u32 v3, 64, v1
    v_min_u32 v3, 159, v3
    v_mfma_f32_16x16x32_bf16 v[160:163], a[168:171], a[40:43], v[160:163]
    ds_read_b64_tr_b16 a[186:187], v13 offset:512
    buffer_load_dwordx4 a[104:107], v9, s[32:35], s64 offen offset:0 sc1
    v_mfma_f32_16x16x32_bf16 v[176:179], a[168:171], a[44:47], v[176:179]
    v_mul_u32_u24 v6, 6554, v3
    v_lshrrev_b32 v6, 16, v6
    v_mfma_f32_16x16x32_bf16 v[184:187], a[172:175], a[44:47], v[184:187]
    ds_read_b64_tr_b16 a[188:189], v13 offset:1024
    v_add_lshl_u32 v3, v3, v6, 4
    v_mfma_f32_16x16x32_bf16 v[168:171], a[172:175], a[40:43], v[168:171]
    v_mul_u32_u24 v30, 1104, v6
    v_add_u32 v6, s74, v3
    v_mfma_f32_16x16x32_bf16 v[152:155], a[172:175], a[36:39], v[152:155]
    ds_read_b64_tr_b16 a[190:191], v13 offset:1536
    v_add3_u32 v3, v3, v30, s73
    v_mfma_f32_16x16x32_bf16 v[136:139], a[172:175], a[32:35], v[136:139]
    s_waitcnt lgkmcnt(4)
    buffer_load_dwordx4 a[108:111], v9, s[32:35], s64 offen offset:256 sc1
    v_mfma_f32_16x16x32_bf16 v[132:135], a[176:179], a[32:35], v[132:135]
    ds_read_b64_tr_b16 a[160:161], v10 offset:8192
    v_add_u32 v4, 128, v1
    v_mfma_f32_16x16x32_bf16 v[148:151], a[176:179], a[36:39], v[148:151]
    v_min_u32 v4, 159, v4
    v_mul_u32_u24 v7, 6554, v4
    v_mfma_f32_16x16x32_bf16 v[164:167], a[176:179], a[40:43], v[164:167]
    ds_read_b64_tr_b16 a[162:163], v10 offset:8704
    v_lshrrev_b32 v7, 16, v7
    v_mfma_f32_16x16x32_bf16 v[180:183], a[176:179], a[44:47], v[180:183]
    buffer_load_dwordx4 a[112:115], v14, s[32:35], s64 offen offset:2048 sc1
    v_add_lshl_u32 v4, v4, v7, 4
    v_mfma_f32_16x16x32_bf16 v[188:191], a[180:183], a[44:47], v[188:191]
    ds_read_b64_tr_b16 a[164:165], v10 offset:9216
    v_mul_u32_u24 v30, 1104, v7
    v_mfma_f32_16x16x32_bf16 v[172:175], a[180:183], a[40:43], v[172:175]
    v_add_u32 v7, s74, v4
    v_add3_u32 v4, v4, v30, s73
    v_mfma_f32_16x16x32_bf16 v[156:159], a[180:183], a[36:39], v[156:159]
    ds_read_b64_tr_b16 a[166:167], v10 offset:9728
    v_mfma_f32_16x16x32_bf16 v[140:143], a[180:183], a[32:35], v[140:143]
    s_waitcnt lgkmcnt(4)
    v_mfma_f32_16x16x32_bf16 v[196:199], a[184:187], a[128:131], v[196:199]
    ds_read_b64_tr_b16 a[168:169], v12 offset:8192
    buffer_load_dwordx4 a[116:119], v14, s[32:35], s64 offen offset:2304 sc1
    v_mfma_f32_16x16x32_bf16 v[212:215], a[184:187], a[132:135], v[212:215]
    ds_write_b128 v5, v[100:103]
    v_mfma_f32_16x16x32_bf16 v[228:231], a[184:187], a[136:139], v[228:231]
    ds_read_b64_tr_b16 a[170:171], v12 offset:8704
    v_mfma_f32_16x16x32_bf16 v[244:247], a[184:187], a[140:143], v[244:247]
    v_mfma_f32_16x16x32_bf16 v[252:255], a[188:191], a[140:143], v[252:255]
    ds_read_b64_tr_b16 a[172:173], v12 offset:9216
    buffer_load_dwordx4 v[80:83], v29, s[32:35], s69 offen sc1
    v_mfma_f32_16x16x32_bf16 v[236:239], a[188:191], a[136:139], v[236:239]
    ds_write_b128 v6, v[104:107]
    v_mfma_f32_16x16x32_bf16 v[220:223], a[188:191], a[132:135], v[220:223]
    ds_read_b64_tr_b16 a[174:175], v12 offset:9728
    s_add_u32 s69, s69, 81920
    v_mfma_f32_16x16x32_bf16 v[204:207], a[188:191], a[128:131], v[204:207]
    s_waitcnt vmcnt(23) lgkmcnt(6)
    v_mfma_f32_16x16x32_bf16 v[128:131], a[160:163], a[48:51], v[128:131]
    ds_read_b64_tr_b16 a[176:177], v11 offset:8192
    buffer_load_dwordx4 a[120:123], v9, s[32:35], s64 offen offset:2048 sc1
    v_mfma_f32_16x16x32_bf16 v[144:147], a[160:163], a[52:55], v[144:147]
    ds_write_b128 v7, v[108:111]
    v_mfma_f32_16x16x32_bf16 v[160:163], a[160:163], a[56:59], v[160:163]
    ds_read_b64_tr_b16 a[178:179], v11 offset:8704
    ds_read_b64 v[30:31], v26 offset:0
    v_mfma_f32_16x16x32_bf16 v[176:179], a[160:163], a[60:63], v[176:179]
    ds_read_b64 v[32:33], v26 offset:8
    ds_read_b64 v[34:35], v26 offset:16
    v_mfma_f32_16x16x32_bf16 v[184:187], a[164:167], a[60:63], v[184:187]
    ds_read_b64_tr_b16 a[180:181], v11 offset:9216
    buffer_load_dwordx4 a[124:127], v9, s[32:35], s64 offen offset:2304 sc1
    v_mfma_f32_16x16x32_bf16 v[168:171], a[164:167], a[56:59], v[168:171]
    ds_read_b64 v[36:37], v26 offset:24
    ds_read_b64 v[38:39], v26 offset:32
    v_mfma_f32_16x16x32_bf16 v[152:155], a[164:167], a[52:55], v[152:155]
    ds_read_b64_tr_b16 a[182:183], v11 offset:9728
    s_lshr_b32 s72, s3, 1
    v_mfma_f32_16x16x32_bf16 v[136:139], a[164:167], a[48:51], v[136:139]
    s_waitcnt lgkmcnt(10)
    s_mul_i32 s72, s72, 13312
    s_add_u32 s72, s72, 65536
    v_mfma_f32_16x16x32_bf16 v[192:195], a[168:171], a[144:147], v[192:195]
    ds_read_b64_tr_b16 a[184:185], v10 offset:16384
    buffer_load_dwordx4 v[84:87], v29, s[32:35], s69 offen sc1
    v_mfma_f32_16x16x32_bf16 v[208:211], a[168:171], a[148:151], v[208:211]
    s_and_b32 s73, s3, 1
    s_mul_i32 s73, s73, 4160
    s_add_u32 s73, s73, s72
    v_mfma_f32_16x16x32_bf16 v[224:227], a[168:171], a[152:155], v[224:227]
    ds_read_b64_tr_b16 a[186:187], v10 offset:16896
    v_mfma_f32_16x16x32_bf16 v[240:243], a[168:171], a[156:159], v[240:243]
    s_bitcmp1_b32 s3, 1
    s_cselect_b32 s74, 0, 16
    s_lshl_b32 s74, s49, s74
    s_and_b32 s74, s74, 0xffff0000
    v_mfma_f32_16x16x32_bf16 v[248:251], a[172:175], a[156:159], v[248:251]
    ds_read_b64_tr_b16 a[188:189], v10 offset:17408
    v_mfma_f32_16x16x32_bf16 v[232:235], a[172:175], a[152:155], v[232:235]
    s_mov_b64 exec, 1
    v_add_f32 v112, s74, v112
    s_mov_b64 exec, -1
    v_mfma_f32_16x16x32_bf16 v[216:219], a[172:175], a[148:151], v[216:219]
    ds_read_b64_tr_b16 a[190:191], v10 offset:17920
    v_sub_u32 v52, 1008, v8
    v_mfma_f32_16x16x32_bf16 v[200:203], a[172:175], a[144:147], v[200:203]
    s_waitcnt lgkmcnt(4)
    v_add_u32 v52, s73, v52
    v_min_u32 v53, 624, v8
    v_mfma_f32_16x16x32_bf16 v[132:135], a[176:179], a[48:51], v[132:135]
    ds_read_b64_tr_b16 a[160:161], v13 offset:8192
    s_add_u32 s65, s58, 36864
    v_mfma_f32_16x16x32_bf16 v[148:151], a[176:179], a[52:55], v[148:151]
    buffer_load_dwordx4 a[128:131], v14, s[32:35], s65 offen offset:0 sc1
    s_add_u32 s74, s72, 8160
    v_mfma_f32_16x16x32_bf16 v[164:167], a[176:179], a[56:59], v[164:167]
    ds_read_b64_tr_b16 a[162:163], v13 offset:8704
    v_add_u32 v53, s74, v53
    v_mfma_f32_16x16x32_bf16 v[180:183], a[176:179], a[60:63], v[180:183]
    v_mov_b32 v104, 0
    v_mov_b32 v105, 0
    v_mfma_f32_16x16x32_bf16 v[188:191], a[180:183], a[60:63], v[188:191]
    ds_read_b64_tr_b16 a[164:165], v13 offset:9216
    v_mov_b32 v106, 0
    v_mfma_f32_16x16x32_bf16 v[172:175], a[180:183], a[56:59], v[172:175]
    buffer_load_dwordx4 a[132:135], v14, s[32:35], s65 offen offset:256 sc1
    v_cvt_pk_bf16_f32 v108, v124, v125
    v_mfma_f32_16x16x32_bf16 v[156:159], a[180:183], a[52:55], v[156:159]
    ds_read_b64_tr_b16 a[166:167], v13 offset:9728
    v_lshl_add_u32 v109, v1, 1, s72
    v_mfma_f32_16x16x32_bf16 v[140:143], a[180:183], a[48:51], v[140:143]
    s_waitcnt vmcnt(22) lgkmcnt(4)
    s_waitcnt vmcnt(16)
    v_cmp_ne_u32 vcc, v25, v24
    s_cbranch_vccnz c3_slow
c3_ok:
    v_mfma_f32_16x16x32_bf16 v[128:131], a[184:187], a[64:67], v[128:131]
    ds_read_b64_tr_b16 a[168:169], v11 offset:16384
    s_add_u32 s66, s54, 81920
    v_mfma_f32_16x16x32_bf16 v[144:147], a[184:187], a[68:71], v[144:147]
    ds_write_b16 v109, v108 offset:128
    v_mfma_f32_16x16x32_bf16 v[160:163], a[184:187], a[72:75], v[160:163]
    ds_read_b64_tr_b16 a[170:171], v11 offset:16896
    buffer_load_dwordx4 a[136:139], v9, s[32:35], s65 offen offset:0 sc1
    v_mfma_f32_16x16x32_bf16 v[176:179], a[184:187], a[76:79], v[176:179]
    ds_write_b16_d16_hi v109, v108 offset:256
    v_mfma_f32_16x16x32_bf16 v[184:187], a[188:191], a[76:79], v[184:187]
    ds_read_b64_tr_b16 a[172:173], v11 offset:17408
    s_add_u32 s74, s72, 0xffffffe0
    v_mfma_f32_16x16x32_bf16 v[168:171], a[188:191], a[72:75], v[168:171]
    s_mov_b64 exec, 0x3ff
    v_add_u32 v53, s74, v8
    s_mov_b64 exec, -1
    v_mfma_f32_16x16x32_bf16 v[152:155], a[188:191], a[68:71], v[152:155]
    ds_read_b64_tr_b16 a[174:175], v11 offset:17920
    buffer_load_dwordx4 a[140:143], v9, s[32:35], s65 offen offset:256 sc1
    v_mfma_f32_16x16x32_bf16 v[136:139], a[188:191], a[64:67], v[136:139]
    s_waitcnt lgkmcnt(6)
    s_add_u32 s74, s73, 0x1000
    v_mfma_f32_16x16x32_bf16 v[196:199], a[160:163], a[144:147], v[196:199]
    ds_read_b64_tr_b16 a[176:177], v12 offset:16384
    v_mfma_f32_16x16x32_bf16 v[212:215], a[160:163], a[148:151], v[212:215]
    s_mov_b64 exec, 3
    v_add_u32 v53, s74, v8
    s_mov_b64 exec, -1
    v_mfma_f32_16x16x32_bf16 v[228:231], a[160:163], a[152:155], v[228:231]
    ds_read_b64_tr_b16 a[178:179], v12 offset:16896
    s_add_u32 s74, s73, 0x400
    v_mfma_f32_16x16x32_bf16 v[244:247], a[160:163], a[156:159], v[244:247]
    buffer_load_dwordx4 a[192:195], v8, s[32:35], s66 offen offset:0 sc1
    v_mfma_f32_16x16x32_bf16 v[252:255], a[164:167], a[156:159], v[252:255]
    ds_read_b64_tr_b16 a[180:181], v12 offset:17408
    v_mfma_f32_16x16x32_bf16 v[236:239], a[164:167], a[152:155], v[236:239]
    s_bfm_b64 exec, 4, 60
    v_add_u32 v53, s74, v8
    s_mov_b64 exec, -1
    v_mfma_f32_16x16x32_bf16 v[220:223], a[164:167], a[148:151], v[220:223]
    ds_read_b64_tr_b16 a[182:183], v12 offset:17920
    v_mfma_f32_16x16x32_bf16 v[204:207], a[164:167], a[144:147], v[204:207]
    s_waitcnt lgkmcnt(4)
    buffer_load_dwordx4 a[196:199], v8, s[32:35], s66 offen offset:1024 sc1
    v_mfma_f32_16x16x32_bf16 v[132:135], a[168:171], a[64:67], v[132:135]
    ds_read_b64_tr_b16 a[184:185], v10 offset:24576
    v_mfma_f32_16x16x32_bf16 v[148:151], a[168:171], a[68:71], v[148:151]
    s_bitcmp1_b32 s3, 0
    s_cselect_b64 s[74:75], -1, 0
    v_mfma_f32_16x16x32_bf16 v[164:167], a[168:171], a[72:75], v[164:167]
    ds_read_b64_tr_b16 a[186:187], v10 offset:25088
    v_mfma_f32_16x16x32_bf16 v[180:183], a[168:171], a[76:79], v[180:183]
    s_and_b64 exec, s[74:75], 1
    v_cvt_pk_bf16_f32 v104, v112, v105
    s_mov_b64 exec, -1
    v_mfma_f32_16x16x32_bf16 v[188:191], a[172:175], a[76:79], v[188:191]
    ds_read_b64_tr_b16 a[188:189], v10 offset:25600
    buffer_load_dwordx4 a[144:147], v14, s[32:35], s65 offen offset:2048 sc1
    v_mfma_f32_16x16x32_bf16 v[172:175], a[172:175], a[72:75], v[172:175]
    s_bfm_b64 exec, 1, 63
    v_cvt_pk_bf16_f32 v106, v123, v123
    s_mov_b64 exec, -1
    v_mfma_f32_16x16x32_bf16 v[156:159], a[172:175], a[68:71], v[156:159]
    ds_read_b64_tr_b16 a[190:191], v10 offset:26112
    v_mov_b32 v107, v106
    v_mfma_f32_16x16x32_bf16 v[140:143], a[172:175], a[64:67], v[140:143]
    s_waitcnt lgkmcnt(4)
    v_and_b32 v110, 0xffff0000, v106
    v_cndmask_b32 v105, v110, v105, s[74:75]
    v_mfma_f32_16x16x32_bf16 v[192:195], a[176:179], a[0:3], v[192:195]
    ds_read_b64_tr_b16 a[160:161], v11 offset:24576
    buffer_load_dwordx4 a[148:151], v14, s[32:35], s65 offen offset:2304 sc1
    v_mfma_f32_16x16x32_bf16 v[208:211], a[176:179], a[4:7], v[208:211]
    ds_write_b128 v53, v[104:107]
    v_mfma_f32_16x16x32_bf16 v[224:227], a[176:179], a[8:11], v[224:227]
    ds_read_b64_tr_b16 a[162:163], v11 offset:25088
    v_cvt_pk_bf16_f32 v96, v123, v123
    v_mfma_f32_16x16x32_bf16 v[240:243], a[176:179], a[12:15], v[240:243]
    v_cndmask_b32 v110, v122, v123, s[74:75]
    v_cvt_pk_bf16_f32 v97, v110, v122
    v_mfma_f32_16x16x32_bf16 v[248:251], a[180:183], a[12:15], v[248:251]
    ds_read_b64_tr_b16 a[164:165], v11 offset:25600
    buffer_load_dwordx4 a[200:203], v8, s[32:35], s66 offen offset:2048 sc1
    v_mfma_f32_16x16x32_bf16 v[232:235], a[180:183], a[8:11], v[232:235]
    v_cndmask_b32 v111, v121, v122, s[74:75]
    v_cvt_pk_bf16_f32 v98, v122, v111
    v_mfma_f32_16x16x32_bf16 v[216:219], a[180:183], a[4:7], v[216:219]
    ds_read_b64_tr_b16 a[166:167], v11 offset:26112
    v_cvt_pk_bf16_f32 v99, v121, v121
    v_mfma_f32_16x16x32_bf16 v[200:203], a[180:183], a[0:3], v[200:203]
    s_waitcnt lgkmcnt(5)
    v_mfma_f32_16x16x32_bf16 v[128:131], a[184:187], a[80:83], v[128:131]
    ds_read_b64_tr_b16 a[168:169], v13 offset:16384
    buffer_load_dwordx4 a[152:155], v9, s[32:35], s65 offen offset:2048 sc1
    v_mfma_f32_16x16x32_bf16 v[144:147], a[184:187], a[84:87], v[144:147]
    ds_write_b128 v52, v[96:99] offset:2048
    v_mfma_f32_16x16x32_bf16 v[160:163], a[184:187], a[88:91], v[160:163]
    ds_read_b64_tr_b16 a[170:171], v13 offset:16896
    v_cndmask_b32 v110, v119, v120, s[74:75]
    v_mfma_f32_16x16x32_bf16 v[176:179], a[184:187], a[92:95], v[176:179]
    v_cndmask_b32 v111, v118, v119, s[74:75]
    v_cvt_pk_bf16_f32 v100, v110, v111
    v_mfma_f32_16x16x32_bf16 v[184:187], a[188:191], a[92:95], v[184:187]
    ds_read_b64_tr_b16 a[172:173], v13 offset:17408
    buffer_load_dwordx4 a[156:159], v9, s[32:35], s65 offen offset:2304 sc1
    v_mfma_f32_16x16x32_bf16 v[168:171], a[188:191], a[88:91], v[168:171]
    v_cndmask_b32 v110, v117, v118, s[74:75]
    v_cndmask_b32 v111, v116, v117, s[74:75]
    v_mfma_f32_16x16x32_bf16 v[152:155], a[188:191], a[84:87], v[152:155]
    ds_read_b64_tr_b16 a[174:175], v13 offset:17920
    v_cvt_pk_bf16_f32 v101, v110, v111
    v_mfma_f32_16x16x32_bf16 v[136:139], a[188:191], a[80:83], v[136:139]
    s_waitcnt lgkmcnt(5)
    v_cndmask_b32 v110, v115, v116, s[74:75]
    v_cndmask_b32 v111, v114, v115, s[74:75]
    v_mfma_f32_16x16x32_bf16 v[132:135], a[160:163], a[80:83], v[132:135]
    ds_read_b64_tr_b16 a[176:177], v10 offset:32768
    buffer_load_dwordx4 a[204:207], v8, s[32:35], s66 offen offset:3072 sc1
    v_mfma_f32_16x16x32_bf16 v[148:151], a[160:163], a[84:87], v[148:151]
    s_add_u32 s66, s66, 4096
    v_cvt_pk_bf16_f32 v102, v110, v111
    v_cndmask_b32 v110, v113, v114, s[74:75]
    v_mfma_f32_16x16x32_bf16 v[164:167], a[160:163], a[88:91], v[164:167]
    ds_read_b64_tr_b16 a[178:179], v10 offset:33280
    v_cndmask_b32 v111, v112, v113, s[74:75]
    v_mfma_f32_16x16x32_bf16 v[180:183], a[160:163], a[92:95], v[180:183]
    v_cvt_pk_bf16_f32 v103, v110, v111
    v_mfma_f32_16x16x32_bf16 v[188:191], a[164:167], a[92:95], v[188:191]
    ds_read_b64_tr_b16 a[180:181], v10 offset:33792
    v_mfma_f32_16x16x32_bf16 v[172:175], a[164:167], a[88:91], v[172:175]
    buffer_load_dwordx4 a[208:211], v8, s[32:35], s66 offen offset:0 sc1
    s_add_u32 s66, s54, 122880
    v_mfma_f32_16x16x32_bf16 v[156:159], a[164:167], a[84:87], v[156:159]
    ds_read_b64_tr_b16 a[182:183], v10 offset:34304
    v_mfma_f32_16x16x32_bf16 v[140:143], a[164:167], a[80:83], v[140:143]
    s_waitcnt lgkmcnt(4)
    v_mfma_f32_16x16x32_bf16 v[196:199], a[168:171], a[0:3], v[196:199]
    ds_read_b64_tr_b16 a[184:185], v12 offset:24576
    v_mfma_f32_16x16x32_bf16 v[212:215], a[168:171], a[4:7], v[212:215]
    buffer_load_dwordx4 a[212:215], v8, s[32:35], s66 offen offset:0 sc1
    v_mfma_f32_16x16x32_bf16 v[228:231], a[168:171], a[8:11], v[228:231]
    ds_read_b64_tr_b16 a[186:187], v12 offset:25088
    ds_write_b128 v52, v[100:103] offset:3072
    v_mfma_f32_16x16x32_bf16 v[244:247], a[168:171], a[12:15], v[244:247]
    s_lshl_b32 s72, s3, 10
    s_add_u32 s72, s72, 65536
    v_lshl_add_u32 v52, v1, 1, s72
    v_mfma_f32_16x16x32_bf16 v[252:255], a[172:175], a[12:15], v[252:255]
    ds_read_b64_tr_b16 a[188:189], v12 offset:25600
    v_mfma_f32_16x16x32_bf16 v[236:239], a[172:175], a[8:11], v[236:239]
    buffer_load_dwordx4 a[216:219], v8, s[32:35], s66 offen offset:1024 sc1
    v_mfma_f32_16x16x32_bf16 v[220:223], a[172:175], a[4:7], v[220:223]
    ds_read_b64_tr_b16 a[190:191], v12 offset:26112
    v_mfma_f32_16x16x32_bf16 v[204:207], a[172:175], a[0:3], v[204:207]
    s_waitcnt vmcnt(21) lgkmcnt(5)
    v_mfma_f32_16x16x32_bf16 v[128:131], a[176:179], a[96:99], v[128:131]
    ds_read_b64_tr_b16 a[160:161], v11 offset:32768
    ds_write_b16 v52, v56 offset:8800
    v_mfma_f32_16x16x32_bf16 v[144:147], a[176:179], a[100:103], v[144:147]
    buffer_load_dwordx4 a[220:223], v8, s[32:35], s66 offen offset:2048 sc1
    v_mfma_f32_16x16x32_bf16 v[160:163], a[176:179], a[104:107], v[160:163]
    ds_read_b64_tr_b16 a[162:163], v11 offset:33280
    v_mfma_f32_16x16x32_bf16 v[176:179], a[176:179], a[108:111], v[176:179]
    ds_write_b16_d16_hi v52, v56 offset:22112
    v_mfma_f32_16x16x32_bf16 v[184:187], a[180:183], a[108:111], v[184:187]
    ds_read_b64_tr_b16 a[164:165], v11 offset:33792
    v_mfma_f32_16x16x32_bf16 v[168:171], a[180:183], a[104:107], v[168:171]
    buffer_load_dwordx4 a[224:227], v8, s[32:35], s66 offen offset:3072 sc1
    s_add_u32 s66, s66, 4096
    v_mfma_f32_16x16x32_bf16 v[152:155], a[180:183], a[100:103], v[152:155]
    ds_read_b64_tr_b16 a[166:167], v11 offset:34304
    v_mfma_f32_16x16x32_bf16 v[136:139], a[180:183], a[96:99], v[136:139]
    s_waitcnt lgkmcnt(6)
    ds_write_b16 v52, v60 offset:8928
    v_mfma_f32_16x16x32_bf16 v[192:195], a[184:187], a[16:19], v[192:195]
    ds_read_b64_tr_b16 a[168:169], v10 offset:40960
    v_mfma_f32_16x16x32_bf16 v[208:211], a[184:187], a[20:23], v[208:211]
    ds_write_b16_d16_hi v52, v60 offset:22240
    v_mfma_f32_16x16x32_bf16 v[224:227], a[184:187], a[24:27], v[224:227]
    ds_read_b64_tr_b16 a[170:171], v10 offset:41472
    buffer_load_dwordx4 a[228:231], v8, s[32:35], s66 offen offset:0 sc1
    v_mfma_f32_16x16x32_bf16 v[240:243], a[184:187], a[28:31], v[240:243]
    ds_write_b16 v52, v64 offset:9056
    v_mfma_f32_16x16x32_bf16 v[248:251], a[188:191], a[28:31], v[248:251]
    ds_read_b64_tr_b16 a[172:173], v10 offset:41984
    s_add_u32 s66, s54, 163840
    v_mfma_f32_16x16x32_bf16 v[232:235], a[188:191], a[24:27], v[232:235]
    ds_write_b16_d16_hi v52, v64 offset:22368
    v_mfma_f32_16x16x32_bf16 v[216:219], a[188:191], a[20:23], v[216:219]
    ds_read_b64_tr_b16 a[174:175], v10 offset:42496
    buffer_load_dwordx4 a[232:235], v8, s[32:35], s66 offen offset:0 sc1
    v_mfma_f32_16x16x32_bf16 v[200:203], a[188:191], a[16:19], v[200:203]
    s_waitcnt lgkmcnt(8)
    v_mfma_f32_16x16x32_bf16 v[132:135], a[160:163], a[96:99], v[132:135]
    ds_read_b64_tr_b16 a[176:177], v13 offset:24576
    v_mfma_f32_16x16x32_bf16 v[148:151], a[160:163], a[100:103], v[148:151]
    ds_write_b16 v52, v68 offset:9184
    v_mfma_f32_16x16x32_bf16 v[164:167], a[160:163], a[104:107], v[164:167]
    ds_read_b64_tr_b16 a[178:179], v13 offset:25088
    v_mfma_f32_16x16x32_bf16 v[180:183], a[160:163], a[108:111], v[180:183]
    buffer_load_dwordx4 a[236:239], v8, s[32:35], s66 offen offset:1024 sc1
    v_mfma_f32_16x16x32_bf16 v[188:191], a[164:167], a[108:111], v[188:191]
    ds_read_b64_tr_b16 a[180:181], v13 offset:25600
    v_mfma_f32_16x16x32_bf16 v[172:175], a[164:167], a[104:107], v[172:175]
    ds_write_b16_d16_hi v52, v68 offset:22496
    v_mfma_f32_16x16x32_bf16 v[156:159], a[164:167], a[100:103], v[156:159]
    ds_read_b64_tr_b16 a[182:183], v13 offset:26112
    v_mfma_f32_16x16x32_bf16 v[140:143], a[164:167], a[96:99], v[140:143]
    s_waitcnt vmcnt(21) lgkmcnt(6)
    buffer_load_dwordx4 a[240:243], v8, s[32:35], s66 offen offset:2048 sc1
    v_mfma_f32_16x16x32_bf16 v[128:131], a[168:171], a[112:115], v[128:131]
    ds_read_b64_tr_b16 a[184:185], v11 offset:40960
    v_mfma_f32_16x16x32_bf16 v[144:147], a[168:171], a[116:119], v[144:147]
    ds_write_b16 v52, v72 offset:9312
    v_mfma_f32_16x16x32_bf16 v[160:163], a[168:171], a[120:123], v[160:163]
    ds_read_b64_tr_b16 a[186:187], v11 offset:41472
    v_mfma_f32_16x16x32_bf16 v[176:179], a[168:171], a[124:127], v[176:179]
    ds_write_b16_d16_hi v52, v72 offset:22624
    v_mfma_f32_16x16x32_bf16 v[184:187], a[172:175], a[124:127], v[184:187]
    ds_read_b64_tr_b16 a[188:189], v11 offset:41984
    buffer_load_dwordx4 a[244:247], v8, s[32:35], s66 offen offset:3072 sc1
    v_mfma_f32_16x16x32_bf16 v[168:171], a[172:175], a[120:123], v[168:171]
    ds_write_b16 v52, v76 offset:9440
    v_mfma_f32_16x16x32_bf16 v[152:155], a[172:175], a[116:119], v[152:155]
    ds_read_b64_tr_b16 a[190:191], v11 offset:42496
    s_add_u32 s66, s66, 4096
    v_mfma_f32_16x16x32_bf16 v[136:139], a[172:175], a[112:115], v[136:139]
    s_waitcnt lgkmcnt(7)
    v_mfma_f32_16x16x32_bf16 v[196:199], a[176:179], a[16:19], v[196:199]
    v_add_u32 v12, 0xfffe0000, v12
    ds_read_b64_tr_b16 a[160:161], v12 offset:0
    v_mfma_f32_16x16x32_bf16 v[212:215], a[176:179], a[20:23], v[212:215]
    buffer_load_dwordx4 a[248:251], v8, s[32:35], s66 offen offset:0 sc1
    s_add_u32 s66, s54, 204800
    v_mfma_f32_16x16x32_bf16 v[228:231], a[176:179], a[24:27], v[228:231]
    ds_read_b64_tr_b16 a[162:163], v12 offset:512
    ds_write_b16_d16_hi v52, v76 offset:22752
    v_mfma_f32_16x16x32_bf16 v[244:247], a[176:179], a[28:31], v[244:247]
    ds_write_b16 v52, v80 offset:9568
    v_mfma_f32_16x16x32_bf16 v[252:255], a[180:183], a[28:31], v[252:255]
    ds_read_b64_tr_b16 a[164:165], v12 offset:1024
    v_mfma_f32_16x16x32_bf16 v[236:239], a[180:183], a[24:27], v[236:239]
    buffer_load_dwordx4 v[88:91], v8, s[32:35], s66 offen offset:0 sc1
    v_mfma_f32_16x16x32_bf16 v[220:223], a[180:183], a[20:23], v[220:223]
    ds_read_b64_tr_b16 a[166:167], v12 offset:1536
    v_mfma_f32_16x16x32_bf16 v[204:207], a[180:183], a[16:19], v[204:207]
    s_waitcnt lgkmcnt(6)
    ds_write_b16_d16_hi v52, v80 offset:22880
    v_mfma_f32_16x16x32_bf16 v[132:135], a[184:187], a[112:115], v[132:135]
    ds_read_b64_tr_b16 a[168:169], v10 offset:49152
    v_mfma_f32_16x16x32_bf16 v[148:151], a[184:187], a[116:119], v[148:151]
    buffer_load_dwordx4 v[92:95], v8, s[32:35], s66 offen offset:1024 sc1
    v_mfma_f32_16x16x32_bf16 v[164:167], a[184:187], a[120:123], v[164:167]
    ds_read_b64_tr_b16 a[170:171], v10 offset:49664
    v_mfma_f32_16x16x32_bf16 v[180:183], a[184:187], a[124:127], v[180:183]
    s_waitcnt vmcnt(25)
    ds_write_b16 v52, v84 offset:9696
    v_mfma_f32_16x16x32_bf16 v[188:191], a[188:191], a[124:127], v[188:191]
    ds_read_b64_tr_b16 a[172:173], v10 offset:50176
    v_mfma_f32_16x16x32_bf16 v[172:175], a[188:191], a[120:123], v[172:175]
    ds_write_b16_d16_hi v52, v84 offset:23008
    v_mfma_f32_16x16x32_bf16 v[156:159], a[188:191], a[116:119], v[156:159]
    ds_read_b64_tr_b16 a[174:175], v10 offset:50688
    buffer_load_dwordx4 v[96:99], v8, s[32:35], s66 offen offset:2048 sc1
    v_mfma_f32_16x16x32_bf16 v[140:143], a[188:191], a[112:115], v[140:143]
    s_waitcnt lgkmcnt(7)
    s_lshl_b32 s69, s44, 13
    s_lshl_b32 s72, s3, 11
    v_mfma_f32_16x16x32_bf16 v[192:195], a[160:163], a[32:35], v[192:195]
    ds_read_b64_tr_b16 a[176:177], v11 offset:49152
    s_add_u32 s69, s69, s72
    v_mfma_f32_16x16x32_bf16 v[208:211], a[160:163], a[36:39], v[208:211]
    s_add_u32 s69, s69, 4898816
    s_add_u32 s11, s69, 1024
    s_mul_i32 s10, s51, 327680
    v_mfma_f32_16x16x32_bf16 v[224:227], a[160:163], a[40:43], v[224:227]
    ds_read_b64_tr_b16 a[178:179], v11 offset:49664
    buffer_load_dwordx4 v[100:103], v8, s[32:35], s66 offen offset:3072 sc1
    v_mfma_f32_16x16x32_bf16 v[240:243], a[160:163], a[44:47], v[240:243]
    s_lshl2_add_u32 s72, s50, s3
    s_add_u32 s66, s66, 4096
    s_mul_i32 s72, s72, 64
    v_mfma_f32_16x16x32_bf16 v[248:251], a[164:167], a[44:47], v[248:251]
    ds_read_b64_tr_b16 a[180:181], v11 offset:50176
    s_add_u32 s10, s10, s72
    v_mfma_f32_16x16x32_bf16 v[232:235], a[164:167], a[40:43], v[232:235]
    s_add_u32 s10, s10, 4898816
    s_lshl3_add_u32 s12, s50, s3
    s_lshl_b32 s12, s12, 9
    v_mfma_f32_16x16x32_bf16 v[216:219], a[164:167], a[36:39], v[216:219]
    ds_read_b64_tr_b16 a[182:183], v11 offset:50688
    s_add_u32 s12, s12, 14614528
    v_mfma_f32_16x16x32_bf16 v[200:203], a[164:167], a[32:35], v[200:203]
    s_waitcnt vmcnt(23) lgkmcnt(4)
    buffer_load_dwordx4 v[104:107], v8, s[32:35], s66 offen offset:0 sc1
    v_mfma_f32_16x16x32_bf16 v[128:131], a[168:171], a[128:131], v[128:131]
    s_add_u32 s13, s12, 2048
    v_add_u32 v13, 0xfffe0000, v13
    ds_read_b64_tr_b16 a[184:185], v13 offset:0
    v_mfma_f32_16x16x32_bf16 v[144:147], a[168:171], a[132:135], v[144:147]
    s_and_b32 s14, s50, 24
    s_add_u32 s66, s54, 245760
    s_add_u32 s14, s14, s51
    v_mfma_f32_16x16x32_bf16 v[160:163], a[168:171], a[136:139], v[160:163]
    ds_read_b64_tr_b16 a[186:187], v13 offset:512
    s_lshl_b32 s14, s14, 11
    v_mfma_f32_16x16x32_bf16 v[176:179], a[168:171], a[140:143], v[176:179]
    s_add_u32 s14, s14, 14745600
    s_or_b32 s66, s66, s56
    v_mfma_f32_16x16x32_bf16 v[184:187], a[172:175], a[140:143], v[184:187]
    ds_read_b64_tr_b16 a[188:189], v13 offset:1024
    buffer_load_dwordx4 v[108:111], v8, s[32:35], s66 offen offset:0 sc1
    v_mfma_f32_16x16x32_bf16 v[168:171], a[172:175], a[136:139], v[168:171]
    s_cmp_eq_u32 s3, 3
    s_cselect_b32 s70, 5, 6
    v_mfma_f32_16x16x32_bf16 v[152:155], a[172:175], a[132:135], v[152:155]
    ds_read_b64_tr_b16 a[190:191], v13 offset:1536
    v_mfma_f32_16x16x32_bf16 v[136:139], a[172:175], a[128:131], v[136:139]
    s_waitcnt lgkmcnt(4)
    s_cmp_eq_u32 s3, 0
    s_cselect_b32 s71, 5, 6
    v_mfma_f32_16x16x32_bf16 v[132:135], a[176:179], a[128:131], v[132:135]
    ds_read_b64_tr_b16 a[160:161], v10 offset:57344
    buffer_load_dwordx4 v[112:115], v8, s[32:35], s66 offen offset:1024 sc1
    v_mfma_f32_16x16x32_bf16 v[148:151], a[176:179], a[132:135], v[148:151]
    v_mfma_f32_16x16x32_bf16 v[164:167], a[176:179], a[136:139], v[164:167]
    ds_read_b64_tr_b16 a[162:163], v10 offset:57856
    v_mfma_f32_16x16x32_bf16 v[180:183], a[176:179], a[140:143], v[180:183]
    v_mfma_f32_16x16x32_bf16 v[188:191], a[180:183], a[140:143], v[188:191]
    ds_read_b64_tr_b16 a[164:165], v10 offset:58368
    v_mfma_f32_16x16x32_bf16 v[172:175], a[180:183], a[136:139], v[172:175]
    buffer_load_dwordx4 v[116:119], v8, s[32:35], s66 offen offset:2048 sc1
    v_mfma_f32_16x16x32_bf16 v[156:159], a[180:183], a[132:135], v[156:159]
    ds_read_b64_tr_b16 a[166:167], v10 offset:58880
    v_mfma_f32_16x16x32_bf16 v[140:143], a[180:183], a[128:131], v[140:143]
    s_waitcnt lgkmcnt(4)
    v_mfma_f32_16x16x32_bf16 v[196:199], a[184:187], a[32:35], v[196:199]
    ds_read_b64_tr_b16 a[168:169], v12 offset:8192
    v_mfma_f32_16x16x32_bf16 v[212:215], a[184:187], a[36:39], v[212:215]
    buffer_load_dwordx4 v[120:123], v8, s[32:35], s66 offen offset:3072 sc1
    s_add_u32 s66, s66, 4096
    v_mfma_f32_16x16x32_bf16 v[228:231], a[184:187], a[40:43], v[228:231]
    ds_read_b64_tr_b16 a[170:171], v12 offset:8704
    v_mfma_f32_16x16x32_bf16 v[244:247], a[184:187], a[44:47], v[244:247]
    v_mfma_f32_16x16x32_bf16 v[252:255], a[188:191], a[44:47], v[252:255]
    ds_read_b64_tr_b16 a[172:173], v12 offset:9216
    v_mfma_f32_16x16x32_bf16 v[236:239], a[188:191], a[40:43], v[236:239]
    v_mfma_f32_16x16x32_bf16 v[220:223], a[188:191], a[36:39], v[220:223]
    ds_read_b64_tr_b16 a[174:175], v12 offset:9728
    buffer_load_dwordx4 v[124:127], v8, s[32:35], s66 offen offset:0 sc1
    v_mfma_f32_16x16x32_bf16 v[204:207], a[188:191], a[32:35], v[204:207]
    s_waitcnt vmcnt(22) lgkmcnt(4)
    s_add_u32 s66, s54, 0
    v_mfma_f32_16x16x32_bf16 v[128:131], a[160:163], a[144:147], v[128:131]
    ds_read_b64_tr_b16 a[176:177], v11 offset:57344
    v_mfma_f32_16x16x32_bf16 v[144:147], a[160:163], a[148:151], v[144:147]
    v_mfma_f32_16x16x32_bf16 v[160:163], a[160:163], a[152:155], v[160:163]
    ds_read_b64_tr_b16 a[178:179], v11 offset:57856
    buffer_load_dwordx4 v[48:51], v8, s[32:35], s66 offen offset:0 sc1
    v_mfma_f32_16x16x32_bf16 v[176:179], a[160:163], a[156:159], v[176:179]
    v_mfma_f32_16x16x32_bf16 v[184:187], a[164:167], a[156:159], v[184:187]
    ds_read_b64_tr_b16 a[180:181], v11 offset:58368
    v_mfma_f32_16x16x32_bf16 v[168:171], a[164:167], a[152:155], v[168:171]
    v_mfma_f32_16x16x32_bf16 v[152:155], a[164:167], a[148:151], v[152:155]
    ds_read_b64_tr_b16 a[182:183], v11 offset:58880
    v_mfma_f32_16x16x32_bf16 v[136:139], a[164:167], a[144:147], v[136:139]
    s_waitcnt lgkmcnt(4)
    buffer_load_dwordx4 v[52:55], v8, s[32:35], s66 offen offset:1024 sc1
    v_mfma_f32_16x16x32_bf16 v[192:195], a[168:171], a[48:51], v[192:195]
    ds_read_b64_tr_b16 a[184:185], v13 offset:8192
    v_mfma_f32_16x16x32_bf16 v[208:211], a[168:171], a[52:55], v[208:211]
    v_mfma_f32_16x16x32_bf16 v[224:227], a[168:171], a[56:59], v[224:227]
    ds_read_b64_tr_b16 a[186:187], v13 offset:8704
    v_mfma_f32_16x16x32_bf16 v[240:243], a[168:171], a[60:63], v[240:243]
    buffer_load_dwordx4 v[56:59], v8, s[32:35], s66 offen offset:2048 sc1
    v_mfma_f32_16x16x32_bf16 v[248:251], a[172:175], a[60:63], v[248:251]
    ds_read_b64_tr_b16 a[188:189], v13 offset:9216
    v_mfma_f32_16x16x32_bf16 v[232:235], a[172:175], a[56:59], v[232:235]
    v_mfma_f32_16x16x32_bf16 v[216:219], a[172:175], a[52:55], v[216:219]
    ds_read_b64_tr_b16 a[190:191], v13 offset:9728
    v_mfma_f32_16x16x32_bf16 v[200:203], a[172:175], a[48:51], v[200:203]
    s_waitcnt lgkmcnt(4)
    v_mfma_f32_16x16x32_bf16 v[132:135], a[176:179], a[144:147], v[132:135]
    ds_read_b64_tr_b16 a[160:161], v12 offset:16384
    buffer_load_dwordx4 v[60:63], v8, s[32:35], s66 offen offset:3072 sc1
    v_mfma_f32_16x16x32_bf16 v[148:151], a[176:179], a[148:151], v[148:151]
    s_add_u32 s66, s66, 4096
    v_mfma_f32_16x16x32_bf16 v[164:167], a[176:179], a[152:155], v[164:167]
    ds_read_b64_tr_b16 a[162:163], v12 offset:16896
    v_mfma_f32_16x16x32_bf16 v[180:183], a[176:179], a[156:159], v[180:183]
    v_mfma_f32_16x16x32_bf16 v[188:191], a[180:183], a[156:159], v[188:191]
    ds_read_b64_tr_b16 a[164:165], v12 offset:17408
    buffer_load_dwordx4 v[64:67], v8, s[32:35], s66 offen offset:0 sc1
    v_mfma_f32_16x16x32_bf16 v[172:175], a[180:183], a[152:155], v[172:175]
    s_add_u32 s66, s54, 40960
    v_mfma_f32_16x16x32_bf16 v[156:159], a[180:183], a[148:151], v[156:159]
    ds_read_b64_tr_b16 a[166:167], v12 offset:17920
    v_mfma_f32_16x16x32_bf16 v[140:143], a[180:183], a[144:147], v[140:143]
    s_waitcnt lgkmcnt(4)
    v_mfma_f32_16x16x32_bf16 v[196:199], a[184:187], a[48:51], v[196:199]
    ds_read_b64_tr_b16 a[168:169], v13 offset:16384
    v_mfma_f32_16x16x32_bf16 v[212:215], a[184:187], a[52:55], v[212:215]
    buffer_load_dwordx4 v[68:71], v8, s[32:35], s66 offen offset:0 sc1
    v_mfma_f32_16x16x32_bf16 v[228:231], a[184:187], a[56:59], v[228:231]
    ds_read_b64_tr_b16 a[170:171], v13 offset:16896
    v_mul_f32 v128, s62, v128
    v_mul_f32 v129, s62, v129
    v_mul_f32 v130, s62, v130
    v_mfma_f32_16x16x32_bf16 v[244:247], a[184:187], a[60:63], v[244:247]
    v_mul_f32 v131, s62, v131
    v_mul_f32 v132, s62, v132
    v_mul_f32 v133, s62, v133
    v_mul_f32 v134, s62, v134
    v_mfma_f32_16x16x32_bf16 v[252:255], a[188:191], a[60:63], v[252:255]
    ds_read_b64_tr_b16 a[172:173], v13 offset:17408
    buffer_load_dwordx4 v[72:75], v8, s[32:35], s66 offen offset:1024 sc1
    v_mul_f32 v135, s62, v135
    v_mfma_f32_16x16x32_bf16 v[236:239], a[188:191], a[56:59], v[236:239]
    v_exp_f32 v128, v128
    v_exp_f32 v129, v129
    v_mfma_f32_16x16x32_bf16 v[220:223], a[188:191], a[52:55], v[220:223]
    ds_read_b64_tr_b16 a[174:175], v13 offset:17920
    v_exp_f32 v130, v130
    v_mfma_f32_16x16x32_bf16 v[204:207], a[188:191], a[48:51], v[204:207]
    s_waitcnt lgkmcnt(4)
    v_exp_f32 v131, v131
    v_exp_f32 v132, v132
    v_mfma_f32_16x16x32_bf16 v[192:195], a[160:163], a[64:67], v[192:195]
    ds_read_b64_tr_b16 a[176:177], v12 offset:24576
    buffer_load_dwordx4 v[76:79], v8, s[32:35], s66 offen offset:2048 sc1
    v_exp_f32 v133, v133
    v_mfma_f32_16x16x32_bf16 v[208:211], a[160:163], a[68:71], v[208:211]
    v_exp_f32 v134, v134
    v_mul_f32 v144, s62, v144
    v_mul_f32 v145, s62, v145
    v_mfma_f32_16x16x32_bf16 v[224:227], a[160:163], a[72:75], v[224:227]
    ds_read_b64_tr_b16 a[178:179], v12 offset:25088
    v_exp_f32 v135, v135
    v_mul_f32 v146, s62, v146
    v_mfma_f32_16x16x32_bf16 v[240:243], a[160:163], a[76:79], v[240:243]
    buffer_load_dwordx4 v[80:83], v8, s[32:35], s66 offen offset:3072 sc1
    v_add_f32 v128, 1.0, v128
    v_mul_f32 v147, s62, v147
    v_add_f32 v129, 1.0, v129
    v_mfma_f32_16x16x32_bf16 v[248:251], a[164:167], a[76:79], v[248:251]
    ds_read_b64_tr_b16 a[180:181], v12 offset:25600
    v_add_f32 v130, 1.0, v130
    v_mul_f32 v148, s62, v148
    s_add_u32 s66, s66, 4096
    v_mfma_f32_16x16x32_bf16 v[232:235], a[164:167], a[72:75], v[232:235]
    v_add_f32 v131, 1.0, v131
    v_mul_f32 v149, s62, v149
    v_add_f32 v132, 1.0, v132
    v_mul_f32 v150, s62, v150
    v_mfma_f32_16x16x32_bf16 v[216:219], a[164:167], a[68:71], v[216:219]
    ds_read_b64_tr_b16 a[182:183], v12 offset:26112
    buffer_load_dwordx4 v[84:87], v8, s[32:35], s66 offen offset:0 sc1
    v_add_f32 v133, 1.0, v133
    v_mul_f32 v151, s62, v151
    v_mfma_f32_16x16x32_bf16 v[200:203], a[164:167], a[64:67], v[200:203]
    s_waitcnt lgkmcnt(4)
    v_add_f32 v134, 1.0, v134
    v_exp_f32 v144, v144
    s_add_u32 s66, s55, 0
    v_mfma_f32_16x16x32_bf16 v[196:199], a[168:171], a[64:67], v[196:199]
    ds_read_b64_tr_b16 a[184:185], v13 offset:24576
    v_add_f32 v135, 1.0, v135
    v_exp_f32 v145, v145
    v_mfma_f32_16x16x32_bf16 v[212:215], a[168:171], a[68:71], v[212:215]
    buffer_load_dwordx4 a[0:3], v8, s[32:35], s66 offen offset:0 sc1
    v_rcp_f32 v128, v128
    v_mfma_f32_16x16x32_bf16 v[228:231], a[168:171], a[72:75], v[228:231]
    ds_read_b64_tr_b16 a[186:187], v13 offset:25088
    v_rcp_f32 v129, v129
    v_mfma_f32_16x16x32_bf16 v[244:247], a[168:171], a[76:79], v[244:247]
    v_rcp_f32 v130, v130
    v_exp_f32 v146, v146
    v_mfma_f32_16x16x32_bf16 v[252:255], a[172:175], a[76:79], v[252:255]
    ds_read_b64_tr_b16 a[188:189], v13 offset:25600
    buffer_load_dwordx4 a[4:7], v8, s[32:35], s66 offen offset:1024 sc1
    v_rcp_f32 v131, v131
    v_mfma_f32_16x16x32_bf16 v[236:239], a[172:175], a[72:75], v[236:239]
    v_rcp_f32 v132, v132
    v_exp_f32 v147, v147
    v_mfma_f32_16x16x32_bf16 v[220:223], a[172:175], a[68:71], v[220:223]
    ds_read_b64_tr_b16 a[190:191], v13 offset:26112
    v_rcp_f32 v133, v133
    v_mfma_f32_16x16x32_bf16 v[204:207], a[172:175], a[64:67], v[204:207]
    s_waitcnt lgkmcnt(4)
    v_rcp_f32 v134, v134
    v_exp_f32 v148, v148
    v_mfma_f32_16x16x32_bf16 v[192:195], a[176:179], a[80:83], v[192:195]
    ds_read_b64_tr_b16 a[160:161], v12 offset:32768
    buffer_load_dwordx4 a[8:11], v8, s[32:35], s66 offen offset:2048 sc1
    v_rcp_f32 v135, v135
    v_mfma_f32_16x16x32_bf16 v[208:211], a[176:179], a[84:87], v[208:211]
    v_mul_f32 v128, v128, v136
    v_exp_f32 v149, v149
    v_mul_f32 v129, v129, v137
    v_mfma_f32_16x16x32_bf16 v[224:227], a[176:179], a[88:91], v[224:227]
    ds_read_b64_tr_b16 a[162:163], v12 offset:33280
    v_mul_f32 v130, v130, v138
    v_exp_f32 v150, v150
    v_mfma_f32_16x16x32_bf16 v[240:243], a[176:179], a[92:95], v[240:243]
    buffer_load_dwordx4 a[12:15], v8, s[32:35], s66 offen offset:3072 sc1
    v_mul_f32 v131, v131, v139
    v_exp_f32 v151, v151
    v_mfma_f32_16x16x32_bf16 v[248:251], a[180:183], a[92:95], v[248:251]
    ds_read_b64_tr_b16 a[164:165], v12 offset:33792
    v_mul_f32 v132, v132, v140
    v_add_f32 v144, 1.0, v144
    s_add_u32 s66, s66, 4096
    v_mfma_f32_16x16x32_bf16 v[232:235], a[180:183], a[88:91], v[232:235]
    v_mul_f32 v133, v133, v141
    v_add_f32 v145, 1.0, v145
    v_mul_f32 v134, v134, v142
    v_add_f32 v146, 1.0, v146
    v_mfma_f32_16x16x32_bf16 v[216:219], a[180:183], a[84:87], v[216:219]
    ds_read_b64_tr_b16 a[166:167], v12 offset:34304
    buffer_load_dwordx4 a[16:19], v8, s[32:35], s66 offen offset:0 sc1
    v_mul_f32 v135, v135, v143
    v_add_f32 v147, 1.0, v147
    v_mfma_f32_16x16x32_bf16 v[200:203], a[180:183], a[80:83], v[200:203]
    s_waitcnt lgkmcnt(4)
    v_cvt_pk_bf16_f32 v136, v128, v129
    v_add_f32 v148, 1.0, v148
    s_add_u32 s66, s55, 40960
    v_cvt_pk_bf16_f32 v137, v130, v131
    v_mfma_f32_16x16x32_bf16 v[196:199], a[184:187], a[80:83], v[196:199]
    ds_read_b64_tr_b16 a[168:169], v13 offset:32768
    v_cvt_pk_bf16_f32 v138, v132, v133
    v_add_f32 v149, 1.0, v149
    v_cvt_pk_bf16_f32 v139, v134, v135
    v_mfma_f32_16x16x32_bf16 v[212:215], a[184:187], a[84:87], v[212:215]
    buffer_store_dwordx4 v[136:139], v8, s[32:35], s59 offen offset:0 sc1
    v_add_f32 v150, 1.0, v150
    v_mul_f32 v160, s62, v160
    v_add_f32 v151, 1.0, v151
    v_mfma_f32_16x16x32_bf16 v[228:231], a[184:187], a[88:91], v[228:231]
    ds_read_b64_tr_b16 a[170:171], v13 offset:33280
    v_mul_f32 v161, s62, v161
    v_rcp_f32 v144, v144
    v_mfma_f32_16x16x32_bf16 v[244:247], a[184:187], a[92:95], v[244:247]
    v_mul_f32 v162, s62, v162
    v_rcp_f32 v145, v145
    v_mul_f32 v163, s62, v163
    v_mfma_f32_16x16x32_bf16 v[252:255], a[188:191], a[92:95], v[252:255]
    ds_read_b64_tr_b16 a[172:173], v13 offset:33792
    v_mul_f32 v164, s62, v164
    v_rcp_f32 v146, v146
    v_mfma_f32_16x16x32_bf16 v[236:239], a[188:191], a[88:91], v[236:239]
    buffer_load_dwordx4 a[20:23], v8, s[32:35], s66 offen offset:0 sc1
    v_mul_f32 v165, s62, v165
    v_rcp_f32 v147, v147
    v_mfma_f32_16x16x32_bf16 v[220:223], a[188:191], a[84:87], v[220:223]
    ds_read_b64_tr_b16 a[174:175], v13 offset:34304
    v_mul_f32 v166, s62, v166
    v_rcp_f32 v148, v148
    v_mfma_f32_16x16x32_bf16 v[204:207], a[188:191], a[80:83], v[204:207]
    s_waitcnt lgkmcnt(4)
    v_mul_f32 v167, s62, v167
    v_rcp_f32 v149, v149
    v_mfma_f32_16x16x32_bf16 v[192:195], a[160:163], a[96:99], v[192:195]
    ds_read_b64_tr_b16 a[176:177], v12 offset:40960
    v_exp_f32 v160, v160
    v_mfma_f32_16x16x32_bf16 v[208:211], a[160:163], a[100:103], v[208:211]
    buffer_load_dwordx4 a[24:27], v8, s[32:35], s66 offen offset:1024 sc1
    v_exp_f32 v161, v161
    v_mfma_f32_16x16x32_bf16 v[224:227], a[160:163], a[104:107], v[224:227]
    ds_read_b64_tr_b16 a[178:179], v12 offset:41472
    v_exp_f32 v162, v162
    v_mfma_f32_16x16x32_bf16 v[240:243], a[160:163], a[108:111], v[240:243]
    v_exp_f32 v163, v163
    v_rcp_f32 v150, v150
    v_mfma_f32_16x16x32_bf16 v[248:251], a[164:167], a[108:111], v[248:251]
    ds_read_b64_tr_b16 a[180:181], v12 offset:41984
    buffer_load_dwordx4 a[28:31], v8, s[32:35], s66 offen offset:2048 sc1
    v_exp_f32 v164, v164
    v_mfma_f32_16x16x32_bf16 v[232:235], a[164:167], a[104:107], v[232:235]
    v_exp_f32 v165, v165
    v_rcp_f32 v151, v151
    v_mfma_f32_16x16x32_bf16 v[216:219], a[164:167], a[100:103], v[216:219]
    ds_read_b64_tr_b16 a[182:183], v12 offset:42496
    v_exp_f32 v166, v166
    v_mul_f32 v144, v144, v152
    v_mfma_f32_16x16x32_bf16 v[200:203], a[164:167], a[96:99], v[200:203]
    s_waitcnt lgkmcnt(4)
    buffer_load_dwordx4 a[32:35], v8, s[32:35], s66 offen offset:3072 sc1
    v_exp_f32 v167, v167
    v_mfma_f32_16x16x32_bf16 v[196:199], a[168:171], a[96:99], v[196:199]
    ds_read_b64_tr_b16 a[184:185], v13 offset:40960
    v_add_f32 v160, 1.0, v160
    v_mul_f32 v145, v145, v153
    s_add_u32 s66, s66, 4096
    v_mfma_f32_16x16x32_bf16 v[212:215], a[168:171], a[100:103], v[212:215]
    v_add_f32 v161, 1.0, v161
    v_mul_f32 v146, v146, v154
    v_add_f32 v162, 1.0, v162
    v_mul_f32 v147, v147, v155
    v_mfma_f32_16x16x32_bf16 v[228:231], a[168:171], a[104:107], v[228:231]
    ds_read_b64_tr_b16 a[186:187], v13 offset:41472
    buffer_load_dwordx4 a[36:39], v8, s[32:35], s66 offen offset:0 sc1
    v_add_f32 v163, 1.0, v163
    v_mul_f32 v148, v148, v156
    v_mfma_f32_16x16x32_bf16 v[244:247], a[168:171], a[108:111], v[244:247]
    s_add_u32 s66, s55, 81920
    v_add_f32 v164, 1.0, v164
    v_mul_f32 v149, v149, v157
    v_add_f32 v165, 1.0, v165
    v_mul_f32 v150, v150, v158
    v_mfma_f32_16x16x32_bf16 v[252:255], a[172:175], a[108:111], v[252:255]
    ds_read_b64_tr_b16 a[188:189], v13 offset:41984
    v_add_f32 v166, 1.0, v166
    v_mul_f32 v151, v151, v159
    v_add_f32 v167, 1.0, v167
    v_mfma_f32_16x16x32_bf16 v[236:239], a[172:175], a[104:107], v[236:239]
    buffer_load_dwordx4 a[40:43], v8, s[32:35], s66 offen offset:0 sc1
    v_rcp_f32 v160, v160
    v_cvt_pk_bf16_f32 v152, v144, v145
    v_mfma_f32_16x16x32_bf16 v[220:223], a[172:175], a[100:103], v[220:223]
    ds_read_b64_tr_b16 a[190:191], v13 offset:42496
    v_rcp_f32 v161, v161
    v_cvt_pk_bf16_f32 v153, v146, v147
    v_mfma_f32_16x16x32_bf16 v[204:207], a[172:175], a[96:99], v[204:207]
    s_waitcnt lgkmcnt(4)
    v_rcp_f32 v162, v162
    v_cvt_pk_bf16_f32 v154, v148, v149
    v_cvt_pk_bf16_f32 v155, v150, v151
    v_mfma_f32_16x16x32_bf16 v[192:195], a[176:179], a[112:115], v[192:195]
    ds_read_b64_tr_b16 a[160:161], v12 offset:49152
    buffer_store_dwordx4 v[152:155], v8, s[32:35], s59 offen offset:1024 sc1
    v_rcp_f32 v163, v163
    v_mfma_f32_16x16x32_bf16 v[208:211], a[176:179], a[116:119], v[208:211]
    v_rcp_f32 v164, v164
    v_mul_f32 v176, s62, v176
    v_mul_f32 v177, s62, v177
    v_mfma_f32_16x16x32_bf16 v[224:227], a[176:179], a[120:123], v[224:227]
    ds_read_b64_tr_b16 a[162:163], v12 offset:49664
    v_rcp_f32 v165, v165
    v_mul_f32 v178, s62, v178
    v_mfma_f32_16x16x32_bf16 v[240:243], a[176:179], a[124:127], v[240:243]
    v_rcp_f32 v166, v166
    v_mul_f32 v179, s62, v179
    v_mul_f32 v180, s62, v180
    v_mfma_f32_16x16x32_bf16 v[248:251], a[180:183], a[124:127], v[248:251]
    ds_read_b64_tr_b16 a[164:165], v12 offset:50176
    buffer_load_dwordx4 a[44:47], v8, s[32:35], s66 offen offset:1024 sc1
    v_rcp_f32 v167, v167
    v_mfma_f32_16x16x32_bf16 v[232:235], a[180:183], a[120:123], v[232:235]
    v_mul_f32 v160, v160, v168
    v_mul_f32 v181, s62, v181
    v_mul_f32 v161, v161, v169
    v_mul_f32 v182, s62, v182
    v_mfma_f32_16x16x32_bf16 v[216:219], a[180:183], a[116:119], v[216:219]
    ds_read_b64_tr_b16 a[166:167], v12 offset:50688
    v_mul_f32 v162, v162, v170
    v_mul_f32 v183, s62, v183
    v_mul_f32 v163, v163, v171
    v_mfma_f32_16x16x32_bf16 v[200:203], a[180:183], a[112:115], v[200:203]
    s_waitcnt lgkmcnt(4)
    buffer_load_dwordx4 a[48:51], v8, s[32:35], s66 offen offset:2048 sc1
    v_mul_f32 v164, v164, v172
    v_mul_f32 v165, v165, v173
    v_mfma_f32_16x16x32_bf16 v[196:199], a[184:187], a[112:115], v[196:199]
    ds_read_b64_tr_b16 a[168:169], v13 offset:49152
    v_mul_f32 v166, v166, v174
    v_exp_f32 v176, v176
    v_mfma_f32_16x16x32_bf16 v[212:215], a[184:187], a[116:119], v[212:215]
    v_mul_f32 v167, v167, v175
    v_exp_f32 v177, v177
    v_cvt_pk_bf16_f32 v168, v160, v161
    v_mfma_f32_16x16x32_bf16 v[228:231], a[184:187], a[120:123], v[228:231]
    ds_read_b64_tr_b16 a[170:171], v13 offset:49664
    buffer_load_dwordx4 a[52:55], v8, s[32:35], s66 offen offset:3072 sc1
    v_cvt_pk_bf16_f32 v169, v162, v163
    v_cvt_pk_bf16_f32 v170, v164, v165
    v_mfma_f32_16x16x32_bf16 v[244:247], a[184:187], a[124:127], v[244:247]
    s_add_u32 s66, s66, 4096
    v_cvt_pk_bf16_f32 v171, v166, v167
    v_exp_f32 v178, v178
    v_mfma_f32_16x16x32_bf16 v[252:255], a[188:191], a[124:127], v[252:255]
    ds_read_b64_tr_b16 a[172:173], v13 offset:50176
    v_exp_f32 v179, v179
    v_mfma_f32_16x16x32_bf16 v[236:239], a[188:191], a[120:123], v[236:239]
    v_exp_f32 v180, v180
    v_exp_f32 v181, v181
    v_mfma_f32_16x16x32_bf16 v[220:223], a[188:191], a[116:119], v[220:223]
    ds_read_b64_tr_b16 a[174:175], v13 offset:50688
    buffer_store_dwordx4 v[168:171], v8, s[32:35], s59 offen offset:2048 sc1
    v_exp_f32 v182, v182
    v_mfma_f32_16x16x32_bf16 v[204:207], a[188:191], a[112:115], v[204:207]
    s_waitcnt lgkmcnt(4)
    v_exp_f32 v183, v183
    v_add_f32 v176, 1.0, v176
    v_add_f32 v177, 1.0, v177
    v_mfma_f32_16x16x32_bf16 v[192:195], a[160:163], a[128:131], v[192:195]
    ds_read_b64_tr_b16 a[176:177], v12 offset:57344
    v_add_f32 v178, 1.0, v178
    v_add_f32 v179, 1.0, v179
    v_add_f32 v180, 1.0, v180
    v_mfma_f32_16x16x32_bf16 v[208:211], a[160:163], a[132:135], v[208:211]
    v_add_f32 v181, 1.0, v181
    v_add_f32 v182, 1.0, v182
    v_add_f32 v183, 1.0, v183
    v_mfma_f32_16x16x32_bf16 v[224:227], a[160:163], a[136:139], v[224:227]
    ds_read_b64_tr_b16 a[178:179], v12 offset:57856
    v_rcp_f32 v176, v176
    v_mfma_f32_16x16x32_bf16 v[240:243], a[160:163], a[140:143], v[240:243]
    buffer_load_dwordx4 a[56:59], v8, s[32:35], s66 offen offset:0 sc1
    v_rcp_f32 v177, v177
    v_mfma_f32_16x16x32_bf16 v[248:251], a[164:167], a[140:143], v[248:251]
    ds_read_b64_tr_b16 a[180:181], v12 offset:58368
    v_rcp_f32 v178, v178
    v_mfma_f32_16x16x32_bf16 v[232:235], a[164:167], a[136:139], v[232:235]
    v_rcp_f32 v179, v179
    v_rcp_f32 v180, v180
    v_mfma_f32_16x16x32_bf16 v[216:219], a[164:167], a[132:135], v[216:219]
    ds_read_b64_tr_b16 a[182:183], v12 offset:58880
    v_rcp_f32 v181, v181
    v_mfma_f32_16x16x32_bf16 v[200:203], a[164:167], a[128:131], v[200:203]
    s_waitcnt lgkmcnt(4)
    v_rcp_f32 v182, v182
    v_rcp_f32 v183, v183
    v_mfma_f32_16x16x32_bf16 v[196:199], a[168:171], a[128:131], v[196:199]
    ds_read_b64_tr_b16 a[184:185], v13 offset:57344
    v_mul_f32 v176, v176, v184
    v_mul_f32 v177, v177, v185
    v_mul_f32 v178, v178, v186
    v_mfma_f32_16x16x32_bf16 v[212:215], a[168:171], a[132:135], v[212:215]
    v_mul_f32 v179, v179, v187
    v_mul_f32 v180, v180, v188
    v_mul_f32 v181, v181, v189
    v_mul_f32 v182, v182, v190
    v_mfma_f32_16x16x32_bf16 v[228:231], a[168:171], a[136:139], v[228:231]
    ds_read_b64_tr_b16 a[186:187], v13 offset:57856
    v_mul_f32 v183, v183, v191
    v_cvt_pk_bf16_f32 v184, v176, v177
    v_cvt_pk_bf16_f32 v185, v178, v179
    v_mfma_f32_16x16x32_bf16 v[244:247], a[168:171], a[140:143], v[244:247]
    v_cvt_pk_bf16_f32 v186, v180, v181
    v_cvt_pk_bf16_f32 v187, v182, v183
    v_mfma_f32_16x16x32_bf16 v[252:255], a[172:175], a[140:143], v[252:255]
    ds_read_b64_tr_b16 a[188:189], v13 offset:58368
    buffer_store_dwordx4 v[184:187], v8, s[32:35], s59 offen offset:3072 sc1
    v_mfma_f32_16x16x32_bf16 v[236:239], a[172:175], a[136:139], v[236:239]
    v_mfma_f32_16x16x32_bf16 v[220:223], a[172:175], a[132:135], v[220:223]
    ds_read_b64_tr_b16 a[190:191], v13 offset:58880
    v_mfma_f32_16x16x32_bf16 v[204:207], a[172:175], a[128:131], v[204:207]
    s_waitcnt lgkmcnt(4)
    v_mfma_f32_16x16x32_bf16 v[192:195], a[176:179], a[144:147], v[192:195]
    v_mfma_f32_16x16x32_bf16 v[208:211], a[176:179], a[148:151], v[208:211]
    v_mfma_f32_16x16x32_bf16 v[224:227], a[176:179], a[152:155], v[224:227]
    v_mfma_f32_16x16x32_bf16 v[240:243], a[176:179], a[156:159], v[240:243]
    v_mfma_f32_16x16x32_bf16 v[248:251], a[180:183], a[156:159], v[248:251]
    v_mfma_f32_16x16x32_bf16 v[232:235], a[180:183], a[152:155], v[232:235]
    v_mfma_f32_16x16x32_bf16 v[216:219], a[180:183], a[148:151], v[216:219]
    v_mfma_f32_16x16x32_bf16 v[200:203], a[180:183], a[144:147], v[200:203]
    s_waitcnt lgkmcnt(0)
    v_mfma_f32_16x16x32_bf16 v[196:199], a[184:187], a[144:147], v[196:199]
    v_mfma_f32_16x16x32_bf16 v[212:215], a[184:187], a[148:151], v[212:215]
    v_mfma_f32_16x16x32_bf16 v[228:231], a[184:187], a[152:155], v[228:231]
    v_mfma_f32_16x16x32_bf16 v[244:247], a[184:187], a[156:159], v[244:247]
    v_mfma_f32_16x16x32_bf16 v[252:255], a[188:191], a[156:159], v[252:255]
    v_mfma_f32_16x16x32_bf16 v[236:239], a[188:191], a[152:155], v[236:239]
    v_mfma_f32_16x16x32_bf16 v[220:223], a[188:191], a[148:151], v[220:223]
    v_mfma_f32_16x16x32_bf16 v[204:207], a[188:191], a[144:147], v[204:207]
    s_barrier
    s_and_b32 s76, s3, 1
    s_mul_i32 s76, s76, 768
    v_add_u32 v9, s76, v20
    v_pk_mul_f32 v[192:193], v[192:193], s[62:63]
    s_add_u32 s66, s55, 122880
    buffer_load_dwordx4 v[128:131], v8, s[32:35], s66 offen offset:0 sc1
    v_pk_mul_f32 v[194:195], v[194:195], s[62:63]
    v_pk_mul_f32 v[196:197], v[196:197], s[62:63]
    v_pk_mul_f32 v[198:199], v[198:199], s[62:63]
    v_exp_f32 v192, v192
    v_exp_f32 v193, v193
    v_exp_f32 v194, v194
    v_exp_f32 v195, v195
    v_exp_f32 v196, v196
    v_exp_f32 v197, v197
    v_exp_f32 v198, v198
    buffer_load_dwordx4 v[132:135], v8, s[32:35], s66 offen offset:1024 sc1
    v_exp_f32 v199, v199
    v_pk_add_f32 v[192:193], v[192:193], 1.0 op_sel_hi:[1,0]
    v_pk_add_f32 v[194:195], v[194:195], 1.0 op_sel_hi:[1,0]
    v_pk_add_f32 v[196:197], v[196:197], 1.0 op_sel_hi:[1,0]
    v_pk_add_f32 v[198:199], v[198:199], 1.0 op_sel_hi:[1,0]
    v_rcp_f32 v192, v192
    v_rcp_f32 v193, v193
    v_rcp_f32 v194, v194
    v_rcp_f32 v195, v195
    v_rcp_f32 v196, v196
    v_rcp_f32 v197, v197
    buffer_load_dwordx4 v[136:139], v8, s[32:35], s66 offen offset:2048 sc1
    v_rcp_f32 v198, v198
    v_rcp_f32 v199, v199
    v_pk_mul_f32 v[192:193], v[192:193], v[200:201]
    v_pk_mul_f32 v[194:195], v[194:195], v[202:203]
    v_pk_mul_f32 v[196:197], v[196:197], v[204:205]
    v_pk_mul_f32 v[198:199], v[198:199], v[206:207]
    v_cvt_pk_bf16_f32 v200, v192, v193
    v_cvt_pk_bf16_f32 v201, v194, v195
    v_cvt_pk_bf16_f32 v202, v196, v197
    v_cvt_pk_bf16_f32 v203, v198, v199
    buffer_store_dwordx4 v[200:203], v8, s[32:35], s60 offen offset:0 sc1
    v_pk_mul_f32 v[208:209], v[208:209], s[62:63]
    v_pk_mul_f32 v[210:211], v[210:211], s[62:63]
    v_pk_mul_f32 v[212:213], v[212:213], s[62:63]
    ds_read_b128 a[80:83], v20 offset:192
    ds_read2_b32 a[64:65], v16 offset0:176 offset1:177
    v_pk_mul_f32 v[214:215], v[214:215], s[62:63]
    v_exp_f32 v208, v208
    v_exp_f32 v209, v209
    v_exp_f32 v210, v210
    v_exp_f32 v211, v211
    v_exp_f32 v212, v212
    v_exp_f32 v213, v213
    v_exp_f32 v214, v214
    v_exp_f32 v215, v215
    v_pk_add_f32 v[208:209], v[208:209], 1.0 op_sel_hi:[1,0]
    v_pk_add_f32 v[210:211], v[210:211], 1.0 op_sel_hi:[1,0]
    ds_read2_b32 a[66:67], v16 offset0:178 offset1:179
    ds_read_b128 a[164:167], v9 offset:192
    v_pk_add_f32 v[212:213], v[212:213], 1.0 op_sel_hi:[1,0]
    v_pk_add_f32 v[214:215], v[214:215], 1.0 op_sel_hi:[1,0]
    ds_read_b128 a[168:171], v9 offset:176
    ds_read_b128 a[84:87], v20 offset:704
    buffer_load_dwordx4 v[140:143], v8, s[32:35], s66 offen offset:3072 sc1
    v_rcp_f32 v208, v208
    v_rcp_f32 v209, v209
    v_rcp_f32 v210, v210
    v_rcp_f32 v211, v211
    v_rcp_f32 v212, v212
    v_rcp_f32 v213, v213
    v_rcp_f32 v214, v214
    v_rcp_f32 v215, v215
    v_pk_mul_f32 v[208:209], v[208:209], v[216:217]
    v_pk_mul_f32 v[210:211], v[210:211], v[218:219]
    v_pk_mul_f32 v[212:213], v[212:213], v[220:221]
    ds_read2_b32 a[68:69], v16 offset0:48 offset1:49
    ds_read2_b32 a[70:71], v16 offset0:50 offset1:51
    v_pk_mul_f32 v[214:215], v[214:215], v[222:223]
    v_cvt_pk_bf16_f32 v216, v208, v209
    v_cvt_pk_bf16_f32 v217, v210, v211
    v_cvt_pk_bf16_f32 v218, v212, v213
    v_cvt_pk_bf16_f32 v219, v214, v215
    buffer_store_dwordx4 v[216:219], v8, s[32:35], s60 offen offset:1024 sc1
    v_pk_mul_f32 v[224:225], v[224:225], s[62:63]
    v_pk_mul_f32 v[226:227], v[226:227], s[62:63]
    ds_read_b128 a[88:91], v20 offset:1216
    ds_read2_b32 a[72:73], v17 offset0:176 offset1:177
    v_pk_mul_f32 v[228:229], v[228:229], s[62:63]
    v_pk_mul_f32 v[230:231], v[230:231], s[62:63]
    ds_read2_b32 a[74:75], v17 offset0:178 offset1:179
    ds_read_b128 a[92:95], v20 offset:1728
    v_exp_f32 v224, v224
    v_exp_f32 v225, v225
    v_exp_f32 v226, v226
    v_exp_f32 v227, v227
    v_exp_f32 v228, v228
    v_exp_f32 v229, v229
    v_exp_f32 v230, v230
    s_waitcnt vmcnt(6)
    s_mov_b64 exec, 1
    buffer_store_dword v25, off, s[32:35], s46 sc1
    s_mov_b64 exec, -1
    v_exp_f32 v231, v231
    v_pk_add_f32 v[224:225], v[224:225], 1.0 op_sel_hi:[1,0]
    v_pk_add_f32 v[226:227], v[226:227], 1.0 op_sel_hi:[1,0]
    v_pk_add_f32 v[228:229], v[228:229], 1.0 op_sel_hi:[1,0]
    ds_read2_b32 a[76:77], v17 offset0:48 offset1:49
    ds_read2_b32 a[78:79], v17 offset0:50 offset1:51
    v_pk_add_f32 v[230:231], v[230:231], 1.0 op_sel_hi:[1,0]
    v_rcp_f32 v224, v224
    v_rcp_f32 v225, v225
    v_rcp_f32 v226, v226
    v_rcp_f32 v227, v227
    v_rcp_f32 v228, v228
    v_rcp_f32 v229, v229
    v_rcp_f32 v230, v230
    v_rcp_f32 v231, v231
    v_pk_mul_f32 v[224:225], v[224:225], v[232:233]
    v_pk_mul_f32 v[226:227], v[226:227], v[234:235]
    v_pk_mul_f32 v[228:229], v[228:229], v[236:237]
    v_pk_mul_f32 v[230:231], v[230:231], v[238:239]
    v_cvt_pk_bf16_f32 v232, v224, v225
    v_cvt_pk_bf16_f32 v233, v226, v227
    v_cvt_pk_bf16_f32 v234, v228, v229
    v_cvt_pk_bf16_f32 v235, v230, v231
    buffer_store_dwordx4 v[232:235], v8, s[32:35], s60 offen offset:2048 sc1
    v_pk_mul_f32 v[240:241], v[240:241], s[62:63]
    v_pk_mul_f32 v[242:243], v[242:243], s[62:63]
    v_pk_mul_f32 v[244:245], v[244:245], s[62:63]
    v_pk_mul_f32 v[246:247], v[246:247], s[62:63]
    v_exp_f32 v240, v240
    v_exp_f32 v241, v241
    v_exp_f32 v242, v242
    v_exp_f32 v243, v243
    v_exp_f32 v244, v244
    v_exp_f32 v245, v245
    v_exp_f32 v246, v246
    v_exp_f32 v247, v247
    v_pk_add_f32 v[240:241], v[240:241], 1.0 op_sel_hi:[1,0]
    v_pk_add_f32 v[242:243], v[242:243], 1.0 op_sel_hi:[1,0]
    v_pk_add_f32 v[244:245], v[244:245], 1.0 op_sel_hi:[1,0]
    v_pk_add_f32 v[246:247], v[246:247], 1.0 op_sel_hi:[1,0]
    v_rcp_f32 v240, v240
    v_rcp_f32 v241, v241
    v_rcp_f32 v242, v242
    v_rcp_f32 v243, v243
    v_rcp_f32 v244, v244
    v_rcp_f32 v245, v245
    v_rcp_f32 v246, v246
    v_rcp_f32 v247, v247
    v_pk_mul_f32 v[240:241], v[240:241], v[248:249]
    v_pk_mul_f32 v[242:243], v[242:243], v[250:251]
    v_pk_mul_f32 v[244:245], v[244:245], v[252:253]
    v_pk_mul_f32 v[246:247], v[246:247], v[254:255]
    v_cvt_pk_bf16_f32 v248, v240, v241
    v_cvt_pk_bf16_f32 v249, v242, v243
    v_cvt_pk_bf16_f32 v250, v244, v245
    v_cvt_pk_bf16_f32 v251, v246, v247
    buffer_store_dwordx4 v[248:251], v8, s[32:35], s60 offen offset:3072 sc1
join:
    s_waitcnt lgkmcnt(11)
    v_mfma_f32_16x16x32_bf16 v[224:227], a[64:67], a[80:83], 0
    ds_read_b128 a[96:99], v20 offset:2240
    s_waitcnt lgkmcnt(11)
    v_mfma_f32_16x16x32_bf16 v[208:211], a[164:167], v[40:43], 0
    ds_read_b128 a[100:103], v20 offset:2752
    v_min_u32 v28, s70, v1
    s_waitcnt lgkmcnt(11)
    v_mfma_f32_16x16x32_bf16 v[212:215], a[168:171], v[44:47], 0
    ds_read_b128 a[104:107], v20 offset:3264
    v_lshlrev_b32 v28, 6, v28
    s_waitcnt lgkmcnt(9)
    v_mfma_f32_16x16x32_bf16 v[228:231], a[68:71], a[80:83], 0
    ds_read_b128 a[108:111], v20 offset:3776
    v_lshlrev_b32 v13, 4, v0
    v_mfma_f32_16x16x32_bf16 v[228:231], a[64:67], a[84:87], v[228:231]
    ds_read2_b32 a[160:161], v18 offset0:176 offset1:177
    v_add_u32 v10, 1024, v13
    s_waitcnt lgkmcnt(8)
    v_mfma_f32_16x16x32_bf16 v[232:235], a[72:75], a[80:83], 0
    ds_read2_b32 a[162:163], v18 offset0:178 offset1:179
    v_and_b32 v10, 0xfff, v10
    v_mfma_f32_16x16x32_bf16 v[232:235], a[68:71], a[84:87], v[232:235]
    ds_read_b128 a[172:175], v9 offset:1216
    v_add_u32 v11, 2048, v13
    v_mfma_f32_16x16x32_bf16 v[232:235], a[64:67], a[88:91], v[232:235]
    ds_read_b128 a[176:179], v9 offset:1200
    v_and_b32 v11, 0xfff, v11
    s_waitcnt lgkmcnt(8)
    v_mfma_f32_16x16x32_bf16 v[236:239], a[76:79], a[80:83], 0
    ds_read_b128 a[128:131], v20 offset:128
    v_add_u32 v12, 3072, v13
    v_mfma_f32_16x16x32_bf16 v[236:239], a[72:75], a[84:87], v[236:239]
    ds_read2_b32 a[112:113], v16 offset0:160 offset1:161
    v_and_b32 v12, 0xfff, v12
    v_mfma_f32_16x16x32_bf16 v[236:239], a[68:71], a[88:91], v[236:239]
    s_add_u32 s66, s66, 4096
    v_cvt_pk_bf16_f32 v216, v208, v212
    ds_read2_b32 a[114:115], v16 offset0:162 offset1:163
    v_mfma_f32_16x16x32_bf16 v[236:239], a[64:67], a[92:95], v[236:239]
    ds_read_b128 a[132:135], v20 offset:640
    buffer_load_dwordx4 v[144:147], v8, s[32:35], s66 offen offset:0 sc1
    v_mfma_f32_16x16x32_bf16 v[240:243], a[76:79], a[84:87], 0
    ds_read2_b32 a[116:117], v16 offset0:32 offset1:33
    s_add_u32 s66, s55, 163840
    v_mfma_f32_16x16x32_bf16 v[240:243], a[72:75], a[88:91], v[240:243]
    v_cvt_pk_bf16_f32 v217, v209, v213
    ds_read2_b32 a[118:119], v16 offset0:34 offset1:35
    v_mfma_f32_16x16x32_bf16 v[240:243], a[68:71], a[92:95], v[240:243]
    s_waitcnt lgkmcnt(8)
    ds_read_b128 a[136:139], v20 offset:1152
    v_mfma_f32_16x16x32_bf16 v[240:243], a[64:67], a[96:99], v[240:243]
    ds_read2_b32 a[120:121], v17 offset0:160 offset1:161
    buffer_load_dwordx4 v[148:151], v8, s[32:35], s66 offen offset:0 sc1
    v_mfma_f32_16x16x32_bf16 v[244:247], a[76:79], a[88:91], 0
    v_cvt_pk_bf16_f32 v218, v210, v214
    ds_read2_b32 a[122:123], v17 offset0:162 offset1:163
    v_mfma_f32_16x16x32_bf16 v[244:247], a[72:75], a[92:95], v[244:247]
    ds_read_b128 a[140:143], v20 offset:1664
    v_mfma_f32_16x16x32_bf16 v[244:247], a[68:71], a[96:99], v[244:247]
    ds_read2_b32 a[124:125], v17 offset0:32 offset1:33
    buffer_load_dwordx4 v[152:155], v8, s[32:35], s66 offen offset:1024 sc1
    v_mfma_f32_16x16x32_bf16 v[244:247], a[64:67], a[100:103], v[244:247]
    v_cvt_pk_bf16_f32 v219, v211, v215
    ds_read2_b32 a[126:127], v17 offset0:34 offset1:35
    v_mfma_f32_16x16x32_bf16 v[248:251], a[76:79], a[92:95], 0
    ds_read_b128 a[144:147], v20 offset:2176
    v_mfma_f32_16x16x32_bf16 v[248:251], a[72:75], a[96:99], v[248:251]
    ds_read_b128 a[148:151], v20 offset:2688
    v_mfma_f32_16x16x32_bf16 v[248:251], a[68:71], a[100:103], v[248:251]
    ds_read_b128 a[152:155], v20 offset:3200
    buffer_load_dwordx4 v[156:159], v8, s[32:35], s66 offen offset:2048 sc1
    v_mfma_f32_16x16x32_bf16 v[248:251], a[64:67], a[104:107], v[248:251]
    ds_read_b128 a[156:159], v20 offset:3712
    v_mfma_f32_16x16x32_bf16 v[252:255], a[76:79], a[96:99], 0
    v_mfma_f32_16x16x32_bf16 v[252:255], a[72:75], a[100:103], v[252:255]
    v_mfma_f32_16x16x32_bf16 v[252:255], a[68:71], a[104:107], v[252:255]
    buffer_load_dwordx4 v[160:163], v8, s[32:35], s66 offen offset:3072 sc1
    s_add_u32 s66, s66, 4096
    v_mfma_f32_16x16x32_bf16 v[252:255], a[64:67], a[108:111], v[252:255]
    v_mfma_f32_16x16x32_bf16 v[240:243], a[160:163], a[80:83], v[240:243]
    v_mfma_f32_16x16x32_bf16 v[244:247], a[160:163], a[84:87], v[244:247]
    v_mfma_f32_16x16x32_bf16 v[248:251], a[160:163], a[88:91], v[248:251]
    buffer_load_dwordx4 v[164:167], v8, s[32:35], s66 offen offset:0 sc1
    s_add_u32 s66, s55, 204800
    v_mfma_f32_16x16x32_bf16 v[252:255], a[160:163], a[92:95], v[252:255]
    s_waitcnt lgkmcnt(4)
    v_mfma_f32_16x16x32_bf16 v[224:227], a[112:115], a[128:131], v[224:227]
    ds_read2_b32 a[180:181], v19 offset0:3 offset1:2
    v_mfma_f32_16x16x32_bf16 v[208:211], a[172:175], v[40:43], 0
    ds_read2_b32 a[182:183], v19 offset0:1 offset1:0
    v_mfma_f32_16x16x32_bf16 v[212:215], a[176:179], v[44:47], 0
    ds_read2_b32 a[184:185], v19 offset0:19 offset1:18
    buffer_load_dwordx4 v[168:171], v8, s[32:35], s66 offen offset:0 sc1
    v_mfma_f32_16x16x32_bf16 v[228:231], a[116:119], a[128:131], v[228:231]
    ds_read2_b32 a[186:187], v19 offset0:17 offset1:16
    v_mfma_f32_16x16x32_bf16 v[228:231], a[112:115], a[132:135], v[228:231]
    ds_read2_b32 a[188:189], v19 offset0:35 offset1:34
    v_mfma_f32_16x16x32_bf16 v[232:235], a[120:123], a[128:131], v[232:235]
    ds_read2_b32 a[190:191], v19 offset0:33 offset1:32
    v_mfma_f32_16x16x32_bf16 v[232:235], a[116:119], a[132:135], v[232:235]
    ds_read2_b32 a[60:61], v19 offset0:51 offset1:50
    buffer_load_dwordx4 v[172:175], v8, s[32:35], s66 offen offset:1024 sc1
    v_mfma_f32_16x16x32_bf16 v[232:235], a[112:115], a[136:139], v[232:235]
    s_waitcnt lgkmcnt(7)
    ds_read2_b32 a[62:63], v19 offset0:49 offset1:48
    v_mfma_f32_16x16x32_bf16 v[236:239], a[124:127], a[128:131], v[236:239]
    ds_read_b128 a[80:83], v20 offset:64
    v_mfma_f32_16x16x32_bf16 v[236:239], a[120:123], a[132:135], v[236:239]
    ds_read2_b32 a[64:65], v16 offset0:144 offset1:145
    v_mfma_f32_16x16x32_bf16 v[236:239], a[116:119], a[136:139], v[236:239]
    v_cvt_pk_bf16_f32 v220, v208, v212
    ds_read2_b32 a[66:67], v16 offset0:146 offset1:147
    buffer_load_dwordx4 v[176:179], v8, s[32:35], s66 offen offset:2048 sc1
    v_mfma_f32_16x16x32_bf16 v[236:239], a[112:115], a[140:143], v[236:239]
    ds_read_b128 a[84:87], v20 offset:576
    v_mfma_f32_16x16x32_bf16 v[240:243], a[124:127], a[132:135], v[240:243]
    ds_read2_b32 a[68:69], v16 offset0:16 offset1:17
    buffer_load_dword v24, v28, s[32:35], s12 offen sc1
    v_mfma_f32_16x16x32_bf16 v[240:243], a[120:123], a[136:139], v[240:243]
    v_cvt_pk_bf16_f32 v221, v209, v213
    ds_read2_b32 a[70:71], v16 offset0:18 offset1:19
    v_mfma_f32_16x16x32_bf16 v[240:243], a[116:119], a[140:143], v[240:243]
    ds_read_b128 a[88:91], v20 offset:1088
    buffer_load_dwordx4 v[180:183], v8, s[32:35], s66 offen offset:3072 sc1
    v_mfma_f32_16x16x32_bf16 v[240:243], a[112:115], a[144:147], v[240:243]
    ds_read2_b32 a[72:73], v17 offset0:144 offset1:145
    s_add_u32 s66, s66, 4096
    v_mfma_f32_16x16x32_bf16 v[244:247], a[124:127], a[136:139], v[244:247]
    v_cvt_pk_bf16_f32 v222, v210, v214
    ds_read2_b32 a[74:75], v17 offset0:146 offset1:147
    v_mfma_f32_16x16x32_bf16 v[244:247], a[120:123], a[140:143], v[244:247]
    ds_read_b128 a[92:95], v20 offset:1600
    buffer_load_dwordx4 v[184:187], v8, s[32:35], s66 offen offset:0 sc1
    v_mfma_f32_16x16x32_bf16 v[244:247], a[116:119], a[144:147], v[244:247]
    ds_read2_b32 a[76:77], v17 offset0:16 offset1:17
    s_add_u32 s66, s55, 245760
    v_mfma_f32_16x16x32_bf16 v[244:247], a[112:115], a[148:151], v[244:247]
    s_or_b32 s66, s66, s57
    v_cvt_pk_bf16_f32 v223, v211, v215
    ds_read2_b32 a[78:79], v17 offset0:18 offset1:19
    v_mfma_f32_16x16x32_bf16 v[248:251], a[124:127], a[140:143], v[248:251]
    ds_read_b128 a[96:99], v20 offset:2112
    v_mfma_f32_16x16x32_bf16 v[248:251], a[120:123], a[144:147], v[248:251]
    s_waitcnt lgkmcnt(13)
    ds_read_b128 a[100:103], v20 offset:2624
    v_mfma_f32_16x16x32_bf16 v[248:251], a[116:119], a[148:151], v[248:251]
    ds_read_b128 a[104:107], v20 offset:3136
    buffer_load_dwordx4 v[188:191], v8, s[32:35], s66 offen offset:0 sc1
    v_mfma_f32_16x16x32_bf16 v[248:251], a[112:115], a[152:155], v[248:251]
    ds_read_b128 a[108:111], v20 offset:3648
    s_waitcnt vmcnt(13)
    s_mov_b64 exec, 1
    buffer_store_dword v25, off, s[32:35], s61 sc1
    s_mov_b64 exec, -1
    s_mov_b64 exec, 1
    buffer_store_dword v25, off, s[32:35], s18 sc1
    s_mov_b64 exec, -1
    v_mfma_f32_16x16x32_bf16 v[252:255], a[124:127], a[144:147], v[252:255]
    v_mfma_f32_16x16x32_bf16 v[252:255], a[120:123], a[148:151], v[252:255]
    v_mfma_f32_16x16x32_bf16 v[240:243], v[216:219], a[180:183], v[240:243]
    v_mfma_f32_16x16x32_bf16 v[244:247], v[216:219], a[184:187], v[244:247]
    buffer_load_dwordx4 v[192:195], v8, s[32:35], s66 offen offset:1024 sc1
    v_mfma_f32_16x16x32_bf16 v[248:251], v[216:219], a[188:191], v[248:251]
    v_mfma_f32_16x16x32_bf16 v[252:255], v[216:219], a[60:63], v[252:255]
    v_mfma_f32_16x16x32_bf16 v[252:255], a[116:119], a[152:155], v[252:255]
    v_mfma_f32_16x16x32_bf16 v[252:255], a[112:115], a[156:159], v[252:255]
    s_waitcnt lgkmcnt(4)
    buffer_load_dwordx4 v[196:199], v8, s[32:35], s66 offen offset:2048 sc1
    v_mfma_f32_16x16x32_bf16 v[224:227], a[64:67], a[80:83], v[224:227]
    ds_read_b128 a[128:131], v20 offset:0
    v_mfma_f32_16x16x32_bf16 v[228:231], a[68:71], a[80:83], v[228:231]
    ds_read2_b32 a[112:113], v16 offset0:128 offset1:129
    v_mfma_f32_16x16x32_bf16 v[228:231], a[64:67], a[84:87], v[228:231]
    ds_read2_b32 a[114:115], v16 offset0:130 offset1:131
    v_mfma_f32_16x16x32_bf16 v[232:235], a[72:75], a[80:83], v[232:235]
    buffer_load_dwordx4 v[200:203], v8, s[32:35], s66 offen offset:3072 sc1
    s_add_u32 s66, s66, 4096
    v_mfma_f32_16x16x32_bf16 v[248:251], v[220:223], a[180:183], v[248:251]
    ds_read_b128 a[132:135], v20 offset:512
    v_mfma_f32_16x16x32_bf16 v[252:255], v[220:223], a[184:187], v[252:255]
    ds_read2_b32 a[116:117], v16 offset0:0 offset1:1
    v_mfma_f32_16x16x32_bf16 v[232:235], a[68:71], a[84:87], v[232:235]
    ds_read2_b32 a[118:119], v16 offset0:2 offset1:3
    v_mfma_f32_16x16x32_bf16 v[232:235], a[64:67], a[88:91], v[232:235]
    s_waitcnt lgkmcnt(6)
    buffer_load_dwordx4 v[204:207], v8, s[32:35], s66 offen offset:0 sc1
    v_mfma_f32_16x16x32_bf16 v[236:239], a[76:79], a[80:83], v[236:239]
    ds_read_b128 a[136:139], v20 offset:1024
    v_mfma_f32_16x16x32_bf16 v[236:239], a[72:75], a[84:87], v[236:239]
    ds_read2_b32 a[120:121], v17 offset0:128 offset1:129
    v_mfma_f32_16x16x32_bf16 v[236:239], a[68:71], a[88:91], v[236:239]
    ds_read2_b32 a[122:123], v17 offset0:130 offset1:131
    v_mfma_f32_16x16x32_bf16 v[236:239], a[64:67], a[92:95], v[236:239]
    v_mfma_f32_16x16x32_bf16 v[240:243], a[76:79], a[84:87], v[240:243]
    ds_read_b128 a[140:143], v20 offset:1536
    v_mfma_f32_16x16x32_bf16 v[240:243], a[72:75], a[88:91], v[240:243]
    ds_read2_b32 a[124:125], v17 offset0:0 offset1:1
    v_mfma_f32_16x16x32_bf16 v[240:243], a[68:71], a[92:95], v[240:243]
    ds_read2_b32 a[126:127], v17 offset0:2 offset1:3
    v_mfma_f32_16x16x32_bf16 v[240:243], a[64:67], a[96:99], v[240:243]
    v_mfma_f32_16x16x32_bf16 v[244:247], a[76:79], a[88:91], v[244:247]
    ds_read_b128 a[144:147], v20 offset:2048
    v_mfma_f32_16x16x32_bf16 v[244:247], a[72:75], a[92:95], v[244:247]
    ds_read_b128 a[148:151], v20 offset:2560
    v_mfma_f32_16x16x32_bf16 v[244:247], a[68:71], a[96:99], v[244:247]
    ds_read_b128 a[152:155], v20 offset:3072
    v_mfma_f32_16x16x32_bf16 v[244:247], a[64:67], a[100:103], v[244:247]
    s_waitcnt vmcnt(9)
    v_cmp_ne_u32 vcc, v25, v24
    s_cbranch_vccnz c4_slow
c4_ok:
    v_mfma_f32_16x16x32_bf16 v[248:251], a[76:79], a[92:95], v[248:251]
    ds_read_b128 a[156:159], v20 offset:3584
    buffer_load_dwordx4 a[160:163], v10, s[32:35], s52 offen sc1
    v_mfma_f32_16x16x32_bf16 v[248:251], a[72:75], a[96:99], v[248:251]
    v_mfma_f32_16x16x32_bf16 v[248:251], a[68:71], a[100:103], v[248:251]
    v_mfma_f32_16x16x32_bf16 v[248:251], a[64:67], a[104:107], v[248:251]
    v_mfma_f32_16x16x32_bf16 v[252:255], a[76:79], a[96:99], v[252:255]
    buffer_load_dwordx4 a[164:167], v11, s[32:35], s52 offen sc1
    v_mfma_f32_16x16x32_bf16 v[252:255], a[72:75], a[100:103], v[252:255]
    v_mfma_f32_16x16x32_bf16 v[252:255], a[68:71], a[104:107], v[252:255]
    v_mfma_f32_16x16x32_bf16 v[252:255], a[64:67], a[108:111], v[252:255]
    s_waitcnt lgkmcnt(0)
    v_mfma_f32_16x16x32_bf16 v[224:227], a[112:115], a[128:131], v[224:227]
    buffer_load_dwordx4 a[168:171], v12, s[32:35], s52 offen sc1
    v_mfma_f32_16x16x32_bf16 v[228:231], a[116:119], a[128:131], v[228:231]
    v_mfma_f32_16x16x32_bf16 v[228:231], a[112:115], a[132:135], v[228:231]
    v_mfma_f32_16x16x32_bf16 v[232:235], a[120:123], a[128:131], v[232:235]
    v_mfma_f32_16x16x32_bf16 v[232:235], a[116:119], a[132:135], v[232:235]
    buffer_load_dwordx4 a[172:175], v13, s[32:35], s52 offen sc1
    s_add_u32 s67, s52, 32768
    v_mfma_f32_16x16x32_bf16 v[232:235], a[112:115], a[136:139], v[232:235]
    ds_write_b128 v21, v[224:227] offset:0
    v_mfma_f32_16x16x32_bf16 v[236:239], a[124:127], a[128:131], v[236:239]
    v_mfma_f32_16x16x32_bf16 v[236:239], a[120:123], a[132:135], v[236:239]
    buffer_load_dwordx4 a[176:179], v10, s[32:35], s67 offen sc1
    s_add_u32 s67, s52, 65536
    v_mfma_f32_16x16x32_bf16 v[236:239], a[116:119], a[136:139], v[236:239]
    ds_write_b128 v21, v[228:231] offset:1280
    v_mfma_f32_16x16x32_bf16 v[236:239], a[112:115], a[140:143], v[236:239]
    v_mfma_f32_16x16x32_bf16 v[240:243], a[124:127], a[132:135], v[240:243]
    buffer_load_dwordx4 a[252:255], v10, s[32:35], s67 offen sc1
    s_add_u32 s67, s52, 32768
    v_mfma_f32_16x16x32_bf16 v[240:243], a[120:123], a[136:139], v[240:243]
    ds_write_b128 v21, v[232:235] offset:2560
    v_mfma_f32_16x16x32_bf16 v[240:243], a[116:119], a[140:143], v[240:243]
    v_mfma_f32_16x16x32_bf16 v[240:243], a[112:115], a[144:147], v[240:243]
    buffer_load_dwordx4 a[180:183], v11, s[32:35], s67 offen sc1
    s_add_u32 s67, s52, 65536
    v_mfma_f32_16x16x32_bf16 v[244:247], a[124:127], a[136:139], v[244:247]
    ds_write_b128 v21, v[236:239] offset:3840
    v_mfma_f32_16x16x32_bf16 v[244:247], a[120:123], a[140:143], v[244:247]
    v_mfma_f32_16x16x32_bf16 v[244:247], a[116:119], a[144:147], v[244:247]
    v_mfma_f32_16x16x32_bf16 v[244:247], a[112:115], a[148:151], v[244:247]
    buffer_load_dwordx4 a[184:187], v11, s[32:35], s67 offen sc1
    s_add_u32 s67, s52, 32768
    v_mfma_f32_16x16x32_bf16 v[248:251], a[124:127], a[140:143], v[248:251]
    ds_write_b128 v21, v[240:243] offset:5120
    v_mfma_f32_16x16x32_bf16 v[248:251], a[120:123], a[144:147], v[248:251]
    v_mfma_f32_16x16x32_bf16 v[248:251], a[116:119], a[148:151], v[248:251]
    buffer_load_dwordx4 a[188:191], v12, s[32:35], s67 offen sc1
    s_add_u32 s67, s52, 65536
    v_mfma_f32_16x16x32_bf16 v[248:251], a[112:115], a[152:155], v[248:251]
    v_mfma_f32_16x16x32_bf16 v[252:255], a[124:127], a[144:147], v[252:255]
    ds_write_b128 v21, v[244:247] offset:6400
    v_mfma_f32_16x16x32_bf16 v[252:255], a[120:123], a[148:151], v[252:255]
    buffer_load_dwordx4 a[60:63], v12, s[32:35], s67 offen sc1
    s_add_u32 s67, s52, 32768
    v_mfma_f32_16x16x32_bf16 v[252:255], a[116:119], a[152:155], v[252:255]
    v_mfma_f32_16x16x32_bf16 v[252:255], a[112:115], a[156:159], v[252:255]
    s_nop 0
    ds_write_b128 v21, v[248:251] offset:7680
    buffer_load_dwordx4 a[64:67], v13, s[32:35], s67 offen sc1
    s_nop 4
    ds_write_b128 v21, v[252:255] offset:8960
    s_waitcnt lgkmcnt(0)
    s_barrier
    s_add_u32 s67, s52, 65536
    buffer_load_dwordx4 a[68:71], v13, s[32:35], s67 offen sc1
    ds_read_b128 v[224:227], v22 offset:0
    ds_read_b128 v[228:231], v22 offset:10240
    ds_read_b128 v[232:235], v22 offset:20480
    ds_read_b128 v[236:239], v22 offset:30720
    ds_read_b128 v[240:243], v22 offset:1280
    ds_read_b128 v[244:247], v22 offset:11520
    ds_read_b128 v[248:251], v22 offset:21760
    ds_read_b128 v[252:255], v22 offset:32000
    s_add_u32 s67, s52, 98304
    buffer_load_dwordx4 a[72:75], v10, s[32:35], s67 offen sc1
    s_waitcnt lgkmcnt(6)
    v_pk_add_f32 v[224:225], v[224:225], v[228:229]
    v_pk_add_f32 v[226:227], v[226:227], v[230:231]
    s_waitcnt lgkmcnt(4)
    v_pk_add_f32 v[232:233], v[232:233], v[236:237]
    v_pk_add_f32 v[234:235], v[234:235], v[238:239]
    v_cvt_pk_bf16_f32 v40, v224, v232
    v_cvt_pk_bf16_f32 v41, v225, v233
    v_cvt_pk_bf16_f32 v42, v226, v234
    v_cvt_pk_bf16_f32 v43, v227, v235
    buffer_store_dwordx4 v[40:43], v8, s[32:35], s69 offen sc1
    s_waitcnt lgkmcnt(2)
    v_pk_add_f32 v[240:241], v[240:241], v[244:245]
    v_pk_add_f32 v[242:243], v[242:243], v[246:247]
    s_waitcnt lgkmcnt(0)
    v_pk_add_f32 v[248:249], v[248:249], v[252:253]
    v_pk_add_f32 v[250:251], v[250:251], v[254:255]
    v_cvt_pk_bf16_f32 v44, v240, v248
    v_cvt_pk_bf16_f32 v45, v241, v249
    v_cvt_pk_bf16_f32 v46, v242, v250
    v_cvt_pk_bf16_f32 v47, v243, v251
    buffer_store_dwordx4 v[44:47], v8, s[32:35], s11 offen sc1
    s_waitcnt vmcnt(14)
    v_mfma_f32_16x16x32_bf16 a[112:115], v[48:51], a[160:163], 0
    s_add_u32 s67, s52, 131072
    v_min_u32 v28, s71, v1
    v_lshlrev_b32 v28, 6, v28
    v_mfma_f32_16x16x32_bf16 a[116:119], v[52:55], a[160:163], 0
    v_mfma_f32_16x16x32_bf16 a[120:123], v[56:59], a[160:163], 0
    v_mfma_f32_16x16x32_bf16 a[124:127], v[60:63], a[160:163], 0
    v_mfma_f32_16x16x32_bf16 a[128:131], v[64:67], a[160:163], 0
    s_waitcnt vmcnt(13)
    v_mfma_f32_16x16x32_bf16 a[132:135], v[48:51], a[164:167], 0
    v_mfma_f32_16x16x32_bf16 a[136:139], v[52:55], a[164:167], 0
    v_mfma_f32_16x16x32_bf16 a[140:143], v[56:59], a[164:167], 0
    v_mfma_f32_16x16x32_bf16 a[144:147], v[60:63], a[164:167], 0
    v_mfma_f32_16x16x32_bf16 a[148:151], v[64:67], a[164:167], 0
    s_waitcnt vmcnt(12)
    v_mfma_f32_16x16x32_bf16 v[216:219], v[48:51], a[168:171], 0
    buffer_load_dwordx4 a[76:79], v10, s[32:35], s67 offen sc1
    s_add_u32 s67, s52, 98304
    v_mfma_f32_16x16x32_bf16 v[220:223], v[52:55], a[168:171], 0
    v_mfma_f32_16x16x32_bf16 v[224:227], v[56:59], a[168:171], 0
    v_mfma_f32_16x16x32_bf16 v[228:231], v[60:63], a[168:171], 0
    v_mfma_f32_16x16x32_bf16 v[232:235], v[64:67], a[168:171], 0
    s_waitcnt vmcnt(12)
    v_mfma_f32_16x16x32_bf16 v[236:239], v[48:51], a[172:175], 0
    buffer_load_dwordx4 a[80:83], v11, s[32:35], s67 offen sc1
    s_add_u32 s67, s52, 131072
    v_mfma_f32_16x16x32_bf16 v[240:243], v[52:55], a[172:175], 0
    v_mfma_f32_16x16x32_bf16 v[244:247], v[56:59], a[172:175], 0
    v_mfma_f32_16x16x32_bf16 v[248:251], v[60:63], a[172:175], 0
    v_mfma_f32_16x16x32_bf16 v[252:255], v[64:67], a[172:175], 0
    s_waitcnt vmcnt(11)
    v_mfma_f32_16x16x32_bf16 a[112:115], v[68:71], a[176:179], a[112:115]
    buffer_load_dwordx4 a[84:87], v11, s[32:35], s67 offen sc1
    s_add_u32 s67, s52, 98304
    v_mfma_f32_16x16x32_bf16 a[112:115], a[192:195], a[252:255], a[112:115]
    v_mfma_f32_16x16x32_bf16 a[116:119], v[72:75], a[176:179], a[116:119]
    v_mfma_f32_16x16x32_bf16 a[116:119], a[196:199], a[252:255], a[116:119]
    v_mfma_f32_16x16x32_bf16 a[120:123], v[76:79], a[176:179], a[120:123]
    v_mfma_f32_16x16x32_bf16 a[120:123], a[200:203], a[252:255], a[120:123]
    buffer_load_dwordx4 a[88:91], v12, s[32:35], s67 offen sc1
    buffer_load_dword v24, v28, s[32:35], s13 offen sc1
    v_mfma_f32_16x16x32_bf16 a[124:127], v[80:83], a[176:179], a[124:127]
    s_add_u32 s67, s52, 131072
    v_mfma_f32_16x16x32_bf16 a[124:127], a[204:207], a[252:255], a[124:127]
    v_mfma_f32_16x16x32_bf16 a[128:131], v[84:87], a[176:179], a[128:131]
    v_mfma_f32_16x16x32_bf16 a[128:131], a[208:211], a[252:255], a[128:131]
    s_waitcnt vmcnt(12)
    v_mfma_f32_16x16x32_bf16 a[132:135], v[68:71], a[180:183], a[132:135]
    v_mfma_f32_16x16x32_bf16 a[132:135], a[192:195], a[184:187], a[132:135]
    buffer_load_dwordx4 a[92:95], v12, s[32:35], s67 offen sc1
    s_add_u32 s67, s52, 98304
    v_mfma_f32_16x16x32_bf16 a[136:139], v[72:75], a[180:183], a[136:139]
    v_mfma_f32_16x16x32_bf16 a[136:139], a[196:199], a[184:187], a[136:139]
    v_mfma_f32_16x16x32_bf16 a[140:143], v[76:79], a[180:183], a[140:143]
    v_mfma_f32_16x16x32_bf16 a[140:143], a[200:203], a[184:187], a[140:143]
    v_mfma_f32_16x16x32_bf16 a[144:147], v[80:83], a[180:183], a[144:147]
    buffer_load_dwordx4 a[96:99], v13, s[32:35], s67 offen sc1
    s_add_u32 s67, s52, 131072
    v_mfma_f32_16x16x32_bf16 a[144:147], a[204:207], a[184:187], a[144:147]
    v_mfma_f32_16x16x32_bf16 a[148:151], v[84:87], a[180:183], a[148:151]
    v_mfma_f32_16x16x32_bf16 a[148:151], a[208:211], a[184:187], a[148:151]
    s_waitcnt vmcnt(12)
    v_mfma_f32_16x16x32_bf16 v[216:219], v[68:71], a[188:191], v[216:219]
    v_mfma_f32_16x16x32_bf16 v[216:219], a[192:195], a[60:63], v[216:219]
    buffer_load_dwordx4 a[100:103], v13, s[32:35], s67 offen sc1
    s_add_u32 s67, s52, 163840
    v_mfma_f32_16x16x32_bf16 v[220:223], v[72:75], a[188:191], v[220:223]
    v_mfma_f32_16x16x32_bf16 v[220:223], a[196:199], a[60:63], v[220:223]
    v_mfma_f32_16x16x32_bf16 v[224:227], v[76:79], a[188:191], v[224:227]
    v_mfma_f32_16x16x32_bf16 v[224:227], a[200:203], a[60:63], v[224:227]
    v_mfma_f32_16x16x32_bf16 v[228:231], v[80:83], a[188:191], v[228:231]
    buffer_load_dwordx4 a[104:107], v10, s[32:35], s67 offen sc1
    v_mfma_f32_16x16x32_bf16 v[228:231], a[204:207], a[60:63], v[228:231]
    s_waitcnt vmcnt(9)
    s_mov_b64 exec, 1
    buffer_store_dword v25, off, s[32:35], s19 sc1
    s_mov_b64 exec, -1
    v_mfma_f32_16x16x32_bf16 v[232:235], v[84:87], a[188:191], v[232:235]
    v_mfma_f32_16x16x32_bf16 v[232:235], a[208:211], a[60:63], v[232:235]
    v_mfma_f32_16x16x32_bf16 v[236:239], v[68:71], a[64:67], v[236:239]
    v_mfma_f32_16x16x32_bf16 v[236:239], a[192:195], a[68:71], v[236:239]
    v_mfma_f32_16x16x32_bf16 v[240:243], v[72:75], a[64:67], v[240:243]
    buffer_load_dwordx4 a[108:111], v10, s[32:35], s22 offen sc1
    s_add_u32 s67, s52, 163840
    v_mfma_f32_16x16x32_bf16 v[240:243], a[196:199], a[68:71], v[240:243]
    v_mfma_f32_16x16x32_bf16 v[244:247], v[76:79], a[64:67], v[244:247]
    v_mfma_f32_16x16x32_bf16 v[244:247], a[200:203], a[68:71], v[244:247]
    v_mfma_f32_16x16x32_bf16 v[248:251], v[80:83], a[64:67], v[248:251]
    v_mfma_f32_16x16x32_bf16 v[248:251], a[204:207], a[68:71], v[248:251]
    buffer_load_dwordx4 a[152:155], v11, s[32:35], s67 offen sc1
    v_mfma_f32_16x16x32_bf16 v[252:255], v[84:87], a[64:67], v[252:255]
    v_mfma_f32_16x16x32_bf16 v[252:255], a[208:211], a[68:71], v[252:255]
    s_waitcnt vmcnt(11)
    v_mfma_f32_16x16x32_bf16 a[112:115], a[212:215], a[72:75], a[112:115]
    v_mfma_f32_16x16x32_bf16 a[112:115], a[232:235], a[76:79], a[112:115]
    v_mfma_f32_16x16x32_bf16 a[116:119], a[216:219], a[72:75], a[116:119]
    buffer_load_dwordx4 a[156:159], v11, s[32:35], s22 offen sc1
    s_add_u32 s67, s52, 163840
    v_mfma_f32_16x16x32_bf16 a[116:119], a[236:239], a[76:79], a[116:119]
    v_mfma_f32_16x16x32_bf16 a[120:123], a[220:223], a[72:75], a[120:123]
    v_mfma_f32_16x16x32_bf16 a[120:123], a[240:243], a[76:79], a[120:123]
    v_mfma_f32_16x16x32_bf16 a[124:127], a[224:227], a[72:75], a[124:127]
    v_mfma_f32_16x16x32_bf16 a[124:127], a[244:247], a[76:79], a[124:127]
    buffer_load_dwordx4 a[160:163], v12, s[32:35], s67 offen sc1
    v_mfma_f32_16x16x32_bf16 a[128:131], a[228:231], a[72:75], a[128:131]
    v_mfma_f32_16x16x32_bf16 a[128:131], a[248:251], a[76:79], a[128:131]
    s_waitcnt vmcnt(11)
    v_mfma_f32_16x16x32_bf16 a[132:135], a[212:215], a[80:83], a[132:135]
    v_mfma_f32_16x16x32_bf16 a[132:135], a[232:235], a[84:87], a[132:135]
    v_mfma_f32_16x16x32_bf16 a[136:139], a[216:219], a[80:83], a[136:139]
    buffer_load_dwordx4 a[164:167], v12, s[32:35], s22 offen sc1
    s_add_u32 s67, s52, 163840
    v_mfma_f32_16x16x32_bf16 a[136:139], a[236:239], a[84:87], a[136:139]
    v_mfma_f32_16x16x32_bf16 a[140:143], a[220:223], a[80:83], a[140:143]
    v_mfma_f32_16x16x32_bf16 a[140:143], a[240:243], a[84:87], a[140:143]
    v_mfma_f32_16x16x32_bf16 a[144:147], a[224:227], a[80:83], a[144:147]
    v_mfma_f32_16x16x32_bf16 a[144:147], a[244:247], a[84:87], a[144:147]
    buffer_load_dwordx4 a[168:171], v13, s[32:35], s67 offen sc1
    v_mfma_f32_16x16x32_bf16 a[148:151], a[228:231], a[80:83], a[148:151]
    v_mfma_f32_16x16x32_bf16 a[148:151], a[248:251], a[84:87], a[148:151]
    s_waitcnt vmcnt(10)
    v_mfma_f32_16x16x32_bf16 v[216:219], a[212:215], a[88:91], v[216:219]
    v_mfma_f32_16x16x32_bf16 v[216:219], a[232:235], a[92:95], v[216:219]
    v_mfma_f32_16x16x32_bf16 v[220:223], a[216:219], a[88:91], v[220:223]
    buffer_load_dwordx4 a[172:175], v13, s[32:35], s22 offen sc1
    v_mfma_f32_16x16x32_bf16 v[220:223], a[236:239], a[92:95], v[220:223]
    v_cmp_ne_u32 vcc, v25, v24
    s_cbranch_vccnz c5_slow
c5_ok:
    v_mfma_f32_16x16x32_bf16 v[224:227], a[220:223], a[88:91], v[224:227]
    v_min_u32 v28, 39, v1
    v_lshlrev_b32 v28, 5, v28
    v_mfma_f32_16x16x32_bf16 v[224:227], a[240:243], a[92:95], v[224:227]
    v_mfma_f32_16x16x32_bf16 v[228:231], a[224:227], a[88:91], v[228:231]
    v_mfma_f32_16x16x32_bf16 v[228:231], a[244:247], a[92:95], v[228:231]
    buffer_load_dwordx4 a[176:179], v10, s[32:35], s53 offen sc1
    s_add_u32 s67, s53, 32768
    v_mfma_f32_16x16x32_bf16 v[232:235], a[228:231], a[88:91], v[232:235]
    v_mfma_f32_16x16x32_bf16 v[232:235], a[248:251], a[92:95], v[232:235]
    s_waitcnt vmcnt(10)
    v_mfma_f32_16x16x32_bf16 v[236:239], a[212:215], a[96:99], v[236:239]
    v_mfma_f32_16x16x32_bf16 v[236:239], a[232:235], a[100:103], v[236:239]
    v_mfma_f32_16x16x32_bf16 v[240:243], a[216:219], a[96:99], v[240:243]
    buffer_load_dwordx4 a[252:255], v10, s[32:35], s67 offen sc1
    s_add_u32 s67, s53, 65536
    v_mfma_f32_16x16x32_bf16 v[240:243], a[236:239], a[100:103], v[240:243]
    v_mfma_f32_16x16x32_bf16 v[244:247], a[220:223], a[96:99], v[244:247]
    v_mfma_f32_16x16x32_bf16 v[244:247], a[240:243], a[100:103], v[244:247]
    v_mfma_f32_16x16x32_bf16 v[248:251], a[224:227], a[96:99], v[248:251]
    v_mfma_f32_16x16x32_bf16 v[248:251], a[244:247], a[100:103], v[248:251]
    buffer_load_dwordx4 a[180:183], v10, s[32:35], s67 offen sc1
    s_add_u32 s67, s53, 98304
    v_mfma_f32_16x16x32_bf16 v[252:255], a[228:231], a[96:99], v[252:255]
    v_mfma_f32_16x16x32_bf16 v[252:255], a[248:251], a[100:103], v[252:255]
    s_waitcnt vmcnt(9)
    v_mfma_f32_16x16x32_bf16 a[112:115], v[88:91], a[104:107], a[112:115]
    v_mfma_f32_16x16x32_bf16 a[112:115], v[108:111], a[108:111], a[112:115]
    v_mfma_f32_16x16x32_bf16 a[116:119], v[92:95], a[104:107], a[116:119]
    buffer_load_dwordx4 a[184:187], v10, s[32:35], s67 offen sc1
    s_add_u32 s67, s53, 131072
    v_mfma_f32_16x16x32_bf16 a[116:119], v[112:115], a[108:111], a[116:119]
    v_mfma_f32_16x16x32_bf16 a[120:123], v[96:99], a[104:107], a[120:123]
    v_mfma_f32_16x16x32_bf16 a[120:123], v[116:119], a[108:111], a[120:123]
    v_mfma_f32_16x16x32_bf16 a[124:127], v[100:103], a[104:107], a[124:127]
    v_mfma_f32_16x16x32_bf16 a[124:127], v[120:123], a[108:111], a[124:127]
    buffer_load_dwordx4 a[188:191], v10, s[32:35], s67 offen sc1
    s_add_u32 s67, s53, 163840
    v_mfma_f32_16x16x32_bf16 a[128:131], v[104:107], a[104:107], a[128:131]
    v_mfma_f32_16x16x32_bf16 a[128:131], v[124:127], a[108:111], a[128:131]
    s_waitcnt vmcnt(9)
    v_mfma_f32_16x16x32_bf16 a[132:135], v[88:91], a[152:155], a[132:135]
    v_mfma_f32_16x16x32_bf16 a[132:135], v[108:111], a[156:159], a[132:135]
    v_mfma_f32_16x16x32_bf16 a[136:139], v[92:95], a[152:155], a[136:139]
    buffer_load_dwordx4 a[60:63], v10, s[32:35], s67 offen sc1
    v_mfma_f32_16x16x32_bf16 a[136:139], v[112:115], a[156:159], a[136:139]
    v_mfma_f32_16x16x32_bf16 a[140:143], v[96:99], a[152:155], a[140:143]
    v_mfma_f32_16x16x32_bf16 a[140:143], v[116:119], a[156:159], a[140:143]
    v_mfma_f32_16x16x32_bf16 a[144:147], v[100:103], a[152:155], a[144:147]
    v_mfma_f32_16x16x32_bf16 a[144:147], v[120:123], a[156:159], a[144:147]
    buffer_load_dwordx4 a[192:195], v10, s[32:35], s23 offen sc1
    v_mfma_f32_16x16x32_bf16 a[148:151], v[104:107], a[152:155], a[148:151]
    v_mfma_f32_16x16x32_bf16 a[148:151], v[124:127], a[156:159], a[148:151]
    s_waitcnt vmcnt(9)
    v_mfma_f32_16x16x32_bf16 v[216:219], v[88:91], a[160:163], v[216:219]
    v_mfma_f32_16x16x32_bf16 v[216:219], v[108:111], a[164:167], v[216:219]
    v_mfma_f32_16x16x32_bf16 v[220:223], v[92:95], a[160:163], v[220:223]
    buffer_load_dwordx4 a[196:199], v11, s[32:35], s53 offen sc1
    s_add_u32 s67, s53, 32768
    v_mfma_f32_16x16x32_bf16 v[220:223], v[112:115], a[164:167], v[220:223]
    v_mfma_f32_16x16x32_bf16 v[224:227], v[96:99], a[160:163], v[224:227]
    v_mfma_f32_16x16x32_bf16 v[224:227], v[116:119], a[164:167], v[224:227]
    v_mfma_f32_16x16x32_bf16 v[228:231], v[100:103], a[160:163], v[228:231]
    v_mfma_f32_16x16x32_bf16 v[228:231], v[120:123], a[164:167], v[228:231]
    buffer_load_dwordx4 a[200:203], v11, s[32:35], s67 offen sc1
    s_add_u32 s67, s53, 65536
    v_mfma_f32_16x16x32_bf16 v[232:235], v[104:107], a[160:163], v[232:235]
    v_mfma_f32_16x16x32_bf16 v[232:235], v[124:127], a[164:167], v[232:235]
    s_waitcnt vmcnt(9)
    v_mfma_f32_16x16x32_bf16 v[236:239], v[88:91], a[168:171], v[236:239]
    v_mfma_f32_16x16x32_bf16 v[236:239], v[108:111], a[172:175], v[236:239]
    v_mfma_f32_16x16x32_bf16 v[240:243], v[92:95], a[168:171], v[240:243]
    buffer_load_dwordx4 a[204:207], v11, s[32:35], s67 offen sc1
    s_add_u32 s67, s53, 98304
    v_mfma_f32_16x16x32_bf16 v[240:243], v[112:115], a[172:175], v[240:243]
    v_mfma_f32_16x16x32_bf16 v[244:247], v[96:99], a[168:171], v[244:247]
    v_mfma_f32_16x16x32_bf16 v[244:247], v[116:119], a[172:175], v[244:247]
    v_mfma_f32_16x16x32_bf16 v[248:251], v[100:103], a[168:171], v[248:251]
    v_mfma_f32_16x16x32_bf16 v[248:251], v[120:123], a[172:175], v[248:251]
    buffer_load_dwordx4 a[208:211], v11, s[32:35], s67 offen sc1
    s_add_u32 s67, s53, 131072
    v_mfma_f32_16x16x32_bf16 v[252:255], v[104:107], a[168:171], v[252:255]
    v_mfma_f32_16x16x32_bf16 v[252:255], v[124:127], a[172:175], v[252:255]
    s_waitcnt vmcnt(9)
    v_mfma_f32_16x16x32_bf16 a[112:115], a[0:3], a[176:179], a[112:115]
    v_mfma_f32_16x16x32_bf16 a[112:115], a[20:23], a[252:255], a[112:115]
    v_mfma_f32_16x16x32_bf16 a[116:119], a[4:7], a[176:179], a[116:119]
    buffer_load_dwordx4 a[64:67], v11, s[32:35], s67 offen sc1
    s_add_u32 s67, s53, 163840
    v_mfma_f32_16x16x32_bf16 a[116:119], a[24:27], a[252:255], a[116:119]
    v_mfma_f32_16x16x32_bf16 a[120:123], a[8:11], a[176:179], a[120:123]
    v_mfma_f32_16x16x32_bf16 a[120:123], a[28:31], a[252:255], a[120:123]
    v_mfma_f32_16x16x32_bf16 a[124:127], a[12:15], a[176:179], a[124:127]
    v_mfma_f32_16x16x32_bf16 a[124:127], a[32:35], a[252:255], a[124:127]
    buffer_load_dwordx4 a[68:71], v11, s[32:35], s67 offen sc1
    v_mfma_f32_16x16x32_bf16 a[128:131], a[16:19], a[176:179], a[128:131]
    v_mfma_f32_16x16x32_bf16 a[128:131], a[36:39], a[252:255], a[128:131]
    s_waitcnt vmcnt(9)
    v_mfma_f32_16x16x32_bf16 a[112:115], a[40:43], a[180:183], a[112:115]
    buffer_load_dword v24, v28, s[32:35], s14 offen sc1
    v_mfma_f32_16x16x32_bf16 a[112:115], v[128:131], a[184:187], a[112:115]
    v_mfma_f32_16x16x32_bf16 a[116:119], a[44:47], a[180:183], a[116:119]
    v_mfma_f32_16x16x32_bf16 a[116:119], v[132:135], a[184:187], a[116:119]
    buffer_load_dwordx4 a[72:75], v11, s[32:35], s23 offen sc1
    v_mfma_f32_16x16x32_bf16 a[120:123], a[48:51], a[180:183], a[120:123]
    v_lshlrev_b32 v88, 16, v30
    v_and_b32 v89, 0xffff0000, v30
    v_mfma_f32_16x16x32_bf16 a[120:123], v[136:139], a[184:187], a[120:123]
    v_lshlrev_b32 v90, 16, v31
    v_and_b32 v91, 0xffff0000, v31
    v_mfma_f32_16x16x32_bf16 a[124:127], a[52:55], a[180:183], a[124:127]
    v_lshlrev_b32 v92, 16, v32
    v_and_b32 v93, 0xffff0000, v32
    v_mfma_f32_16x16x32_bf16 a[124:127], v[140:143], a[184:187], a[124:127]
    v_lshlrev_b32 v94, 16, v33
    v_and_b32 v95, 0xffff0000, v33
    v_mfma_f32_16x16x32_bf16 a[128:131], a[56:59], a[180:183], a[128:131]
    buffer_load_dwordx4 a[76:79], v12, s[32:35], s53 offen sc1
    v_lshlrev_b32 v96, 16, v34
    v_mfma_f32_16x16x32_bf16 a[128:131], v[144:147], a[184:187], a[128:131]
    s_waitcnt vmcnt(9)
    s_add_u32 s67, s53, 32768
    v_and_b32 v97, 0xffff0000, v34
    v_mfma_f32_16x16x32_bf16 a[112:115], v[148:151], a[188:191], a[112:115]
    v_lshlrev_b32 v98, 16, v35
    v_and_b32 v99, 0xffff0000, v35
    v_mfma_f32_16x16x32_bf16 a[112:115], v[168:171], a[60:63], a[112:115]
    v_lshlrev_b32 v100, 16, v36
    v_and_b32 v101, 0xffff0000, v36
    v_mfma_f32_16x16x32_bf16 a[112:115], v[188:191], a[192:195], a[112:115]
    v_lshlrev_b32 v102, 16, v37
    v_and_b32 v103, 0xffff0000, v37
    v_mfma_f32_16x16x32_bf16 a[116:119], v[152:155], a[188:191], a[116:119]
    buffer_load_dwordx4 a[80:83], v12, s[32:35], s67 offen sc1
    v_lshlrev_b32 v104, 16, v38
    v_mfma_f32_16x16x32_bf16 a[116:119], v[172:175], a[60:63], a[116:119]
    s_add_u32 s67, s53, 65536
    v_and_b32 v105, 0xffff0000, v38
    v_lshlrev_b32 v106, 16, v39
    v_mfma_f32_16x16x32_bf16 a[116:119], v[192:195], a[192:195], a[116:119]
    v_and_b32 v107, 0xffff0000, v39
    v_mfma_f32_16x16x32_bf16 a[120:123], v[156:159], a[188:191], a[120:123]
    v_mfma_f32_16x16x32_bf16 a[120:123], v[176:179], a[60:63], a[120:123]
    v_mfma_f32_16x16x32_bf16 a[120:123], v[196:199], a[192:195], a[120:123]
    buffer_load_dwordx4 a[84:87], v12, s[32:35], s67 offen sc1
    s_add_u32 s67, s53, 98304
    v_mfma_f32_16x16x32_bf16 a[124:127], v[160:163], a[188:191], a[124:127]
    ds_write_b128 v10, a[112:115] offset:0
    v_mfma_f32_16x16x32_bf16 a[124:127], v[180:183], a[60:63], a[124:127]
    v_mfma_f32_16x16x32_bf16 a[124:127], v[200:203], a[192:195], a[124:127]
    v_mfma_f32_16x16x32_bf16 a[128:131], v[164:167], a[188:191], a[128:131]
    buffer_load_dwordx4 a[88:91], v12, s[32:35], s67 offen sc1
    s_add_u32 s67, s53, 131072
    v_mfma_f32_16x16x32_bf16 a[128:131], v[184:187], a[60:63], a[128:131]
    ds_write_b128 v10, a[116:119] offset:4096
    v_mfma_f32_16x16x32_bf16 a[128:131], v[204:207], a[192:195], a[128:131]
    s_waitcnt vmcnt(10)
    v_mfma_f32_16x16x32_bf16 a[132:135], a[0:3], a[196:199], a[132:135]
    v_mfma_f32_16x16x32_bf16 a[132:135], a[20:23], a[200:203], a[132:135]
    buffer_load_dwordx4 a[92:95], v12, s[32:35], s67 offen sc1
    s_add_u32 s67, s53, 163840
    v_mfma_f32_16x16x32_bf16 a[136:139], a[4:7], a[196:199], a[136:139]
    ds_write_b128 v10, a[120:123] offset:8192
    v_mfma_f32_16x16x32_bf16 a[136:139], a[24:27], a[200:203], a[136:139]
    v_mfma_f32_16x16x32_bf16 a[140:143], a[8:11], a[196:199], a[140:143]
    v_mfma_f32_16x16x32_bf16 a[140:143], a[28:31], a[200:203], a[140:143]
    buffer_load_dwordx4 a[212:215], v12, s[32:35], s67 offen sc1
    v_mfma_f32_16x16x32_bf16 a[144:147], a[12:15], a[196:199], a[144:147]
    ds_write_b128 v10, a[124:127] offset:12288
    v_mfma_f32_16x16x32_bf16 a[144:147], a[32:35], a[200:203], a[144:147]
    v_mfma_f32_16x16x32_bf16 a[148:151], a[16:19], a[196:199], a[148:151]
    v_mfma_f32_16x16x32_bf16 a[148:151], a[36:39], a[200:203], a[148:151]
    s_waitcnt vmcnt(10)
    buffer_load_dwordx4 a[216:219], v12, s[32:35], s23 offen sc1
    v_mfma_f32_16x16x32_bf16 a[132:135], a[40:43], a[204:207], a[132:135]
    ds_write_b128 v10, a[128:131] offset:16384
    v_mfma_f32_16x16x32_bf16 a[132:135], v[128:131], a[208:211], a[132:135]
    v_mfma_f32_16x16x32_bf16 a[136:139], a[44:47], a[204:207], a[136:139]
    v_mfma_f32_16x16x32_bf16 a[136:139], v[132:135], a[208:211], a[136:139]
    buffer_load_dwordx4 a[220:223], v13, s[32:35], s53 offen sc1
    s_add_u32 s67, s53, 32768
    v_mfma_f32_16x16x32_bf16 a[140:143], a[48:51], a[204:207], a[140:143]
    v_mfma_f32_16x16x32_bf16 a[140:143], v[136:139], a[208:211], a[140:143]
    v_mfma_f32_16x16x32_bf16 a[144:147], a[52:55], a[204:207], a[144:147]
    v_mfma_f32_16x16x32_bf16 a[144:147], v[140:143], a[208:211], a[144:147]
    v_mfma_f32_16x16x32_bf16 a[148:151], a[56:59], a[204:207], a[148:151]
    buffer_load_dwordx4 a[224:227], v13, s[32:35], s67 offen sc1
    s_add_u32 s67, s53, 65536
    v_mfma_f32_16x16x32_bf16 a[148:151], v[144:147], a[208:211], a[148:151]
    s_waitcnt vmcnt(9)
    v_mfma_f32_16x16x32_bf16 a[132:135], v[148:151], a[64:67], a[132:135]
    v_mfma_f32_16x16x32_bf16 a[132:135], v[168:171], a[68:71], a[132:135]
    v_mfma_f32_16x16x32_bf16 a[132:135], v[188:191], a[72:75], a[132:135]
    v_mfma_f32_16x16x32_bf16 a[136:139], v[152:155], a[64:67], a[136:139]
    buffer_load_dwordx4 a[228:231], v13, s[32:35], s67 offen sc1
    s_add_u32 s67, s53, 98304
    v_mfma_f32_16x16x32_bf16 a[136:139], v[172:175], a[68:71], a[136:139]
    v_mfma_f32_16x16x32_bf16 a[136:139], v[192:195], a[72:75], a[136:139]
    v_mfma_f32_16x16x32_bf16 a[140:143], v[156:159], a[64:67], a[140:143]
    v_mfma_f32_16x16x32_bf16 a[140:143], v[176:179], a[68:71], a[140:143]
    v_mfma_f32_16x16x32_bf16 a[140:143], v[196:199], a[72:75], a[140:143]
    buffer_load_dwordx4 a[232:235], v13, s[32:35], s67 offen sc1
    s_add_u32 s67, s53, 131072
    v_mfma_f32_16x16x32_bf16 a[144:147], v[160:163], a[64:67], a[144:147]
    ds_write_b128 v11, a[132:135] offset:20480
    v_mfma_f32_16x16x32_bf16 a[144:147], v[180:183], a[68:71], a[144:147]
    v_mfma_f32_16x16x32_bf16 a[144:147], v[200:203], a[72:75], a[144:147]
    v_mfma_f32_16x16x32_bf16 a[148:151], v[164:167], a[64:67], a[148:151]
    buffer_load_dwordx4 a[236:239], v13, s[32:35], s67 offen sc1
    s_add_u32 s67, s53, 163840
    v_mfma_f32_16x16x32_bf16 a[148:151], v[184:187], a[68:71], a[148:151]
    ds_write_b128 v11, a[136:139] offset:24576
    v_mfma_f32_16x16x32_bf16 a[148:151], v[204:207], a[72:75], a[148:151]
    s_waitcnt vmcnt(10)
    v_cmp_ne_u32 vcc, v25, v24
    s_cbranch_vccnz c6_slow
c6_ok:
    v_mfma_f32_16x16x32_bf16 v[216:219], a[0:3], a[76:79], v[216:219]
    buffer_load_dword v14, v27, s[32:35], s10 offen offset:0 sc1
    s_add_u32 s10, s10, 8192
    v_mfma_f32_16x16x32_bf16 v[216:219], a[20:23], a[80:83], v[216:219]
    ds_write_b128 v11, a[140:143] offset:28672
    v_mfma_f32_16x16x32_bf16 v[220:223], a[4:7], a[76:79], v[220:223]
    buffer_load_dwordx4 a[240:243], v13, s[32:35], s67 offen sc1
    buffer_load_dword v15, v27, s[32:35], s10 offen offset:0 sc1
    v_mfma_f32_16x16x32_bf16 v[220:223], a[24:27], a[80:83], v[220:223]
    s_add_u32 s10, s10, 8192
    buffer_load_dword v16, v27, s[32:35], s10 offen offset:0 sc1
    v_mfma_f32_16x16x32_bf16 v[224:227], a[8:11], a[76:79], v[224:227]
    ds_write_b128 v11, a[144:147] offset:32768
    v_mfma_f32_16x16x32_bf16 v[224:227], a[28:31], a[80:83], v[224:227]
    s_add_u32 s10, s10, 8192
    buffer_load_dword v17, v27, s[32:35], s10 offen offset:0 sc1
    v_mfma_f32_16x16x32_bf16 v[228:231], a[12:15], a[76:79], v[228:231]
    s_add_u32 s10, s10, 8192
    buffer_load_dword v18, v27, s[32:35], s10 offen offset:0 sc1
    v_mfma_f32_16x16x32_bf16 v[228:231], a[32:35], a[80:83], v[228:231]
    ds_write_b128 v11, a[148:151] offset:36864
    v_mfma_f32_16x16x32_bf16 v[232:235], a[16:19], a[76:79], v[232:235]
    s_add_u32 s10, s10, 8192
    buffer_load_dword v19, v27, s[32:35], s10 offen offset:0 sc1
    v_mfma_f32_16x16x32_bf16 v[232:235], a[36:39], a[80:83], v[232:235]
    s_waitcnt vmcnt(15)
    s_add_u32 s10, s10, 8192
    v_mfma_f32_16x16x32_bf16 v[216:219], a[40:43], a[84:87], v[216:219]
    buffer_load_dword v20, v27, s[32:35], s10 offen offset:0 sc1
    s_add_u32 s10, s10, 8192
    v_mfma_f32_16x16x32_bf16 v[216:219], v[128:131], a[88:91], v[216:219]
    s_waitcnt lgkmcnt(0)
    s_barrier
    v_mfma_f32_16x16x32_bf16 v[220:223], a[44:47], a[84:87], v[220:223]
    ds_read_b128 v[48:51], v13 offset:0
    buffer_load_dword v21, v27, s[32:35], s10 offen offset:0 sc1
    v_mfma_f32_16x16x32_bf16 v[220:223], v[132:135], a[88:91], v[220:223]
    ds_read_b128 v[52:55], v13 offset:4096
    s_add_u32 s10, s10, 8192
    v_mfma_f32_16x16x32_bf16 v[224:227], a[48:51], a[84:87], v[224:227]
    ds_read_b128 v[56:59], v13 offset:8192
    buffer_load_dword v22, v27, s[32:35], s10 offen offset:0 sc1
    v_mfma_f32_16x16x32_bf16 v[224:227], v[136:139], a[88:91], v[224:227]
    ds_read_b128 v[60:63], v13 offset:12288
    s_add_u32 s10, s10, 8192
    v_mfma_f32_16x16x32_bf16 v[228:231], a[52:55], a[84:87], v[228:231]
    ds_read_b128 v[64:67], v13 offset:16384
    buffer_load_dword v23, v27, s[32:35], s10 offen offset:0 sc1
    v_mfma_f32_16x16x32_bf16 v[228:231], v[140:143], a[88:91], v[228:231]
    ds_read_b128 v[68:71], v13 offset:20480
    ds_read_b128 v[72:75], v13 offset:24576
    v_mfma_f32_16x16x32_bf16 v[232:235], a[56:59], a[84:87], v[232:235]
    ds_read_b128 v[76:79], v13 offset:28672
    ds_read_b128 v[80:83], v13 offset:32768
    v_mfma_f32_16x16x32_bf16 v[232:235], v[144:147], a[88:91], v[232:235]
    s_waitcnt vmcnt(16)
    ds_read_b128 v[84:87], v13 offset:36864
    v_mfma_f32_16x16x32_bf16 v[216:219], v[148:151], a[92:95], v[216:219]
    buffer_load_dwordx4 a[244:247], v13, s[32:35], s23 offen sc1
    v_mfma_f32_16x16x32_bf16 v[216:219], v[168:171], a[212:215], v[216:219]
    v_mfma_f32_16x16x32_bf16 v[216:219], v[188:191], a[216:219], v[216:219]
    v_mfma_f32_16x16x32_bf16 v[220:223], v[152:155], a[92:95], v[220:223]
    v_mfma_f32_16x16x32_bf16 v[220:223], v[172:175], a[212:215], v[220:223]
    v_mfma_f32_16x16x32_bf16 v[220:223], v[192:195], a[216:219], v[220:223]
    s_waitcnt lgkmcnt(4)
    v_add_f32 v48, v48, v68
    v_add_f32 v49, v49, v69
    v_mfma_f32_16x16x32_bf16 v[224:227], v[156:159], a[92:95], v[224:227]
    v_add_f32 v50, v50, v70
    v_add_f32 v51, v51, v71
    v_mfma_f32_16x16x32_bf16 v[224:227], v[176:179], a[212:215], v[224:227]
    s_waitcnt lgkmcnt(3)
    v_add_f32 v52, v52, v72
    v_add_f32 v53, v53, v73
    v_mfma_f32_16x16x32_bf16 v[224:227], v[196:199], a[216:219], v[224:227]
    ds_write_b128 v12, v[216:219] offset:40960
    v_mfma_f32_16x16x32_bf16 v[228:231], v[160:163], a[92:95], v[228:231]
    v_add_f32 v54, v54, v74
    v_add_f32 v55, v55, v75
    v_mfma_f32_16x16x32_bf16 v[228:231], v[180:183], a[212:215], v[228:231]
    s_waitcnt lgkmcnt(3)
    v_add_f32 v56, v56, v76
    v_add_f32 v57, v57, v77
    v_mfma_f32_16x16x32_bf16 v[228:231], v[200:203], a[216:219], v[228:231]
    ds_write_b128 v12, v[220:223] offset:45056
    v_mfma_f32_16x16x32_bf16 v[232:235], v[164:167], a[92:95], v[232:235]
    v_add_f32 v58, v58, v78
    v_add_f32 v59, v59, v79
    v_mfma_f32_16x16x32_bf16 v[232:235], v[184:187], a[212:215], v[232:235]
    s_waitcnt lgkmcnt(3)
    v_add_f32 v60, v60, v80
    v_add_f32 v61, v61, v81
    v_mfma_f32_16x16x32_bf16 v[232:235], v[204:207], a[216:219], v[232:235]
    s_waitcnt vmcnt(15)
    v_add_f32 v62, v62, v82
    v_add_f32 v63, v63, v83
    v_mfma_f32_16x16x32_bf16 v[236:239], a[0:3], a[220:223], v[236:239]
    ds_write_b128 v12, v[224:227] offset:49152
    v_mfma_f32_16x16x32_bf16 v[236:239], a[20:23], a[224:227], v[236:239]
    s_waitcnt lgkmcnt(3)
    v_add_f32 v64, v64, v84
    v_add_f32 v65, v65, v85
    v_mfma_f32_16x16x32_bf16 v[240:243], a[4:7], a[220:223], v[240:243]
    v_add_f32 v66, v66, v86
    v_add_f32 v67, v67, v87
    v_mfma_f32_16x16x32_bf16 v[240:243], a[24:27], a[224:227], v[240:243]
    ds_write_b128 v12, v[228:231] offset:53248
    v_mfma_f32_16x16x32_bf16 v[244:247], a[8:11], a[220:223], v[244:247]
    v_mfma_f32_16x16x32_bf16 v[244:247], a[28:31], a[224:227], v[244:247]
    v_mfma_f32_16x16x32_bf16 v[248:251], a[12:15], a[220:223], v[248:251]
    ds_write_b128 v12, v[232:235] offset:57344
    v_mfma_f32_16x16x32_bf16 v[248:251], a[32:35], a[224:227], v[248:251]
    v_mfma_f32_16x16x32_bf16 v[252:255], a[16:19], a[220:223], v[252:255]
    v_mfma_f32_16x16x32_bf16 v[252:255], a[36:39], a[224:227], v[252:255]
    s_waitcnt vmcnt(13)
    v_mfma_f32_16x16x32_bf16 v[236:239], a[40:43], a[228:231], v[236:239]
    s_waitcnt lgkmcnt(0)
    s_barrier
    v_mfma_f32_16x16x32_bf16 v[236:239], v[128:131], a[232:235], v[236:239]
    ds_read_b128 v[216:219], v13 offset:40960
    ds_read_b128 v[220:223], v13 offset:45056
    v_mfma_f32_16x16x32_bf16 v[240:243], a[44:47], a[228:231], v[240:243]
    ds_read_b128 v[224:227], v13 offset:49152
    ds_read_b128 v[228:231], v13 offset:53248
    v_mfma_f32_16x16x32_bf16 v[240:243], v[132:135], a[232:235], v[240:243]
    ds_read_b128 v[232:235], v13 offset:57344
    v_mfma_f32_16x16x32_bf16 v[244:247], a[48:51], a[228:231], v[244:247]
    v_mfma_f32_16x16x32_bf16 v[244:247], v[136:139], a[232:235], v[244:247]
    v_mfma_f32_16x16x32_bf16 v[248:251], a[52:55], a[228:231], v[248:251]
    v_mfma_f32_16x16x32_bf16 v[248:251], v[140:143], a[232:235], v[248:251]
    v_mfma_f32_16x16x32_bf16 v[252:255], a[56:59], a[228:231], v[252:255]
    v_mfma_f32_16x16x32_bf16 v[252:255], v[144:147], a[232:235], v[252:255]
    s_waitcnt vmcnt(0)
    s_waitcnt lgkmcnt(4)
    v_add_f32 v48, v48, v216
    v_add_f32 v49, v49, v217
    v_mfma_f32_16x16x32_bf16 v[236:239], v[148:151], a[236:239], v[236:239]
    v_add_f32 v50, v50, v218
    v_add_f32 v51, v51, v219
    v_mfma_f32_16x16x32_bf16 v[236:239], v[168:171], a[240:243], v[236:239]
    s_waitcnt lgkmcnt(3)
    v_add_f32 v52, v52, v220
    v_add_f32 v53, v53, v221
    v_mfma_f32_16x16x32_bf16 v[236:239], v[188:191], a[244:247], v[236:239]
    v_add_f32 v54, v54, v222
    v_add_f32 v55, v55, v223
    v_mfma_f32_16x16x32_bf16 v[240:243], v[152:155], a[236:239], v[240:243]
    s_waitcnt lgkmcnt(2)
    v_add_f32 v56, v56, v224
    v_add_f32 v57, v57, v225
    v_mfma_f32_16x16x32_bf16 v[240:243], v[172:175], a[240:243], v[240:243]
    v_add_f32 v58, v58, v226
    v_add_f32 v59, v59, v227
    v_mfma_f32_16x16x32_bf16 v[240:243], v[192:195], a[244:247], v[240:243]
    s_waitcnt lgkmcnt(1)
    v_add_f32 v60, v60, v228
    v_add_f32 v61, v61, v229
    v_mfma_f32_16x16x32_bf16 v[244:247], v[156:159], a[236:239], v[244:247]
    v_add_f32 v62, v62, v230
    v_add_f32 v63, v63, v231
    v_mfma_f32_16x16x32_bf16 v[244:247], v[176:179], a[240:243], v[244:247]
    s_waitcnt lgkmcnt(0)
    v_add_f32 v64, v64, v232
    v_add_f32 v65, v65, v233
    v_mfma_f32_16x16x32_bf16 v[244:247], v[196:199], a[244:247], v[244:247]
    v_add_f32 v66, v66, v234
    v_add_f32 v67, v67, v235
    v_mfma_f32_16x16x32_bf16 v[248:251], v[160:163], a[236:239], v[248:251]
    v_mfma_f32_16x16x32_bf16 v[248:251], v[180:183], a[240:243], v[248:251]
    v_mfma_f32_16x16x32_bf16 v[248:251], v[200:203], a[244:247], v[248:251]
    v_lshlrev_b32 v108, 16, v14
    v_and_b32 v109, 0xffff0000, v14
    v_mfma_f32_16x16x32_bf16 v[252:255], v[164:167], a[236:239], v[252:255]
    v_lshlrev_b32 v110, 16, v15
    v_and_b32 v111, 0xffff0000, v15
    v_mfma_f32_16x16x32_bf16 v[252:255], v[184:187], a[240:243], v[252:255]
    v_lshlrev_b32 v112, 16, v16
    v_and_b32 v113, 0xffff0000, v16
    v_mfma_f32_16x16x32_bf16 v[252:255], v[204:207], a[244:247], v[252:255]
    v_lshlrev_b32 v114, 16, v17
    v_and_b32 v115, 0xffff0000, v17
    v_lshlrev_b32 v116, 16, v18
    v_and_b32 v117, 0xffff0000, v18
    v_lshlrev_b32 v118, 16, v19
    v_and_b32 v119, 0xffff0000, v19
    v_lshlrev_b32 v120, 16, v20
    v_and_b32 v121, 0xffff0000, v20
    v_lshlrev_b32 v122, 16, v21
    v_and_b32 v123, 0xffff0000, v21
    v_lshlrev_b32 v124, 16, v22
    v_and_b32 v125, 0xffff0000, v22
    v_lshlrev_b32 v126, 16, v23
    v_and_b32 v127, 0xffff0000, v23
    v_pk_add_f32 v[236:237], v[236:237], v[48:49]
    v_pk_add_f32 v[238:239], v[238:239], v[50:51]
    v_pk_add_f32 v[240:241], v[240:241], v[52:53]
    v_pk_add_f32 v[242:243], v[242:243], v[54:55]
    v_pk_mul_f32 v[48:49], v[236:237], s[62:63]
    v_pk_mul_f32 v[50:51], v[238:239], s[62:63]
    v_pk_mul_f32 v[52:53], v[240:241], s[62:63]
    v_pk_mul_f32 v[54:55], v[242:243], s[62:63]
    v_exp_f32 v48, v48
    v_exp_f32 v49, v49
    v_exp_f32 v50, v50
    v_exp_f32 v51, v51
    v_exp_f32 v52, v52
    v_exp_f32 v53, v53
    v_exp_f32 v54, v54
    v_exp_f32 v55, v55
    v_pk_add_f32 v[48:49], v[48:49], 1.0 op_sel_hi:[1,0]
    v_pk_add_f32 v[50:51], v[50:51], 1.0 op_sel_hi:[1,0]
    v_pk_add_f32 v[52:53], v[52:53], 1.0 op_sel_hi:[1,0]
    v_pk_add_f32 v[54:55], v[54:55], 1.0 op_sel_hi:[1,0]
    v_rcp_f32 v48, v48
    v_rcp_f32 v49, v49
    v_rcp_f32 v50, v50
    v_rcp_f32 v51, v51
    v_rcp_f32 v52, v52
    v_rcp_f32 v53, v53
    v_rcp_f32 v54, v54
    v_rcp_f32 v55, v55
    v_pk_add_f32 v[244:245], v[244:245], v[56:57]
    v_pk_add_f32 v[246:247], v[246:247], v[58:59]
    v_pk_add_f32 v[248:249], v[248:249], v[60:61]
    v_pk_add_f32 v[250:251], v[250:251], v[62:63]
    v_pk_mul_f32 v[56:57], v[244:245], s[62:63]
    v_pk_mul_f32 v[58:59], v[246:247], s[62:63]
    v_pk_mul_f32 v[60:61], v[248:249], s[62:63]
    v_pk_mul_f32 v[62:63], v[250:251], s[62:63]
    v_exp_f32 v56, v56
    v_exp_f32 v57, v57
    v_exp_f32 v58, v58
    v_exp_f32 v59, v59
    v_exp_f32 v60, v60
    v_exp_f32 v61, v61
    v_exp_f32 v62, v62
    v_exp_f32 v63, v63
    v_pk_add_f32 v[56:57], v[56:57], 1.0 op_sel_hi:[1,0]
    v_pk_add_f32 v[58:59], v[58:59], 1.0 op_sel_hi:[1,0]
    v_pk_add_f32 v[60:61], v[60:61], 1.0 op_sel_hi:[1,0]
    v_pk_add_f32 v[62:63], v[62:63], 1.0 op_sel_hi:[1,0]
    v_rcp_f32 v56, v56
    v_rcp_f32 v57, v57
    v_rcp_f32 v58, v58
    v_rcp_f32 v59, v59
    v_rcp_f32 v60, v60
    v_rcp_f32 v61, v61
    v_rcp_f32 v62, v62
    v_rcp_f32 v63, v63
    v_pk_add_f32 v[252:253], v[252:253], v[64:65]
    v_pk_add_f32 v[254:255], v[254:255], v[66:67]
    v_pk_mul_f32 v[64:65], v[252:253], s[62:63]
    v_pk_mul_f32 v[66:67], v[254:255], s[62:63]
    v_exp_f32 v64, v64
    v_exp_f32 v65, v65
    v_exp_f32 v66, v66
    v_exp_f32 v67, v67
    v_pk_add_f32 v[64:65], v[64:65], 1.0 op_sel_hi:[1,0]
    v_pk_add_f32 v[66:67], v[66:67], 1.0 op_sel_hi:[1,0]
    v_rcp_f32 v64, v64
    v_rcp_f32 v65, v65
    v_rcp_f32 v66, v66
    v_rcp_f32 v67, v67
    v_pk_mul_f32 v[236:237], v[236:237], v[48:49]
    v_pk_mul_f32 v[238:239], v[238:239], v[50:51]
    v_pk_mul_f32 v[240:241], v[240:241], v[52:53]
    v_pk_mul_f32 v[242:243], v[242:243], v[54:55]
    v_pk_fma_f32 v[236:237], v[236:237], v[108:109], v[88:89]
    v_pk_fma_f32 v[238:239], v[238:239], v[110:111], v[90:91]
    v_pk_fma_f32 v[240:241], v[240:241], v[112:113], v[92:93]
    v_pk_fma_f32 v[242:243], v[242:243], v[114:115], v[94:95]
    v_cvt_pk_bf16_f32 v30, v236, v237
    v_cvt_pk_bf16_f32 v31, v238, v239
    v_cvt_pk_bf16_f32 v32, v240, v241
    v_cvt_pk_bf16_f32 v33, v242, v243
    ds_write_b64 v26, v[30:31] offset:0
    ds_write_b64 v26, v[32:33] offset:8
    v_pk_mul_f32 v[244:245], v[244:245], v[56:57]
    v_pk_mul_f32 v[246:247], v[246:247], v[58:59]
    v_pk_mul_f32 v[248:249], v[248:249], v[60:61]
    v_pk_mul_f32 v[250:251], v[250:251], v[62:63]
    v_pk_fma_f32 v[244:245], v[244:245], v[116:117], v[96:97]
    v_pk_fma_f32 v[246:247], v[246:247], v[118:119], v[98:99]
    v_pk_fma_f32 v[248:249], v[248:249], v[120:121], v[100:101]
    v_pk_fma_f32 v[250:251], v[250:251], v[122:123], v[102:103]
    v_cvt_pk_bf16_f32 v34, v244, v245
    v_cvt_pk_bf16_f32 v35, v246, v247
    v_cvt_pk_bf16_f32 v36, v248, v249
    v_cvt_pk_bf16_f32 v37, v250, v251
    ds_write_b64 v26, v[34:35] offset:16
    ds_write_b64 v26, v[36:37] offset:24
    v_pk_mul_f32 v[252:253], v[252:253], v[64:65]
    v_pk_mul_f32 v[254:255], v[254:255], v[66:67]
    v_pk_fma_f32 v[252:253], v[252:253], v[124:125], v[104:105]
    v_pk_fma_f32 v[254:255], v[254:255], v[126:127], v[106:107]
    v_cvt_pk_bf16_f32 v38, v252, v253
    v_cvt_pk_bf16_f32 v39, v254, v255
    ds_write_b64 v26, v[38:39] offset:32
    ds_read_b128 v[48:51], v5
    ds_read_b128 v[52:55], v6
    ds_read_b128 v[56:59], v7
    s_waitcnt lgkmcnt(2)
    global_store_dwordx4 v2, v[48:51], s[26:27]
    s_waitcnt lgkmcnt(1)
    global_store_dwordx4 v3, v[52:55], s[26:27]
    s_mov_b64 exec, 0xffffffff
    s_waitcnt lgkmcnt(0)
    global_store_dwordx4 v4, v[56:59], s[26:27]
    s_endpgm
role_spare:
    global_load_dwordx4 v[100:103], v2, s[4:5]
    global_load_dwordx4 v[104:107], v3, s[4:5]
    global_load_dwordx4 v[108:111], v4, s[4:5]
    s_and_b32 s72, s41, 3
    s_mov_b32 s73, s40
    s_cmp_ge_u32 s41, 28
    s_cselect_b32 s42, 1, 0
    s_mul_i32 s74, s72, 6
    s_add_u32 s74, s74, s40
    s_cmp_lt_u32 s74, 8
    s_cselect_b32 s42, 0, 1
    s_cmp_ge_u32 s40, 6
    s_cselect_b32 s42, 1, s42
    s_lshl2_add_u32 s74, s40, s41
    s_sub_u32 s74, s74, 48
    s_cmp_ge_u32 s74, 6
    s_cselect_b32 s75, 1, 0
    s_cselect_b32 s76, 6, 0
    s_sub_u32 s74, s74, s76
    s_cmp_lt_u32 s41, 28
    s_cselect_b32 s72, s75, s72
    s_cselect_b32 s73, s74, s73
    s_lshr_b32 s74, s72, 1
    s_lshl3_add_u32 s73, s74, s73
    s_add_u32 s73, s73, 64
    s_lshl_b32 s73, s73, 2
    s_and_b32 s72, s72, 1
    s_lshl1_add_u32 s82, s72, s73
    s_lshl_b32 s72, s82, 9
    s_lshl_b32 s73, s3, 8
    s_add_u32 s72, s72, s73
    v_lshl_add_u32 v7, v1, 1, s72
    global_load_ushort v56, v7, s[6:7] offset:0
    global_load_ushort v57, v7, s[8:9] offset:0
    global_load_ushort v58, v7, s[10:11] offset:0
    global_load_ushort v59, v7, s[12:13] offset:0
    global_load_ushort v60, v7, s[6:7] offset:128
    global_load_ushort v61, v7, s[8:9] offset:128
    global_load_ushort v62, v7, s[10:11] offset:128
    global_load_ushort v63, v7, s[12:13] offset:128
    s_lshl_b32 s72, s82, 2
    s_lshr_b32 s73, s3, 1
    s_lshl_b32 s73, s73, 2
    s_add_u32 s73, s73, s72
    s_load_dword s79, s[14:15], s73
    s_load_dwordx2 s[80:81], s[16:17], s72
    s_mov_b32 s36, s24
    s_mov_b32 s37, s25
    s_sub_u32 s72, s41, 27
    s_lshl3_add_u32 s64, s72, s40
    s_lshl2_add_u32 s72, s40, s41
    s_sub_u32 s72, s72, 48
    s_cmp_ge_u32 s41, 28
    s_cselect_b32 s64, s64, s72
    s_lshl_b32 s59, s3, 10
    v_add_u32 v6, 0, v0
    v_mul_u32_u24 v7, 1561, v6
    v_lshrrev_b32 v7, 16, v7
    v_mul_u32_u24 v7, 608, v7
    v_lshl_add_u32 v80, v6, 4, v7
    v_add_u32 v6, 256, v0
    v_mul_u32_u24 v7, 1561, v6
    v_lshrrev_b32 v7, 16, v7
    v_mul_u32_u24 v7, 608, v7
    v_lshl_add_u32 v81, v6, 4, v7
    v_add_u32 v6, 512, v0
    v_mul_u32_u24 v7, 1561, v6
    v_lshrrev_b32 v7, 16, v7
    v_mul_u32_u24 v7, 608, v7
    v_lshl_add_u32 v82, v6, 4, v7
    v_add_u32 v6, 768, v0
    v_mul_u32_u24 v7, 1561, v6
    v_lshrrev_b32 v7, 16, v7
    v_mul_u32_u24 v7, 608, v7
    v_lshl_add_u32 v83, v6, 4, v7
    v_add_u32 v6, 1024, v0
    v_mul_u32_u24 v7, 1561, v6
    v_lshrrev_b32 v7, 16, v7
    v_mul_u32_u24 v7, 608, v7
    v_lshl_add_u32 v84, v6, 4, v7
    v_add_u32 v6, 1280, v0
    v_mul_u32_u24 v7, 1561, v6
    v_lshrrev_b32 v7, 16, v7
    v_mul_u32_u24 v7, 608, v7
    v_lshl_add_u32 v85, v6, 4, v7
    s_cmp_eq_u32 s3, 0
    s_cselect_b32 s72, 0, 134217728
    v_add_u32 v85, s72, v85
    v_lshrrev_b32 v4, 2, v1
    v_mul_u32_u24 v4, 672, v4
    v_and_b32 v5, 3, v1
    v_mul_u32_u24 v5, 40, v5
    s_mul_i32 s73, s3, 160
    v_add3_u32 v86, v4, v5, s73
    s_bitcmp1_b32 s3, 1
    s_cselect_b32 s76, 0, 16
    s_lshl_b32 s77, s48, s76
    s_and_b32 s77, s77, 0xffff0000
    s_mov_b32 m0, s83
    v_mov_b32 v6, 0x3fb8aa3b
    v_mul_f32 v7, s77, v6
    s_add_u32 s75, s64, 0
    s_lshr_b32 s66, s75, 1
    s_mul_i32 s66, s66, 39680
    s_mul_i32 s75, s75, 640
    s_add_u32 s66, s66, s75
    s_add_u32 m0, s59, 65536
    s_nop 0
    buffer_load_dwordx4 v80, s[36:39], s66 offen lds
    s_mov_b32 m0, s83
    s_waitcnt vmcnt(26)
    v_lshlrev_b32 v52, 16, v52
    v_exp_f32 v7, v7
    v_mul_f32 v52, v52, v6
    s_waitcnt vmcnt(25)
    v_lshlrev_b32 v53, 16, v53
    v_exp_f32 v52, v52
    v_cvt_pk_bf16_f32 v7, v7, v7
    s_waitcnt vmcnt(24)
    v_lshlrev_b32 v54, 16, v54
    s_add_u32 m0, s59, 69632
    s_nop 0
    buffer_load_dwordx4 v81, s[36:39], s66 offen lds
    s_mov_b32 m0, s83
    v_lshlrev_b32 v7, 16, v7
    v_cvt_pk_bf16_f32 v52, v52, v52
    s_waitcnt vmcnt(24)
    v_lshlrev_b32 v55, 16, v55
    v_lshlrev_b32 v52, 16, v52
    v_mul_f32 v53, v53, v7
    v_mul_f32 v52, v52, v7
    v_add_f32 v7, v7, v7
    v_mul_f32 v53, 0.15915494, v53
    v_mul_f32 v52, 0xbfb8aa3b, v52
    v_mul_f32 v192, v54, v7
    v_mul_f32 v193, v55, v7
    v_mul_f32 v186, 0x41000000, v52
    v_mul_f32 v187, 0x41000000, v53
    v_mul_f32 v188, 0x42800000, v52
    v_mul_f32 v189, 0x42800000, v53
    v_mul_f32 v190, 0x43800000, v52
    v_mul_f32 v191, 0x43800000, v53
    v_fract_f32 v185, v53
    v_fract_f32 v187, v187
    v_fract_f32 v189, v189
    v_fract_f32 v191, v191
    v_exp_f32 v184, v52
    v_cos_f32 v176, v185
    v_sin_f32 v177, v185
    v_exp_f32 v186, v186
    v_cos_f32 v178, v187
    v_sin_f32 v179, v187
    v_exp_f32 v188, v188
    v_cos_f32 v180, v189
    v_sin_f32 v181, v189
    v_exp_f32 v190, v190
    v_cos_f32 v182, v191
    v_sin_f32 v183, v191
    v_mov_b32 v212, 1.0
    v_mov_b32 v213, 0
    v_pk_mul_f32 v[176:177], v[176:177], v[184:185] op_sel_hi:[1,0]
    v_pk_mul_f32 v[178:179], v[178:179], v[186:187] op_sel_hi:[1,0]
    v_pk_mul_f32 v[180:181], v[180:181], v[188:189] op_sel_hi:[1,0]
    v_pk_mul_f32 v[182:183], v[182:183], v[190:191] op_sel_hi:[1,0]
    v_cvt_pk_bf16_f32 v236, v192, -v193
    v_cvt_pk_bf16_f32 v240, v212, v213
    v_pk_mul_f32 v[228:229], v[192:193], v[176:177] op_sel_hi:[0,1]
    v_cvt_pk_bf16_f32 v241, v178, v179
    ds_write_addtid_b32 v236 offset:0
    ds_write_addtid_b32 v240 offset:7616
    v_pk_fma_f32 v[194:195], v[192:193], v[176:177], v[228:229] op_sel:[1,1,0] op_sel_hi:[1,0,1] neg_lo:[1,0,0]
    v_pk_mul_f32 v[232:233], v[178:179], v[178:179] op_sel_hi:[0,1]
    v_cvt_pk_bf16_f32 v237, v194, -v195
    v_pk_fma_f32 v[216:217], v[178:179], v[178:179], v[232:233] op_sel:[1,1,0] op_sel_hi:[1,0,1] neg_lo:[1,0,0]
    v_pk_mul_f32 v[230:231], v[194:195], v[176:177] op_sel_hi:[0,1]
    v_cvt_pk_bf16_f32 v242, v216, v217
    ds_write_addtid_b32 v241 offset:7888
    ds_write_addtid_b32 v237 offset:272
    v_pk_fma_f32 v[196:197], v[194:195], v[176:177], v[230:231] op_sel:[1,1,0] op_sel_hi:[1,0,1] neg_lo:[1,0,0]
    v_pk_mul_f32 v[234:235], v[216:217], v[178:179] op_sel_hi:[0,1]
    v_cvt_pk_bf16_f32 v238, v196, -v197
    v_pk_fma_f32 v[218:219], v[216:217], v[178:179], v[234:235] op_sel:[1,1,0] op_sel_hi:[1,0,1] neg_lo:[1,0,0]
    v_pk_mul_f32 v[228:229], v[196:197], v[176:177] op_sel_hi:[0,1]
    v_cvt_pk_bf16_f32 v243, v218, v219
    ds_write_addtid_b32 v242 offset:8160
    ds_write_addtid_b32 v238 offset:544
    v_pk_fma_f32 v[198:199], v[196:197], v[176:177], v[228:229] op_sel:[1,1,0] op_sel_hi:[1,0,1] neg_lo:[1,0,0]
    v_pk_mul_f32 v[232:233], v[218:219], v[178:179] op_sel_hi:[0,1]
    v_cvt_pk_bf16_f32 v239, v198, -v199
    v_pk_fma_f32 v[220:221], v[218:219], v[178:179], v[232:233] op_sel:[1,1,0] op_sel_hi:[1,0,1] neg_lo:[1,0,0]
    v_pk_mul_f32 v[230:231], v[198:199], v[176:177] op_sel_hi:[0,1]
    v_cvt_pk_bf16_f32 v240, v220, v221
    ds_write_addtid_b32 v243 offset:8432
    ds_write_addtid_b32 v239 offset:816
    v_pk_fma_f32 v[200:201], v[198:199], v[176:177], v[230:231] op_sel:[1,1,0] op_sel_hi:[1,0,1] neg_lo:[1,0,0]
    v_pk_mul_f32 v[234:235], v[220:221], v[178:179] op_sel_hi:[0,1]
    v_cvt_pk_bf16_f32 v236, v200, -v201
    v_pk_fma_f32 v[222:223], v[220:221], v[178:179], v[234:235] op_sel:[1,1,0] op_sel_hi:[1,0,1] neg_lo:[1,0,0]
    v_pk_mul_f32 v[228:229], v[200:201], v[176:177] op_sel_hi:[0,1]
    v_cvt_pk_bf16_f32 v241, v222, v223
    ds_write_addtid_b32 v240 offset:8704
    ds_write_addtid_b32 v236 offset:2176
    v_pk_fma_f32 v[202:203], v[200:201], v[176:177], v[228:229] op_sel:[1,1,0] op_sel_hi:[1,0,1] neg_lo:[1,0,0]
    v_pk_mul_f32 v[232:233], v[222:223], v[178:179] op_sel_hi:[0,1]
    v_cvt_pk_bf16_f32 v237, v202, -v203
    v_pk_fma_f32 v[224:225], v[222:223], v[178:179], v[232:233] op_sel:[1,1,0] op_sel_hi:[1,0,1] neg_lo:[1,0,0]
    v_pk_mul_f32 v[230:231], v[202:203], v[176:177] op_sel_hi:[0,1]
    v_cvt_pk_bf16_f32 v242, v224, v225
    ds_write_addtid_b32 v241 offset:8976
    ds_write_addtid_b32 v237 offset:2448
    v_pk_fma_f32 v[204:205], v[202:203], v[176:177], v[230:231] op_sel:[1,1,0] op_sel_hi:[1,0,1] neg_lo:[1,0,0]
    v_pk_mul_f32 v[234:235], v[224:225], v[178:179] op_sel_hi:[0,1]
    v_cvt_pk_bf16_f32 v238, v204, -v205
    v_pk_fma_f32 v[226:227], v[224:225], v[178:179], v[234:235] op_sel:[1,1,0] op_sel_hi:[1,0,1] neg_lo:[1,0,0]
    v_pk_mul_f32 v[228:229], v[204:205], v[176:177] op_sel_hi:[0,1]
    v_cvt_pk_bf16_f32 v243, v226, v227
    ds_write_addtid_b32 v242 offset:9248
    ds_write_addtid_b32 v238 offset:2720
    v_pk_fma_f32 v[206:207], v[204:205], v[176:177], v[228:229] op_sel:[1,1,0] op_sel_hi:[1,0,1] neg_lo:[1,0,0]
    v_cvt_pk_bf16_f32 v240, v180, v181
    v_cvt_pk_bf16_f32 v239, v206, -v207
    v_pk_mul_f32 v[234:235], v[178:179], v[180:181] op_sel_hi:[0,1]
    ds_write_addtid_b32 v243 offset:9520
    ds_write_addtid_b32 v240 offset:9792
    v_pk_mul_f32 v[230:231], v[206:207], v[176:177] op_sel_hi:[0,1]
    v_pk_fma_f32 v[214:215], v[178:179], v[180:181], v[234:235] op_sel:[1,1,0] op_sel_hi:[1,0,1] neg_lo:[1,0,0]
    v_pk_fma_f32 v[208:209], v[206:207], v[176:177], v[230:231] op_sel:[1,1,0] op_sel_hi:[1,0,1] neg_lo:[1,0,0]
    v_cvt_pk_bf16_f32 v241, v214, v215
    v_cvt_pk_bf16_f32 v236, v208, -v209
    v_pk_mul_f32 v[232:233], v[216:217], v[180:181] op_sel_hi:[0,1]
    ds_write_addtid_b32 v239 offset:2992
    ds_write_addtid_b32 v241 offset:10064
    v_pk_mul_f32 v[228:229], v[192:193], v[182:183] op_sel_hi:[0,1]
    v_pk_fma_f32 v[216:217], v[216:217], v[180:181], v[232:233] op_sel:[1,1,0] op_sel_hi:[1,0,1] neg_lo:[1,0,0]
    v_pk_fma_f32 v[192:193], v[192:193], v[182:183], v[228:229] op_sel:[1,1,0] op_sel_hi:[1,0,1] neg_lo:[1,0,0]
    v_cvt_pk_bf16_f32 v242, v216, v217
    v_cvt_pk_bf16_f32 v237, v192, -v193
    v_pk_mul_f32 v[234:235], v[218:219], v[180:181] op_sel_hi:[0,1]
    ds_write_addtid_b32 v236 offset:4352
    ds_write_addtid_b32 v242 offset:10336
    v_pk_mul_f32 v[230:231], v[196:197], v[182:183] op_sel_hi:[0,1]
    v_pk_fma_f32 v[218:219], v[218:219], v[180:181], v[234:235] op_sel:[1,1,0] op_sel_hi:[1,0,1] neg_lo:[1,0,0]
    ds_write_addtid_b32 v237 offset:1088
    ds_write_addtid_b32 v237 offset:1360
    v_pk_fma_f32 v[196:197], v[196:197], v[182:183], v[230:231] op_sel:[1,1,0] op_sel_hi:[1,0,1] neg_lo:[1,0,0]
    v_cvt_pk_bf16_f32 v243, v218, v219
    v_cvt_pk_bf16_f32 v238, v196, -v197
    v_pk_mul_f32 v[232:233], v[220:221], v[180:181] op_sel_hi:[0,1]
    v_pk_mul_f32 v[228:229], v[200:201], v[182:183] op_sel_hi:[0,1]
    v_pk_fma_f32 v[220:221], v[220:221], v[180:181], v[232:233] op_sel:[1,1,0] op_sel_hi:[1,0,1] neg_lo:[1,0,0]
    s_lshl_b32 s68, s45, 5
    s_add_u32 s68, s68, 4096
    s_cmp_lg_u32 s3, 0
    s_cselect_b32 s68, 134217728, s68
    s_waitcnt vmcnt(13)
    s_barrier
    s_mov_b64 exec, 1
    buffer_store_dword v25, off, s[32:35], s68 sc1
    s_mov_b64 exec, -1
    ds_write_addtid_b32 v243 offset:10608
    ds_write_addtid_b32 v238 offset:1632
    v_pk_fma_f32 v[200:201], v[200:201], v[182:183], v[228:229] op_sel:[1,1,0] op_sel_hi:[1,0,1] neg_lo:[1,0,0]
    v_cvt_pk_bf16_f32 v240, v220, v221
    v_cvt_pk_bf16_f32 v239, v200, -v201
    v_pk_mul_f32 v[234:235], v[222:223], v[180:181] op_sel_hi:[0,1]
    v_pk_mul_f32 v[230:231], v[204:205], v[182:183] op_sel_hi:[0,1]
    v_pk_fma_f32 v[222:223], v[222:223], v[180:181], v[234:235] op_sel:[1,1,0] op_sel_hi:[1,0,1] neg_lo:[1,0,0]
    ds_write_addtid_b32 v240 offset:10880
    ds_write_addtid_b32 v239 offset:1904
    ds_write_addtid_b32 v239 offset:3264
    ds_write_addtid_b32 v239 offset:3536
    v_pk_fma_f32 v[204:205], v[204:205], v[182:183], v[230:231] op_sel:[1,1,0] op_sel_hi:[1,0,1] neg_lo:[1,0,0]
    v_cvt_pk_bf16_f32 v241, v222, v223
    v_cvt_pk_bf16_f32 v236, v204, -v205
    v_pk_mul_f32 v[232:233], v[224:225], v[180:181] op_sel_hi:[0,1]
    v_pk_mul_f32 v[228:229], v[208:209], v[182:183] op_sel_hi:[0,1]
    v_pk_fma_f32 v[224:225], v[224:225], v[180:181], v[232:233] op_sel:[1,1,0] op_sel_hi:[1,0,1] neg_lo:[1,0,0]
    ds_write_addtid_b32 v241 offset:11152
    ds_write_addtid_b32 v236 offset:7072
    v_pk_fma_f32 v[208:209], v[208:209], v[182:183], v[228:229] op_sel:[1,1,0] op_sel_hi:[1,0,1] neg_lo:[1,0,0]
    v_cvt_pk_bf16_f32 v242, v224, v225
    v_cvt_pk_bf16_f32 v237, v208, -v209
    v_pk_mul_f32 v[234:235], v[226:227], v[180:181] op_sel_hi:[0,1]
    v_pk_mul_f32 v[230:231], v[192:193], v[182:183] op_sel_hi:[0,1]
    v_pk_fma_f32 v[226:227], v[226:227], v[180:181], v[234:235] op_sel:[1,1,0] op_sel_hi:[1,0,1] neg_lo:[1,0,0]
    ds_write_addtid_b32 v242 offset:11424
    ds_write_addtid_b32 v237 offset:7344
    ds_write_addtid_b32 v237 offset:5440
    v_pk_fma_f32 v[192:193], v[192:193], v[182:183], v[230:231] op_sel:[1,1,0] op_sel_hi:[1,0,1] neg_lo:[1,0,0]
    v_cvt_pk_bf16_f32 v243, v226, v227
    v_cvt_pk_bf16_f32 v238, v192, -v193
    v_pk_mul_f32 v[232:233], v[180:181], v[180:181] op_sel_hi:[0,1]
    v_pk_mul_f32 v[228:229], v[200:201], v[182:183] op_sel_hi:[0,1]
    v_pk_fma_f32 v[212:213], v[180:181], v[180:181], v[232:233] op_sel:[1,1,0] op_sel_hi:[1,0,1] neg_lo:[1,0,0]
    ds_write_addtid_b32 v243 offset:11696
    ds_write_addtid_b32 v238 offset:4624
    s_add_u32 m0, s59, 73728
    s_nop 0
    buffer_load_dwordx4 v82, s[36:39], s66 offen lds
    s_mov_b32 m0, s83
    v_pk_fma_f32 v[200:201], v[200:201], v[182:183], v[228:229] op_sel:[1,1,0] op_sel_hi:[1,0,1] neg_lo:[1,0,0]
    v_cvt_pk_bf16_f32 v240, v212, v213
    v_cvt_pk_bf16_f32 v239, v200, -v201
    v_pk_mul_f32 v[234:235], v[214:215], v[180:181] op_sel_hi:[0,1]
    v_pk_mul_f32 v[230:231], v[208:209], v[182:183] op_sel_hi:[0,1]
    v_pk_fma_f32 v[214:215], v[214:215], v[180:181], v[234:235] op_sel:[1,1,0] op_sel_hi:[1,0,1] neg_lo:[1,0,0]
    ds_write_addtid_b32 v240 offset:11968
    ds_write_addtid_b32 v239 offset:4896
    v_pk_fma_f32 v[208:209], v[208:209], v[182:183], v[230:231] op_sel:[1,1,0] op_sel_hi:[1,0,1] neg_lo:[1,0,0]
    v_cvt_pk_bf16_f32 v241, v214, v215
    v_cvt_pk_bf16_f32 v236, v208, -v209
    v_pk_mul_f32 v[232:233], v[216:217], v[180:181] op_sel_hi:[0,1]
    s_add_u32 m0, s59, 77824
    s_nop 0
    buffer_load_dwordx4 v83, s[36:39], s66 offen lds
    s_mov_b32 m0, s83
    v_pk_mul_f32 v[228:229], v[192:193], v[182:183] op_sel_hi:[0,1]
    v_pk_fma_f32 v[216:217], v[216:217], v[180:181], v[232:233] op_sel:[1,1,0] op_sel_hi:[1,0,1] neg_lo:[1,0,0]
    ds_write_addtid_b32 v241 offset:12240
    ds_write_addtid_b32 v236 offset:5168
    v_pk_fma_f32 v[192:193], v[192:193], v[182:183], v[228:229] op_sel:[1,1,0] op_sel_hi:[1,0,1] neg_lo:[1,0,0]
    v_cvt_pk_bf16_f32 v242, v216, v217
    v_cvt_pk_bf16_f32 v237, v192, -v193
    v_pk_mul_f32 v[234:235], v[218:219], v[180:181] op_sel_hi:[0,1]
    v_pk_mul_f32 v[230:231], v[200:201], v[182:183] op_sel_hi:[0,1]
    v_pk_fma_f32 v[218:219], v[218:219], v[180:181], v[234:235] op_sel:[1,1,0] op_sel_hi:[1,0,1] neg_lo:[1,0,0]
    ds_write_addtid_b32 v242 offset:12512
    s_add_u32 m0, s59, 81920
    s_nop 0
    buffer_load_dwordx4 v84, s[36:39], s66 offen lds
    s_mov_b32 m0, s83
    s_nop 0
    ds_write_addtid_b32 v237 offset:5712
    v_pk_fma_f32 v[200:201], v[200:201], v[182:183], v[230:231] op_sel:[1,1,0] op_sel_hi:[1,0,1] neg_lo:[1,0,0]
    v_cvt_pk_bf16_f32 v243, v218, v219
    v_cvt_pk_bf16_f32 v238, v200, -v201
    v_pk_mul_f32 v[232:233], v[220:221], v[180:181] op_sel_hi:[0,1]
    v_pk_mul_f32 v[228:229], v[208:209], v[182:183] op_sel_hi:[0,1]
    v_pk_fma_f32 v[220:221], v[220:221], v[180:181], v[232:233] op_sel:[1,1,0] op_sel_hi:[1,0,1] neg_lo:[1,0,0]
    ds_write_addtid_b32 v243 offset:12784
    ds_write_addtid_b32 v238 offset:5984
    v_pk_fma_f32 v[208:209], v[208:209], v[182:183], v[228:229] op_sel:[1,1,0] op_sel_hi:[1,0,1] neg_lo:[1,0,0]
    v_cvt_pk_bf16_f32 v240, v220, v221
    s_add_u32 m0, s59, 86016
    s_nop 0
    buffer_load_dwordx4 v85, s[36:39], s66 offen lds
    s_mov_b32 m0, s83
    v_cvt_pk_bf16_f32 v239, v208, -v209
    v_pk_mul_f32 v[234:235], v[222:223], v[180:181] op_sel_hi:[0,1]
    v_pk_mul_f32 v[230:231], v[208:209], v[182:183] op_sel_hi:[0,1]
    v_pk_fma_f32 v[222:223], v[222:223], v[180:181], v[234:235] op_sel:[1,1,0] op_sel_hi:[1,0,1] neg_lo:[1,0,0]
    ds_write_addtid_b32 v240 offset:13056
    ds_write_addtid_b32 v239 offset:6256
    v_pk_fma_f32 v[208:209], v[208:209], v[182:183], v[230:231] op_sel:[1,1,0] op_sel_hi:[1,0,1] neg_lo:[1,0,0]
    v_cvt_pk_bf16_f32 v241, v222, v223
    v_cvt_pk_bf16_f32 v236, v208, -v209
    v_pk_mul_f32 v[232:233], v[224:225], v[180:181] op_sel_hi:[0,1]
    v_pk_mul_f32 v[228:229], v[208:209], v[182:183] op_sel_hi:[0,1]
    v_pk_fma_f32 v[224:225], v[224:225], v[180:181], v[232:233] op_sel:[1,1,0] op_sel_hi:[1,0,1] neg_lo:[1,0,0]
    s_add_u32 s75, s64, 40
    s_lshr_b32 s66, s75, 1
    s_mul_i32 s66, s66, 39680
    s_mul_i32 s75, s75, 640
    s_add_u32 s66, s66, s75
    s_add_u32 m0, s59, 90112
    s_nop 0
    buffer_load_dwordx4 v80, s[36:39], s66 offen lds
    s_mov_b32 m0, s83
    s_nop 0
    ds_write_addtid_b32 v241 offset:13328
    ds_write_addtid_b32 v236 offset:6528
    v_pk_fma_f32 v[208:209], v[208:209], v[182:183], v[228:229] op_sel:[1,1,0] op_sel_hi:[1,0,1] neg_lo:[1,0,0]
    v_cvt_pk_bf16_f32 v242, v224, v225
    v_cvt_pk_bf16_f32 v237, v208, -v209
    v_pk_mul_f32 v[234:235], v[226:227], v[180:181] op_sel_hi:[0,1]
    v_pk_mul_f32 v[230:231], v[208:209], v[182:183] op_sel_hi:[0,1]
    s_add_u32 m0, s59, 94208
    s_nop 0
    buffer_load_dwordx4 v81, s[36:39], s66 offen lds
    s_mov_b32 m0, s83
    v_pk_fma_f32 v[226:227], v[226:227], v[180:181], v[234:235] op_sel:[1,1,0] op_sel_hi:[1,0,1] neg_lo:[1,0,0]
    ds_write_addtid_b32 v242 offset:13600
    ds_write_addtid_b32 v237 offset:3808
    v_pk_fma_f32 v[208:209], v[208:209], v[182:183], v[230:231] op_sel:[1,1,0] op_sel_hi:[1,0,1] neg_lo:[1,0,0]
    v_cvt_pk_bf16_f32 v243, v226, v227
    v_cvt_pk_bf16_f32 v238, v208, -v209
    v_pk_mul_f32 v[232:233], v[212:213], v[180:181] op_sel_hi:[0,1]
    v_pk_mul_f32 v[228:229], v[208:209], v[182:183] op_sel_hi:[0,1]
    v_pk_fma_f32 v[212:213], v[212:213], v[180:181], v[232:233] op_sel:[1,1,0] op_sel_hi:[1,0,1] neg_lo:[1,0,0]
    ds_write_addtid_b32 v243 offset:13872
    ds_write_addtid_b32 v238 offset:6800
    s_add_u32 m0, s59, 98304
    s_nop 0
    buffer_load_dwordx4 v82, s[36:39], s66 offen lds
    s_mov_b32 m0, s83
    v_pk_fma_f32 v[208:209], v[208:209], v[182:183], v[228:229] op_sel:[1,1,0] op_sel_hi:[1,0,1] neg_lo:[1,0,0]
    v_cvt_pk_bf16_f32 v240, v212, v213
    v_cvt_pk_bf16_f32 v239, v208, -v209
    v_pk_mul_f32 v[234:235], v[214:215], v[180:181] op_sel_hi:[0,1]
    v_pk_fma_f32 v[214:215], v[214:215], v[180:181], v[234:235] op_sel:[1,1,0] op_sel_hi:[1,0,1] neg_lo:[1,0,0]
    ds_write_addtid_b32 v240 offset:14144
    ds_write_addtid_b32 v239 offset:4080
    v_cvt_pk_bf16_f32 v241, v214, v215
    v_pk_mul_f32 v[232:233], v[216:217], v[180:181] op_sel_hi:[0,1]
    v_pk_fma_f32 v[216:217], v[216:217], v[180:181], v[232:233] op_sel:[1,1,0] op_sel_hi:[1,0,1] neg_lo:[1,0,0]
    v_cvt_pk_bf16_f32 v242, v216, v217
    v_pk_mul_f32 v[234:235], v[218:219], v[180:181] op_sel_hi:[0,1]
    s_add_u32 m0, s59, 102400
    s_nop 0
    buffer_load_dwordx4 v83, s[36:39], s66 offen lds
    s_mov_b32 m0, s83
    s_nop 0
    ds_write_addtid_b32 v241 offset:14416
    ds_write_addtid_b32 v242 offset:14688
    v_pk_fma_f32 v[218:219], v[218:219], v[180:181], v[234:235] op_sel:[1,1,0] op_sel_hi:[1,0,1] neg_lo:[1,0,0]
    v_cvt_pk_bf16_f32 v243, v218, v219
    v_pk_mul_f32 v[232:233], v[220:221], v[180:181] op_sel_hi:[0,1]
    v_pk_fma_f32 v[220:221], v[220:221], v[180:181], v[232:233] op_sel:[1,1,0] op_sel_hi:[1,0,1] neg_lo:[1,0,0]
    v_cvt_pk_bf16_f32 v240, v220, v221
    v_pk_mul_f32 v[234:235], v[222:223], v[180:181] op_sel_hi:[0,1]
    ds_write_addtid_b32 v243 offset:14960
    ds_write_addtid_b32 v240 offset:15232
    s_add_u32 m0, s59, 106496
    s_nop 0
    buffer_load_dwordx4 v84, s[36:39], s66 offen lds
    s_mov_b32 m0, s83
    v_pk_fma_f32 v[222:223], v[222:223], v[180:181], v[234:235] op_sel:[1,1,0] op_sel_hi:[1,0,1] neg_lo:[1,0,0]
    v_cvt_pk_bf16_f32 v241, v222, v223
    v_pk_mul_f32 v[232:233], v[224:225], v[180:181] op_sel_hi:[0,1]
    v_pk_fma_f32 v[224:225], v[224:225], v[180:181], v[232:233] op_sel:[1,1,0] op_sel_hi:[1,0,1] neg_lo:[1,0,0]
    v_cvt_pk_bf16_f32 v242, v224, v225
    v_pk_mul_f32 v[234:235], v[226:227], v[180:181] op_sel_hi:[0,1]
    ds_write_addtid_b32 v241 offset:15504
    ds_write_addtid_b32 v242 offset:15776
    v_pk_fma_f32 v[226:227], v[226:227], v[180:181], v[234:235] op_sel:[1,1,0] op_sel_hi:[1,0,1] neg_lo:[1,0,0]
    v_cvt_pk_bf16_f32 v243, v226, v227
    ds_write_addtid_b32 v243 offset:16048
    s_add_u32 m0, s59, 110592
    s_nop 0
    buffer_load_dwordx4 v85, s[36:39], s66 offen lds
    s_mov_b32 m0, s83
    v_and_b32 v6, 31, v1
    v_mul_u32_u24 v6, 272, v6
    v_lshrrev_b32 v7, 5, v1
    v_lshl_add_u32 v6, v7, 4, v6
    s_lshr_b32 s76, s3, 1
    s_mul_i32 s76, s76, 32768
    v_add_u32 v6, s76, v6
    s_mov_b32 vcc_lo, 0xc000
    s_mov_b32 vcc_hi, vcc_lo
    v_add_u32 v7, 3264, v6
    v_cndmask_b32 v7, v6, v7, vcc
    s_mov_b32 exec_lo, 0x30000000
    s_mov_b32 exec_hi, exec_lo
    v_subrev_u32 v7, 3808, v6
    s_lshl_b64 exec, exec, 2
    v_subrev_u32 v7, 4352, v6
    s_mov_b64 exec, -1
    s_waitcnt lgkmcnt(0)
    s_barrier
    ds_read_b128 v[176:179], v7 offset:0
    ds_read_b128 v[180:183], v6 offset:7616
    ds_read_b128 v[184:187], v7 offset:32
    ds_read_b128 v[188:191], v6 offset:7648
    ds_read_b128 v[192:195], v7 offset:64
    ds_read_b128 v[196:199], v6 offset:7680
    ds_read_b128 v[200:203], v7 offset:96
    ds_read_b128 v[204:207], v6 offset:7712
    ds_read_b128 v[208:211], v7 offset:128
    ds_read_b128 v[212:215], v6 offset:7744
    ds_read_b128 v[216:219], v7 offset:160
    ds_read_b128 v[220:223], v6 offset:7776
    ds_read_b128 v[224:227], v7 offset:192
    ds_read_b128 v[228:231], v6 offset:7808
    s_waitcnt lgkmcnt(12)
    v_mfma_f32_32x32x16_bf16 v[112:127], v[176:179], v[180:183], 0
    ds_read_b128 v[232:235], v7 offset:224
    ds_read_b128 v[236:239], v6 offset:7840
    s_add_u32 s75, s64, 80
    s_lshr_b32 s66, s75, 1
    s_mul_i32 s66, s66, 39680
    s_waitcnt lgkmcnt(12)
    v_mfma_f32_32x32x16_bf16 v[112:127], v[184:187], v[188:191], v[112:127]
    ds_read_b128 v[176:179], v7 offset:16384
    ds_read_b128 v[180:183], v6 offset:24000
    s_mul_i32 s75, s75, 640
    s_add_u32 s66, s66, s75
    s_add_u32 m0, s59, 114688
    s_waitcnt lgkmcnt(12)
    v_mfma_f32_32x32x16_bf16 v[112:127], v[192:195], v[196:199], v[112:127]
    ds_read_b128 v[184:187], v7 offset:16416
    ds_read_b128 v[188:191], v6 offset:24032
    s_nop 0
    buffer_load_dwordx4 v80, s[36:39], s66 offen lds
    s_waitcnt lgkmcnt(12)
    v_mfma_f32_32x32x16_bf16 v[112:127], v[200:203], v[204:207], v[112:127]
    ds_read_b128 v[192:195], v7 offset:16448
    ds_read_b128 v[196:199], v6 offset:24064
    s_mov_b32 m0, s83
    s_add_u32 m0, s59, 118784
    s_nop 0
    s_waitcnt lgkmcnt(12)
    v_mfma_f32_32x32x16_bf16 v[112:127], v[208:211], v[212:215], v[112:127]
    ds_read_b128 v[200:203], v7 offset:16480
    ds_read_b128 v[204:207], v6 offset:24096
    buffer_load_dwordx4 v81, s[36:39], s66 offen lds
    s_mov_b32 m0, s83
    s_add_u32 m0, s59, 122880
    s_waitcnt lgkmcnt(12)
    v_mfma_f32_32x32x16_bf16 v[112:127], v[216:219], v[220:223], v[112:127]
    ds_read_b128 v[208:211], v7 offset:16512
    ds_read_b128 v[212:215], v6 offset:24128
    s_nop 0
    s_waitcnt lgkmcnt(12)
    v_mfma_f32_32x32x16_bf16 v[112:127], v[224:227], v[228:231], v[112:127]
    ds_read_b128 v[216:219], v7 offset:16544
    ds_read_b128 v[220:223], v6 offset:24160
    buffer_load_dwordx4 v82, s[36:39], s66 offen lds
    s_mov_b32 m0, s83
    s_add_u32 m0, s59, 126976
    s_waitcnt lgkmcnt(12)
    v_mfma_f32_32x32x16_bf16 v[112:127], v[232:235], v[236:239], v[112:127]
    ds_read_b128 v[224:227], v7 offset:16576
    ds_read_b128 v[228:231], v6 offset:24192
    s_nop 0
    s_waitcnt lgkmcnt(12)
    v_mfma_f32_32x32x16_bf16 v[112:127], v[176:179], v[180:183], v[112:127]
    ds_read_b128 v[232:235], v7 offset:16608
    ds_read_b128 v[236:239], v6 offset:24224
    s_waitcnt lgkmcnt(12)
    v_mfma_f32_32x32x16_bf16 v[112:127], v[184:187], v[188:191], v[112:127]
    buffer_load_dwordx4 v83, s[36:39], s66 offen lds
    s_mov_b32 m0, s83
    s_add_u32 m0, s59, 131072
    s_nop 0
    s_waitcnt lgkmcnt(10)
    v_mfma_f32_32x32x16_bf16 v[112:127], v[192:195], v[196:199], v[112:127]
    s_waitcnt lgkmcnt(8)
    v_mfma_f32_32x32x16_bf16 v[112:127], v[200:203], v[204:207], v[112:127]
    buffer_load_dwordx4 v84, s[36:39], s66 offen lds
    s_mov_b32 m0, s83
    s_add_u32 m0, s59, 135168
    s_nop 0
    s_waitcnt lgkmcnt(6)
    v_mfma_f32_32x32x16_bf16 v[112:127], v[208:211], v[212:215], v[112:127]
    s_waitcnt lgkmcnt(4)
    v_mfma_f32_32x32x16_bf16 v[112:127], v[216:219], v[220:223], v[112:127]
    buffer_load_dwordx4 v85, s[36:39], s66 offen lds
    s_mov_b32 m0, s83
    s_waitcnt lgkmcnt(2)
    v_mfma_f32_32x32x16_bf16 v[112:127], v[224:227], v[228:231], v[112:127]
    s_waitcnt lgkmcnt(0)
    v_mfma_f32_32x32x16_bf16 v[112:127], v[232:235], v[236:239], v[112:127]
    s_barrier
    s_cmp_eq_u32 s42, 0
    s_cbranch_scc1 role_light
    s_lshl_b32 s65, s3, 11
    s_add_u32 s65, s65, 4096
    v_min_u32 v28, 63, v1
    v_lshlrev_b32 v28, 5, v28
    buffer_load_dword v24, v28, s[32:35], s65 offen sc1
    s_bitcmp1_b32 s3, 0
    s_cselect_b32 s76, 0, 16
    s_lshl_b32 s77, s79, s76
    s_and_b32 s77, s77, 0xffff0000
    s_mov_b32 m0, s83
    v_mov_b32 v6, 0x3fb8aa3b
    v_mul_f32 v7, s77, v6
    s_waitcnt vmcnt(27)
    v_lshlrev_b32 v56, 16, v56
    v_exp_f32 v7, v7
    v_mul_f32 v56, v56, v6
    s_waitcnt vmcnt(26)
    v_lshlrev_b32 v57, 16, v57
    v_exp_f32 v56, v56
    v_cvt_pk_bf16_f32 v7, v7, v7
    s_waitcnt vmcnt(25)
    v_lshlrev_b32 v58, 16, v58
    v_lshlrev_b32 v7, 16, v7
    v_cvt_pk_bf16_f32 v56, v56, v56
    s_waitcnt vmcnt(24)
    v_lshlrev_b32 v59, 16, v59
    v_lshlrev_b32 v56, 16, v56
    v_mul_f32 v57, v57, v7
    v_mul_f32 v56, v56, v7
    v_add_f32 v7, v7, v7
    v_mul_f32 v57, 0.15915494, v57
    v_mul_f32 v56, 0xbfb8aa3b, v56
    v_mul_f32 v192, v58, v7
    v_mul_f32 v193, v59, v7
    v_mul_f32 v186, 0x41000000, v56
    v_mul_f32 v187, 0x41000000, v57
    v_mul_f32 v188, 0x42800000, v56
    v_mul_f32 v189, 0x42800000, v57
    v_mul_f32 v190, 0x43800000, v56
    v_mul_f32 v191, 0x43800000, v57
    v_fract_f32 v185, v57
    v_fract_f32 v187, v187
    v_fract_f32 v189, v189
    v_fract_f32 v191, v191
    v_exp_f32 v184, v56
    v_cos_f32 v176, v185
    v_sin_f32 v177, v185
    v_exp_f32 v186, v186
    v_cos_f32 v178, v187
    v_sin_f32 v179, v187
    v_exp_f32 v188, v188
    v_cos_f32 v180, v189
    v_sin_f32 v181, v189
    v_exp_f32 v190, v190
    v_cos_f32 v182, v191
    v_sin_f32 v183, v191
    v_mov_b32 v212, 1.0
    v_mov_b32 v213, 0
    v_pk_mul_f32 v[176:177], v[176:177], v[184:185] op_sel_hi:[1,0]
    v_pk_mul_f32 v[178:179], v[178:179], v[186:187] op_sel_hi:[1,0]
    v_pk_mul_f32 v[180:181], v[180:181], v[188:189] op_sel_hi:[1,0]
    v_pk_mul_f32 v[182:183], v[182:183], v[190:191] op_sel_hi:[1,0]
    v_cvt_pk_bf16_f32 v236, v192, -v193
    v_cvt_pk_bf16_f32 v240, v212, v213
    v_pk_mul_f32 v[228:229], v[192:193], v[176:177] op_sel_hi:[0,1]
    v_cvt_pk_bf16_f32 v241, v178, v179
    ds_write_addtid_b32 v236 offset:0
    ds_write_addtid_b32 v240 offset:7616
    v_pk_fma_f32 v[194:195], v[192:193], v[176:177], v[228:229] op_sel:[1,1,0] op_sel_hi:[1,0,1] neg_lo:[1,0,0]
    v_pk_mul_f32 v[232:233], v[178:179], v[178:179] op_sel_hi:[0,1]
    v_cvt_pk_bf16_f32 v237, v194, -v195
    v_pk_fma_f32 v[216:217], v[178:179], v[178:179], v[232:233] op_sel:[1,1,0] op_sel_hi:[1,0,1] neg_lo:[1,0,0]
    v_pk_mul_f32 v[230:231], v[194:195], v[176:177] op_sel_hi:[0,1]
    v_cvt_pk_bf16_f32 v242, v216, v217
    ds_write_addtid_b32 v241 offset:7888
    ds_write_addtid_b32 v237 offset:272
    v_pk_fma_f32 v[196:197], v[194:195], v[176:177], v[230:231] op_sel:[1,1,0] op_sel_hi:[1,0,1] neg_lo:[1,0,0]
    v_pk_mul_f32 v[234:235], v[216:217], v[178:179] op_sel_hi:[0,1]
    v_cvt_pk_bf16_f32 v238, v196, -v197
    v_pk_fma_f32 v[218:219], v[216:217], v[178:179], v[234:235] op_sel:[1,1,0] op_sel_hi:[1,0,1] neg_lo:[1,0,0]
    v_pk_mul_f32 v[228:229], v[196:197], v[176:177] op_sel_hi:[0,1]
    v_cvt_pk_bf16_f32 v243, v218, v219
    ds_write_addtid_b32 v242 offset:8160
    ds_write_addtid_b32 v238 offset:544
    v_pk_fma_f32 v[198:199], v[196:197], v[176:177], v[228:229] op_sel:[1,1,0] op_sel_hi:[1,0,1] neg_lo:[1,0,0]
    v_pk_mul_f32 v[232:233], v[218:219], v[178:179] op_sel_hi:[0,1]
    v_cvt_pk_bf16_f32 v239, v198, -v199
    v_pk_fma_f32 v[220:221], v[218:219], v[178:179], v[232:233] op_sel:[1,1,0] op_sel_hi:[1,0,1] neg_lo:[1,0,0]
    v_pk_mul_f32 v[230:231], v[198:199], v[176:177] op_sel_hi:[0,1]
    v_cvt_pk_bf16_f32 v240, v220, v221
    ds_write_addtid_b32 v243 offset:8432
    ds_write_addtid_b32 v239 offset:816
    v_pk_fma_f32 v[200:201], v[198:199], v[176:177], v[230:231] op_sel:[1,1,0] op_sel_hi:[1,0,1] neg_lo:[1,0,0]
    v_pk_mul_f32 v[234:235], v[220:221], v[178:179] op_sel_hi:[0,1]
    v_cvt_pk_bf16_f32 v236, v200, -v201
    v_pk_fma_f32 v[222:223], v[220:221], v[178:179], v[234:235] op_sel:[1,1,0] op_sel_hi:[1,0,1] neg_lo:[1,0,0]
    v_pk_mul_f32 v[228:229], v[200:201], v[176:177] op_sel_hi:[0,1]
    v_cvt_pk_bf16_f32 v241, v222, v223
    ds_write_addtid_b32 v240 offset:8704
    ds_write_addtid_b32 v236 offset:2176
    v_pk_fma_f32 v[202:203], v[200:201], v[176:177], v[228:229] op_sel:[1,1,0] op_sel_hi:[1,0,1] neg_lo:[1,0,0]
    v_pk_mul_f32 v[232:233], v[222:223], v[178:179] op_sel_hi:[0,1]
    v_cvt_pk_bf16_f32 v237, v202, -v203
    v_pk_fma_f32 v[224:225], v[222:223], v[178:179], v[232:233] op_sel:[1,1,0] op_sel_hi:[1,0,1] neg_lo:[1,0,0]
    v_pk_mul_f32 v[230:231], v[202:203], v[176:177] op_sel_hi:[0,1]
    v_cvt_pk_bf16_f32 v242, v224, v225
    ds_write_addtid_b32 v241 offset:8976
    ds_write_addtid_b32 v237 offset:2448
    v_pk_fma_f32 v[204:205], v[202:203], v[176:177], v[230:231] op_sel:[1,1,0] op_sel_hi:[1,0,1] neg_lo:[1,0,0]
    v_pk_mul_f32 v[234:235], v[224:225], v[178:179] op_sel_hi:[0,1]
    v_cvt_pk_bf16_f32 v238, v204, -v205
    v_pk_fma_f32 v[226:227], v[224:225], v[178:179], v[234:235] op_sel:[1,1,0] op_sel_hi:[1,0,1] neg_lo:[1,0,0]
    v_pk_mul_f32 v[228:229], v[204:205], v[176:177] op_sel_hi:[0,1]
    v_cvt_pk_bf16_f32 v243, v226, v227
    ds_write_addtid_b32 v242 offset:9248
    ds_write_addtid_b32 v238 offset:2720
    v_pk_fma_f32 v[206:207], v[204:205], v[176:177], v[228:229] op_sel:[1,1,0] op_sel_hi:[1,0,1] neg_lo:[1,0,0]
    v_cvt_pk_bf16_f32 v240, v180, v181
    v_cvt_pk_bf16_f32 v239, v206, -v207
    v_pk_mul_f32 v[234:235], v[178:179], v[180:181] op_sel_hi:[0,1]
    ds_write_addtid_b32 v243 offset:9520
    ds_write_addtid_b32 v240 offset:9792
    v_pk_mul_f32 v[230:231], v[206:207], v[176:177] op_sel_hi:[0,1]
    v_pk_fma_f32 v[214:215], v[178:179], v[180:181], v[234:235] op_sel:[1,1,0] op_sel_hi:[1,0,1] neg_lo:[1,0,0]
    v_pk_fma_f32 v[208:209], v[206:207], v[176:177], v[230:231] op_sel:[1,1,0] op_sel_hi:[1,0,1] neg_lo:[1,0,0]
    v_cvt_pk_bf16_f32 v241, v214, v215
    v_cvt_pk_bf16_f32 v236, v208, -v209
    v_pk_mul_f32 v[232:233], v[216:217], v[180:181] op_sel_hi:[0,1]
    ds_write_addtid_b32 v239 offset:2992
    ds_write_addtid_b32 v241 offset:10064
    v_pk_mul_f32 v[228:229], v[192:193], v[182:183] op_sel_hi:[0,1]
    v_pk_fma_f32 v[216:217], v[216:217], v[180:181], v[232:233] op_sel:[1,1,0] op_sel_hi:[1,0,1] neg_lo:[1,0,0]
    v_pk_fma_f32 v[192:193], v[192:193], v[182:183], v[228:229] op_sel:[1,1,0] op_sel_hi:[1,0,1] neg_lo:[1,0,0]
    v_cvt_pk_bf16_f32 v242, v216, v217
    v_cvt_pk_bf16_f32 v237, v192, -v193
    v_pk_mul_f32 v[234:235], v[218:219], v[180:181] op_sel_hi:[0,1]
    ds_write_addtid_b32 v236 offset:4352
    ds_write_addtid_b32 v242 offset:10336
    v_pk_mul_f32 v[230:231], v[196:197], v[182:183] op_sel_hi:[0,1]
    v_pk_fma_f32 v[218:219], v[218:219], v[180:181], v[234:235] op_sel:[1,1,0] op_sel_hi:[1,0,1] neg_lo:[1,0,0]
    ds_write_addtid_b32 v237 offset:1088
    ds_write_addtid_b32 v237 offset:1360
    v_pk_fma_f32 v[196:197], v[196:197], v[182:183], v[230:231] op_sel:[1,1,0] op_sel_hi:[1,0,1] neg_lo:[1,0,0]
    v_cvt_pk_bf16_f32 v243, v218, v219
    v_cvt_pk_bf16_f32 v238, v196, -v197
    v_pk_mul_f32 v[232:233], v[220:221], v[180:181] op_sel_hi:[0,1]
    v_pk_mul_f32 v[228:229], v[200:201], v[182:183] op_sel_hi:[0,1]
    v_pk_fma_f32 v[220:221], v[220:221], v[180:181], v[232:233] op_sel:[1,1,0] op_sel_hi:[1,0,1] neg_lo:[1,0,0]
    ds_write_addtid_b32 v243 offset:10608
    ds_write_addtid_b32 v238 offset:1632
    v_pk_fma_f32 v[200:201], v[200:201], v[182:183], v[228:229] op_sel:[1,1,0] op_sel_hi:[1,0,1] neg_lo:[1,0,0]
    v_cvt_pk_bf16_f32 v240, v220, v221
    v_cvt_pk_bf16_f32 v239, v200, -v201
    v_pk_mul_f32 v[234:235], v[222:223], v[180:181] op_sel_hi:[0,1]
    v_pk_mul_f32 v[230:231], v[204:205], v[182:183] op_sel_hi:[0,1]
    v_pk_fma_f32 v[222:223], v[222:223], v[180:181], v[234:235] op_sel:[1,1,0] op_sel_hi:[1,0,1] neg_lo:[1,0,0]
    ds_write_addtid_b32 v240 offset:10880
    ds_write_addtid_b32 v239 offset:1904
    ds_write_addtid_b32 v239 offset:3264
    ds_write_addtid_b32 v239 offset:3536
    v_pk_fma_f32 v[204:205], v[204:205], v[182:183], v[230:231] op_sel:[1,1,0] op_sel_hi:[1,0,1] neg_lo:[1,0,0]
    v_cvt_pk_bf16_f32 v241, v222, v223
    v_cvt_pk_bf16_f32 v236, v204, -v205
    v_pk_mul_f32 v[232:233], v[224:225], v[180:181] op_sel_hi:[0,1]
    v_pk_mul_f32 v[228:229], v[208:209], v[182:183] op_sel_hi:[0,1]
    v_pk_fma_f32 v[224:225], v[224:225], v[180:181], v[232:233] op_sel:[1,1,0] op_sel_hi:[1,0,1] neg_lo:[1,0,0]
    ds_write_addtid_b32 v241 offset:11152
    s_waitcnt vmcnt(1)
    s_barrier
    v_add_u32 v4, 65536, v86
    ds_read_b64_tr_b16 a[0:1], v4 offset:0
    ds_read_b64_tr_b16 a[2:3], v4 offset:10752
    ds_read_b64_tr_b16 a[4:5], v4 offset:8
    ds_read_b64_tr_b16 a[6:7], v4 offset:10760
    ds_read_b64_tr_b16 a[8:9], v4 offset:16
    ds_read_b64_tr_b16 a[10:11], v4 offset:10768
    ds_read_b64_tr_b16 a[12:13], v4 offset:24
    ds_read_b64_tr_b16 a[14:15], v4 offset:10776
    ds_read_b64_tr_b16 a[16:17], v4 offset:32
    ds_read_b64_tr_b16 a[18:19], v4 offset:10784
    v_add_u32 v4, 90112, v86
    ds_read_b64_tr_b16 a[20:21], v4 offset:0
    ds_read_b64_tr_b16 a[22:23], v4 offset:10752
    ds_read_b64_tr_b16 a[24:25], v4 offset:8
    ds_read_b64_tr_b16 a[26:27], v4 offset:10760
    ds_read_b64_tr_b16 a[28:29], v4 offset:16
    ds_read_b64_tr_b16 a[30:31], v4 offset:10768
    ds_read_b64_tr_b16 a[32:33], v4 offset:24
    ds_read_b64_tr_b16 a[34:35], v4 offset:10776
    ds_read_b64_tr_b16 a[36:37], v4 offset:32
    ds_read_b64_tr_b16 a[38:39], v4 offset:10784
    v_add_u32 v4, 114688, v86
    ds_read_b64_tr_b16 a[40:41], v4 offset:0
    ds_read_b64_tr_b16 a[42:43], v4 offset:10752
    ds_read_b64_tr_b16 a[44:45], v4 offset:8
    ds_read_b64_tr_b16 a[46:47], v4 offset:10760
    ds_read_b64_tr_b16 a[48:49], v4 offset:16
    ds_read_b64_tr_b16 a[50:51], v4 offset:10768
    ds_read_b64_tr_b16 a[52:53], v4 offset:24
    ds_read_b64_tr_b16 a[54:55], v4 offset:10776
    ds_read_b64_tr_b16 a[56:57], v4 offset:32
    ds_read_b64_tr_b16 a[58:59], v4 offset:10784
    ds_write_addtid_b32 v236 offset:7072
    v_pk_fma_f32 v[208:209], v[208:209], v[182:183], v[228:229] op_sel:[1,1,0] op_sel_hi:[1,0,1] neg_lo:[1,0,0]
    v_cvt_pk_bf16_f32 v242, v224, v225
    v_cvt_pk_bf16_f32 v237, v208, -v209
    v_pk_mul_f32 v[234:235], v[226:227], v[180:181] op_sel_hi:[0,1]
    v_pk_mul_f32 v[230:231], v[192:193], v[182:183] op_sel_hi:[0,1]
    v_pk_fma_f32 v[226:227], v[226:227], v[180:181], v[234:235] op_sel:[1,1,0] op_sel_hi:[1,0,1] neg_lo:[1,0,0]
    ds_write_addtid_b32 v242 offset:11424
    ds_write_addtid_b32 v237 offset:7344
    ds_write_addtid_b32 v237 offset:5440
    v_pk_fma_f32 v[192:193], v[192:193], v[182:183], v[230:231] op_sel:[1,1,0] op_sel_hi:[1,0,1] neg_lo:[1,0,0]
    v_cvt_pk_bf16_f32 v243, v226, v227
    v_cvt_pk_bf16_f32 v238, v192, -v193
    v_pk_mul_f32 v[232:233], v[180:181], v[180:181] op_sel_hi:[0,1]
    v_pk_mul_f32 v[228:229], v[200:201], v[182:183] op_sel_hi:[0,1]
    v_pk_fma_f32 v[212:213], v[180:181], v[180:181], v[232:233] op_sel:[1,1,0] op_sel_hi:[1,0,1] neg_lo:[1,0,0]
    ds_write_addtid_b32 v243 offset:11696
    ds_write_addtid_b32 v238 offset:4624
    v_pk_fma_f32 v[200:201], v[200:201], v[182:183], v[228:229] op_sel:[1,1,0] op_sel_hi:[1,0,1] neg_lo:[1,0,0]
    s_add_u32 s75, s64, 0
    s_and_b32 s74, s75, 1
    s_lshl2_add_u32 s74, s74, s3
    s_lshr_b32 s73, s75, 1
    s_mul_i32 s66, s74, 276480
    s_mul_i32 s72, s73, 5120
    s_add_u32 s66, s66, s72
    s_add_u32 s66, s66, 2686976
    s_lshl_b32 s74, s74, 8
    s_lshl2_add_u32 s74, s73, s74
    s_lshl_b32 s74, s74, 2
    s_add_u32 s6, s74, 32768
    s_cmp_ge_u32 s75, 108
    s_cselect_b32 s66, 134217728, s66
    s_cselect_b32 s6, 134217728, s6
    buffer_store_dwordx4 a[0:3], v8, s[32:35], s66 offen offset:0 sc1
    buffer_store_dwordx4 a[4:7], v8, s[32:35], s66 offen offset:1024 sc1
    v_cvt_pk_bf16_f32 v240, v212, v213
    v_cvt_pk_bf16_f32 v239, v200, -v201
    v_pk_mul_f32 v[234:235], v[214:215], v[180:181] op_sel_hi:[0,1]
    v_pk_mul_f32 v[230:231], v[208:209], v[182:183] op_sel_hi:[0,1]
    v_pk_fma_f32 v[214:215], v[214:215], v[180:181], v[234:235] op_sel:[1,1,0] op_sel_hi:[1,0,1] neg_lo:[1,0,0]
    ds_write_addtid_b32 v240 offset:11968
    ds_write_addtid_b32 v239 offset:4896
    v_pk_fma_f32 v[208:209], v[208:209], v[182:183], v[230:231] op_sel:[1,1,0] op_sel_hi:[1,0,1] neg_lo:[1,0,0]
    v_cvt_pk_bf16_f32 v241, v214, v215
    v_cvt_pk_bf16_f32 v236, v208, -v209
    v_pk_mul_f32 v[232:233], v[216:217], v[180:181] op_sel_hi:[0,1]
    v_pk_mul_f32 v[228:229], v[192:193], v[182:183] op_sel_hi:[0,1]
    v_pk_fma_f32 v[216:217], v[216:217], v[180:181], v[232:233] op_sel:[1,1,0] op_sel_hi:[1,0,1] neg_lo:[1,0,0]
    buffer_store_dwordx4 a[8:11], v8, s[32:35], s66 offen offset:2048 sc1
    ds_write_addtid_b32 v241 offset:12240
    ds_write_addtid_b32 v236 offset:5168
    v_pk_fma_f32 v[192:193], v[192:193], v[182:183], v[228:229] op_sel:[1,1,0] op_sel_hi:[1,0,1] neg_lo:[1,0,0]
    v_cvt_pk_bf16_f32 v242, v216, v217
    v_cvt_pk_bf16_f32 v237, v192, -v193
    v_pk_mul_f32 v[234:235], v[218:219], v[180:181] op_sel_hi:[0,1]
    v_pk_mul_f32 v[230:231], v[200:201], v[182:183] op_sel_hi:[0,1]
    v_pk_fma_f32 v[218:219], v[218:219], v[180:181], v[234:235] op_sel:[1,1,0] op_sel_hi:[1,0,1] neg_lo:[1,0,0]
    ds_write_addtid_b32 v242 offset:12512
    ds_write_addtid_b32 v237 offset:5712
    v_pk_fma_f32 v[200:201], v[200:201], v[182:183], v[230:231] op_sel:[1,1,0] op_sel_hi:[1,0,1] neg_lo:[1,0,0]
    buffer_store_dwordx4 a[12:15], v8, s[32:35], s66 offen offset:3072 sc1
    v_cvt_pk_bf16_f32 v243, v218, v219
    v_cvt_pk_bf16_f32 v238, v200, -v201
    v_pk_mul_f32 v[232:233], v[220:221], v[180:181] op_sel_hi:[0,1]
    v_pk_mul_f32 v[228:229], v[208:209], v[182:183] op_sel_hi:[0,1]
    v_pk_fma_f32 v[220:221], v[220:221], v[180:181], v[232:233] op_sel:[1,1,0] op_sel_hi:[1,0,1] neg_lo:[1,0,0]
    ds_write_addtid_b32 v243 offset:12784
    ds_write_addtid_b32 v238 offset:5984
    v_pk_fma_f32 v[208:209], v[208:209], v[182:183], v[228:229] op_sel:[1,1,0] op_sel_hi:[1,0,1] neg_lo:[1,0,0]
    v_cvt_pk_bf16_f32 v240, v220, v221
    v_cvt_pk_bf16_f32 v239, v208, -v209
    v_pk_mul_f32 v[234:235], v[222:223], v[180:181] op_sel_hi:[0,1]
    v_pk_mul_f32 v[230:231], v[208:209], v[182:183] op_sel_hi:[0,1]
    v_pk_fma_f32 v[222:223], v[222:223], v[180:181], v[234:235] op_sel:[1,1,0] op_sel_hi:[1,0,1] neg_lo:[1,0,0]
    s_add_u32 s66, s66, 4096
    buffer_store_dwordx4 a[16:19], v8, s[32:35], s66 offen offset:0 sc1
    ds_write_addtid_b32 v240 offset:13056
    ds_write_addtid_b32 v239 offset:6256
    v_pk_fma_f32 v[208:209], v[208:209], v[182:183], v[230:231] op_sel:[1,1,0] op_sel_hi:[1,0,1] neg_lo:[1,0,0]
    v_cvt_pk_bf16_f32 v241, v222, v223
    v_cvt_pk_bf16_f32 v236, v208, -v209
    v_pk_mul_f32 v[232:233], v[224:225], v[180:181] op_sel_hi:[0,1]
    v_pk_mul_f32 v[228:229], v[208:209], v[182:183] op_sel_hi:[0,1]
    v_pk_fma_f32 v[224:225], v[224:225], v[180:181], v[232:233] op_sel:[1,1,0] op_sel_hi:[1,0,1] neg_lo:[1,0,0]
    ds_write_addtid_b32 v241 offset:13328
    ds_write_addtid_b32 v236 offset:6528
    s_add_u32 s75, s64, 40
    s_and_b32 s74, s75, 1
    s_lshl2_add_u32 s74, s74, s3
    s_lshr_b32 s73, s75, 1
    s_mul_i32 s66, s74, 276480
    s_mul_i32 s72, s73, 5120
    s_add_u32 s66, s66, s72
    s_add_u32 s66, s66, 2686976
    s_lshl_b32 s74, s74, 8
    s_lshl2_add_u32 s74, s73, s74
    s_lshl_b32 s74, s74, 2
    s_add_u32 s7, s74, 32768
    s_cmp_ge_u32 s75, 108
    s_cselect_b32 s66, 134217728, s66
    s_cselect_b32 s7, 134217728, s7
    buffer_store_dwordx4 a[20:23], v8, s[32:35], s66 offen offset:0 sc1
    buffer_store_dwordx4 a[24:27], v8, s[32:35], s66 offen offset:1024 sc1
    v_pk_fma_f32 v[208:209], v[208:209], v[182:183], v[228:229] op_sel:[1,1,0] op_sel_hi:[1,0,1] neg_lo:[1,0,0]
    v_cvt_pk_bf16_f32 v242, v224, v225
    v_cvt_pk_bf16_f32 v237, v208, -v209
    v_pk_mul_f32 v[234:235], v[226:227], v[180:181] op_sel_hi:[0,1]
    v_pk_mul_f32 v[230:231], v[208:209], v[182:183] op_sel_hi:[0,1]
    v_pk_fma_f32 v[226:227], v[226:227], v[180:181], v[234:235] op_sel:[1,1,0] op_sel_hi:[1,0,1] neg_lo:[1,0,0]
    ds_write_addtid_b32 v242 offset:13600
    ds_write_addtid_b32 v237 offset:3808
    v_pk_fma_f32 v[208:209], v[208:209], v[182:183], v[230:231] op_sel:[1,1,0] op_sel_hi:[1,0,1] neg_lo:[1,0,0]
    v_cvt_pk_bf16_f32 v243, v226, v227
    v_cvt_pk_bf16_f32 v238, v208, -v209
    v_pk_mul_f32 v[232:233], v[212:213], v[180:181] op_sel_hi:[0,1]
    v_pk_mul_f32 v[228:229], v[208:209], v[182:183] op_sel_hi:[0,1]
    buffer_store_dwordx4 a[28:31], v8, s[32:35], s66 offen offset:2048 sc1
    v_pk_fma_f32 v[212:213], v[212:213], v[180:181], v[232:233] op_sel:[1,1,0] op_sel_hi:[1,0,1] neg_lo:[1,0,0]
    ds_write_addtid_b32 v243 offset:13872
    ds_write_addtid_b32 v238 offset:6800
    v_pk_fma_f32 v[208:209], v[208:209], v[182:183], v[228:229] op_sel:[1,1,0] op_sel_hi:[1,0,1] neg_lo:[1,0,0]
    v_cvt_pk_bf16_f32 v240, v212, v213
    v_cvt_pk_bf16_f32 v239, v208, -v209
    v_pk_mul_f32 v[234:235], v[214:215], v[180:181] op_sel_hi:[0,1]
    v_pk_fma_f32 v[214:215], v[214:215], v[180:181], v[234:235] op_sel:[1,1,0] op_sel_hi:[1,0,1] neg_lo:[1,0,0]
    ds_write_addtid_b32 v240 offset:14144
    ds_write_addtid_b32 v239 offset:4080
    v_cvt_pk_bf16_f32 v241, v214, v215
    buffer_store_dwordx4 a[32:35], v8, s[32:35], s66 offen offset:3072 sc1
    v_pk_mul_f32 v[232:233], v[216:217], v[180:181] op_sel_hi:[0,1]
    v_pk_fma_f32 v[216:217], v[216:217], v[180:181], v[232:233] op_sel:[1,1,0] op_sel_hi:[1,0,1] neg_lo:[1,0,0]
    v_cvt_pk_bf16_f32 v242, v216, v217
    v_pk_mul_f32 v[234:235], v[218:219], v[180:181] op_sel_hi:[0,1]
    ds_write_addtid_b32 v241 offset:14416
    ds_write_addtid_b32 v242 offset:14688
    v_pk_fma_f32 v[218:219], v[218:219], v[180:181], v[234:235] op_sel:[1,1,0] op_sel_hi:[1,0,1] neg_lo:[1,0,0]
    v_cvt_pk_bf16_f32 v243, v218, v219
    v_pk_mul_f32 v[232:233], v[220:221], v[180:181] op_sel_hi:[0,1]
    v_pk_fma_f32 v[220:221], v[220:221], v[180:181], v[232:233] op_sel:[1,1,0] op_sel_hi:[1,0,1] neg_lo:[1,0,0]
    v_cvt_pk_bf16_f32 v240, v220, v221
    v_pk_mul_f32 v[234:235], v[222:223], v[180:181] op_sel_hi:[0,1]
    ds_write_addtid_b32 v243 offset:14960
    s_add_u32 s66, s66, 4096
    buffer_store_dwordx4 a[36:39], v8, s[32:35], s66 offen offset:0 sc1
    ds_write_addtid_b32 v240 offset:15232
    v_pk_fma_f32 v[222:223], v[222:223], v[180:181], v[234:235] op_sel:[1,1,0] op_sel_hi:[1,0,1] neg_lo:[1,0,0]
    v_cvt_pk_bf16_f32 v241, v222, v223
    v_pk_mul_f32 v[232:233], v[224:225], v[180:181] op_sel_hi:[0,1]
    v_pk_fma_f32 v[224:225], v[224:225], v[180:181], v[232:233] op_sel:[1,1,0] op_sel_hi:[1,0,1] neg_lo:[1,0,0]
    v_cvt_pk_bf16_f32 v242, v224, v225
    v_pk_mul_f32 v[234:235], v[226:227], v[180:181] op_sel_hi:[0,1]
    ds_write_addtid_b32 v241 offset:15504
    ds_write_addtid_b32 v242 offset:15776
    v_pk_fma_f32 v[226:227], v[226:227], v[180:181], v[234:235] op_sel:[1,1,0] op_sel_hi:[1,0,1] neg_lo:[1,0,0]
    v_cvt_pk_bf16_f32 v243, v226, v227
    s_add_u32 s75, s64, 80
    s_and_b32 s74, s75, 1
    s_lshl2_add_u32 s74, s74, s3
    s_lshr_b32 s73, s75, 1
    s_mul_i32 s66, s74, 276480
    s_mul_i32 s72, s73, 5120
    s_add_u32 s66, s66, s72
    s_add_u32 s66, s66, 2686976
    s_lshl_b32 s74, s74, 8
    s_lshl2_add_u32 s74, s73, s74
    s_lshl_b32 s74, s74, 2
    s_add_u32 s8, s74, 32768
    s_cmp_ge_u32 s75, 108
    s_cselect_b32 s66, 134217728, s66
    s_cselect_b32 s8, 134217728, s8
    buffer_store_dwordx4 a[40:43], v8, s[32:35], s66 offen offset:0 sc1
    buffer_store_dwordx4 a[44:47], v8, s[32:35], s66 offen offset:1024 sc1
    ds_write_addtid_b32 v243 offset:16048
    v_and_b32 v6, 31, v1
    v_mul_u32_u24 v6, 272, v6
    v_lshrrev_b32 v7, 5, v1
    v_lshl_add_u32 v6, v7, 4, v6
    v_add_u32 v6, s83, v6
    s_mov_b32 vcc_lo, 0xc000
    s_mov_b32 vcc_hi, vcc_lo
    v_add_u32 v7, 3264, v6
    v_cndmask_b32 v7, v6, v7, vcc
    s_mov_b32 exec_lo, 0x30000000
    s_mov_b32 exec_hi, exec_lo
    v_subrev_u32 v7, 3808, v6
    s_lshl_b64 exec, exec, 2
    v_subrev_u32 v7, 4352, v6
    s_mov_b64 exec, -1
    s_waitcnt lgkmcnt(0)
    ds_read_b128 v[176:179], v7 offset:0
    ds_read_b128 v[180:183], v6 offset:7616
    ds_read_b128 v[184:187], v7 offset:32
    ds_read_b128 v[188:191], v6 offset:7648
    ds_read_b128 v[192:195], v7 offset:64
    ds_read_b128 v[196:199], v6 offset:7680
    ds_read_b128 v[200:203], v7 offset:96
    ds_read_b128 v[204:207], v6 offset:7712
    ds_read_b128 v[208:211], v7 offset:128
    ds_read_b128 v[212:215], v6 offset:7744
    ds_read_b128 v[216:219], v7 offset:160
    ds_read_b128 v[220:223], v6 offset:7776
    ds_read_b128 v[224:227], v7 offset:192
    ds_read_b128 v[228:231], v6 offset:7808
    s_waitcnt lgkmcnt(12)
    v_mfma_f32_32x32x16_bf16 v[64:79], v[176:179], v[180:183], 0
    ds_read_b128 v[232:235], v7 offset:224
    ds_read_b128 v[236:239], v6 offset:7840
    buffer_store_dwordx4 a[48:51], v8, s[32:35], s66 offen offset:2048 sc1
    s_waitcnt lgkmcnt(12)
    v_mfma_f32_32x32x16_bf16 v[64:79], v[184:187], v[188:191], v[64:79]
    s_waitcnt lgkmcnt(10)
    v_mfma_f32_32x32x16_bf16 v[64:79], v[192:195], v[196:199], v[64:79]
    s_waitcnt lgkmcnt(8)
    v_mfma_f32_32x32x16_bf16 v[64:79], v[200:203], v[204:207], v[64:79]
    s_waitcnt lgkmcnt(6)
    v_mfma_f32_32x32x16_bf16 v[64:79], v[208:211], v[212:215], v[64:79]
    buffer_store_dwordx4 a[52:55], v8, s[32:35], s66 offen offset:3072 sc1
    s_add_u32 s66, s66, 4096
    s_waitcnt lgkmcnt(4)
    v_mfma_f32_32x32x16_bf16 v[64:79], v[216:219], v[220:223], v[64:79]
    s_waitcnt lgkmcnt(2)
    v_mfma_f32_32x32x16_bf16 v[64:79], v[224:227], v[228:231], v[64:79]
    s_waitcnt lgkmcnt(0)
    v_mfma_f32_32x32x16_bf16 v[64:79], v[232:235], v[236:239], v[64:79]
    buffer_store_dwordx4 a[56:59], v8, s[32:35], s66 offen offset:0 sc1
    s_waitcnt vmcnt(15)
    v_cmp_ne_u32 vcc, v25, v24
    s_cbranch_vccnz c2h_slow
c2h_ok:
    s_bitcmp1_b32 s3, 0
    s_cselect_b32 s76, 0, 16
    s_lshl_b32 s77, s79, s76
    s_and_b32 s77, s77, 0xffff0000
    s_mov_b32 m0, s83
    v_mov_b32 v6, 0x3fb8aa3b
    v_mul_f32 v7, s77, v6
    s_lshr_b32 s67, s82, 2
    s_mul_i32 s67, s67, 496
    s_lshl_b32 s75, s82, 2
    s_add_u32 s67, s67, s75
    s_mul_i32 s75, s3, 655360
    s_add_u32 s67, s67, s75
    s_add_u32 s67, s67, 65536
    v_lshrrev_b32 v2, 4, v1
    v_mul_u32_u24 v2, 40960, v2
    v_and_b32 v3, 15, v1
    v_lshl_add_u32 v148, v3, 5, v2
    buffer_load_dwordx2 v[128:129], v148, s[32:35], s67 offen offset:0 sc1
    v_lshlrev_b32 v60, 16, v60
    v_exp_f32 v7, v7
    v_mul_f32 v60, v60, v6
    v_lshlrev_b32 v61, 16, v61
    v_exp_f32 v60, v60
    s_waitcnt vmcnt(1)
    s_mov_b64 exec, 1
    buffer_store_dword v25, off, s[32:35], s6 sc1
    s_mov_b64 exec, -1
    s_mov_b64 exec, 1
    buffer_store_dword v25, off, s[32:35], s7 sc1
    s_mov_b64 exec, -1
    s_mov_b64 exec, 1
    buffer_store_dword v25, off, s[32:35], s8 sc1
    s_mov_b64 exec, -1
    v_cvt_pk_bf16_f32 v7, v7, v7
    v_lshlrev_b32 v62, 16, v62
    v_lshlrev_b32 v7, 16, v7
    v_cvt_pk_bf16_f32 v60, v60, v60
    v_lshlrev_b32 v63, 16, v63
    v_lshlrev_b32 v60, 16, v60
    v_mul_f32 v61, v61, v7
    v_mul_f32 v60, v60, v7
    v_add_f32 v7, v7, v7
    v_mul_f32 v61, 0.15915494, v61
    v_mul_f32 v60, 0xbfb8aa3b, v60
    v_mul_f32 v192, v62, v7
    v_mul_f32 v193, v63, v7
    buffer_load_dwordx2 v[130:131], v148, s[32:35], s67 offen offset:16 sc1
    s_add_u32 s67, s67, 163840
    v_mul_f32 v186, 0x41000000, v60
    v_mul_f32 v187, 0x41000000, v61
    v_mul_f32 v188, 0x42800000, v60
    v_mul_f32 v189, 0x42800000, v61
    v_mul_f32 v190, 0x43800000, v60
    v_mul_f32 v191, 0x43800000, v61
    v_fract_f32 v185, v61
    v_fract_f32 v187, v187
    v_fract_f32 v189, v189
    v_fract_f32 v191, v191
    v_exp_f32 v184, v60
    v_cos_f32 v176, v185
    v_sin_f32 v177, v185
    v_exp_f32 v186, v186
    v_cos_f32 v178, v187
    v_sin_f32 v179, v187
    v_exp_f32 v188, v188
    v_cos_f32 v180, v189
    v_sin_f32 v181, v189
    v_exp_f32 v190, v190
    v_cos_f32 v182, v191
    buffer_load_dwordx2 v[132:133], v148, s[32:35], s67 offen offset:0 sc1
    v_sin_f32 v183, v191
    v_mov_b32 v212, 1.0
    v_mov_b32 v213, 0
    v_pk_mul_f32 v[176:177], v[176:177], v[184:185] op_sel_hi:[1,0]
    v_pk_mul_f32 v[178:179], v[178:179], v[186:187] op_sel_hi:[1,0]
    v_pk_mul_f32 v[180:181], v[180:181], v[188:189] op_sel_hi:[1,0]
    v_pk_mul_f32 v[182:183], v[182:183], v[190:191] op_sel_hi:[1,0]
    v_cvt_pk_bf16_f32 v236, v192, -v193
    v_cvt_pk_bf16_f32 v240, v212, v213
    v_pk_mul_f32 v[228:229], v[192:193], v[176:177] op_sel_hi:[0,1]
    v_cvt_pk_bf16_f32 v241, v178, v179
    ds_write_addtid_b32 v236 offset:0
    ds_write_addtid_b32 v240 offset:7616
    v_pk_fma_f32 v[194:195], v[192:193], v[176:177], v[228:229] op_sel:[1,1,0] op_sel_hi:[1,0,1] neg_lo:[1,0,0]
    v_pk_mul_f32 v[232:233], v[178:179], v[178:179] op_sel_hi:[0,1]
    v_cvt_pk_bf16_f32 v237, v194, -v195
    v_pk_fma_f32 v[216:217], v[178:179], v[178:179], v[232:233] op_sel:[1,1,0] op_sel_hi:[1,0,1] neg_lo:[1,0,0]
    v_pk_mul_f32 v[230:231], v[194:195], v[176:177] op_sel_hi:[0,1]
    v_cvt_pk_bf16_f32 v242, v216, v217
    ds_write_addtid_b32 v241 offset:7888
    ds_write_addtid_b32 v237 offset:272
    v_pk_fma_f32 v[196:197], v[194:195], v[176:177], v[230:231] op_sel:[1,1,0] op_sel_hi:[1,0,1] neg_lo:[1,0,0]
    v_pk_mul_f32 v[234:235], v[216:217], v[178:179] op_sel_hi:[0,1]
    v_cvt_pk_bf16_f32 v238, v196, -v197
    v_pk_fma_f32 v[218:219], v[216:217], v[178:179], v[234:235] op_sel:[1,1,0] op_sel_hi:[1,0,1] neg_lo:[1,0,0]
    v_pk_mul_f32 v[228:229], v[196:197], v[176:177] op_sel_hi:[0,1]
    v_cvt_pk_bf16_f32 v243, v218, v219
    ds_write_addtid_b32 v242 offset:8160
    buffer_load_dwordx2 v[134:135], v148, s[32:35], s67 offen offset:16 sc1
    s_add_u32 s67, s67, 163840
    ds_write_addtid_b32 v238 offset:544
    v_pk_fma_f32 v[198:199], v[196:197], v[176:177], v[228:229] op_sel:[1,1,0] op_sel_hi:[1,0,1] neg_lo:[1,0,0]
    v_pk_mul_f32 v[232:233], v[218:219], v[178:179] op_sel_hi:[0,1]
    v_cvt_pk_bf16_f32 v239, v198, -v199
    v_pk_fma_f32 v[220:221], v[218:219], v[178:179], v[232:233] op_sel:[1,1,0] op_sel_hi:[1,0,1] neg_lo:[1,0,0]
    v_pk_mul_f32 v[230:231], v[198:199], v[176:177] op_sel_hi:[0,1]
    v_cvt_pk_bf16_f32 v240, v220, v221
    ds_write_addtid_b32 v243 offset:8432
    ds_write_addtid_b32 v239 offset:816
    v_pk_fma_f32 v[200:201], v[198:199], v[176:177], v[230:231] op_sel:[1,1,0] op_sel_hi:[1,0,1] neg_lo:[1,0,0]
    v_pk_mul_f32 v[234:235], v[220:221], v[178:179] op_sel_hi:[0,1]
    v_cvt_pk_bf16_f32 v236, v200, -v201
    v_pk_fma_f32 v[222:223], v[220:221], v[178:179], v[234:235] op_sel:[1,1,0] op_sel_hi:[1,0,1] neg_lo:[1,0,0]
    v_pk_mul_f32 v[228:229], v[200:201], v[176:177] op_sel_hi:[0,1]
    v_cvt_pk_bf16_f32 v241, v222, v223
    ds_write_addtid_b32 v240 offset:8704
    ds_write_addtid_b32 v236 offset:2176
    v_pk_fma_f32 v[202:203], v[200:201], v[176:177], v[228:229] op_sel:[1,1,0] op_sel_hi:[1,0,1] neg_lo:[1,0,0]
    v_pk_mul_f32 v[232:233], v[222:223], v[178:179] op_sel_hi:[0,1]
    v_cvt_pk_bf16_f32 v237, v202, -v203
    v_pk_fma_f32 v[224:225], v[222:223], v[178:179], v[232:233] op_sel:[1,1,0] op_sel_hi:[1,0,1] neg_lo:[1,0,0]
    v_pk_mul_f32 v[230:231], v[202:203], v[176:177] op_sel_hi:[0,1]
    v_cvt_pk_bf16_f32 v242, v224, v225
    ds_write_addtid_b32 v241 offset:8976
    ds_write_addtid_b32 v237 offset:2448
    buffer_load_dwordx2 v[136:137], v148, s[32:35], s67 offen offset:0 sc1
    v_pk_fma_f32 v[204:205], v[202:203], v[176:177], v[230:231] op_sel:[1,1,0] op_sel_hi:[1,0,1] neg_lo:[1,0,0]
    v_pk_mul_f32 v[234:235], v[224:225], v[178:179] op_sel_hi:[0,1]
    v_cvt_pk_bf16_f32 v238, v204, -v205
    v_pk_fma_f32 v[226:227], v[224:225], v[178:179], v[234:235] op_sel:[1,1,0] op_sel_hi:[1,0,1] neg_lo:[1,0,0]
    v_pk_mul_f32 v[228:229], v[204:205], v[176:177] op_sel_hi:[0,1]
    v_cvt_pk_bf16_f32 v243, v226, v227
    ds_write_addtid_b32 v242 offset:9248
    ds_write_addtid_b32 v238 offset:2720
    v_pk_fma_f32 v[206:207], v[204:205], v[176:177], v[228:229] op_sel:[1,1,0] op_sel_hi:[1,0,1] neg_lo:[1,0,0]
    v_cvt_pk_bf16_f32 v240, v180, v181
    v_cvt_pk_bf16_f32 v239, v206, -v207
    v_pk_mul_f32 v[234:235], v[178:179], v[180:181] op_sel_hi:[0,1]
    ds_write_addtid_b32 v243 offset:9520
    ds_write_addtid_b32 v240 offset:9792
    v_pk_mul_f32 v[230:231], v[206:207], v[176:177] op_sel_hi:[0,1]
    v_pk_fma_f32 v[214:215], v[178:179], v[180:181], v[234:235] op_sel:[1,1,0] op_sel_hi:[1,0,1] neg_lo:[1,0,0]
    v_pk_fma_f32 v[208:209], v[206:207], v[176:177], v[230:231] op_sel:[1,1,0] op_sel_hi:[1,0,1] neg_lo:[1,0,0]
    v_cvt_pk_bf16_f32 v241, v214, v215
    v_cvt_pk_bf16_f32 v236, v208, -v209
    v_pk_mul_f32 v[232:233], v[216:217], v[180:181] op_sel_hi:[0,1]
    ds_write_addtid_b32 v239 offset:2992
    ds_write_addtid_b32 v241 offset:10064
    v_pk_mul_f32 v[228:229], v[192:193], v[182:183] op_sel_hi:[0,1]
    v_pk_fma_f32 v[216:217], v[216:217], v[180:181], v[232:233] op_sel:[1,1,0] op_sel_hi:[1,0,1] neg_lo:[1,0,0]
    v_pk_fma_f32 v[192:193], v[192:193], v[182:183], v[228:229] op_sel:[1,1,0] op_sel_hi:[1,0,1] neg_lo:[1,0,0]
    v_cvt_pk_bf16_f32 v242, v216, v217
    v_cvt_pk_bf16_f32 v237, v192, -v193
    buffer_load_dwordx2 v[138:139], v148, s[32:35], s67 offen offset:16 sc1
    s_add_u32 s67, s67, 163840
    v_pk_mul_f32 v[234:235], v[218:219], v[180:181] op_sel_hi:[0,1]
    ds_write_addtid_b32 v236 offset:4352
    ds_write_addtid_b32 v242 offset:10336
    v_pk_mul_f32 v[230:231], v[196:197], v[182:183] op_sel_hi:[0,1]
    v_pk_fma_f32 v[218:219], v[218:219], v[180:181], v[234:235] op_sel:[1,1,0] op_sel_hi:[1,0,1] neg_lo:[1,0,0]
    ds_write_addtid_b32 v237 offset:1088
    ds_write_addtid_b32 v237 offset:1360
    v_pk_fma_f32 v[196:197], v[196:197], v[182:183], v[230:231] op_sel:[1,1,0] op_sel_hi:[1,0,1] neg_lo:[1,0,0]
    v_cvt_pk_bf16_f32 v243, v218, v219
    v_cvt_pk_bf16_f32 v238, v196, -v197
    v_pk_mul_f32 v[232:233], v[220:221], v[180:181] op_sel_hi:[0,1]
    v_pk_mul_f32 v[228:229], v[200:201], v[182:183] op_sel_hi:[0,1]
    v_pk_fma_f32 v[220:221], v[220:221], v[180:181], v[232:233] op_sel:[1,1,0] op_sel_hi:[1,0,1] neg_lo:[1,0,0]
    ds_write_addtid_b32 v243 offset:10608
    ds_write_addtid_b32 v238 offset:1632
    v_pk_fma_f32 v[200:201], v[200:201], v[182:183], v[228:229] op_sel:[1,1,0] op_sel_hi:[1,0,1] neg_lo:[1,0,0]
    v_cvt_pk_bf16_f32 v240, v220, v221
    v_cvt_pk_bf16_f32 v239, v200, -v201
    v_pk_mul_f32 v[234:235], v[222:223], v[180:181] op_sel_hi:[0,1]
    v_pk_mul_f32 v[230:231], v[204:205], v[182:183] op_sel_hi:[0,1]
    v_pk_fma_f32 v[222:223], v[222:223], v[180:181], v[234:235] op_sel:[1,1,0] op_sel_hi:[1,0,1] neg_lo:[1,0,0]
    ds_write_addtid_b32 v240 offset:10880
    ds_write_addtid_b32 v239 offset:1904
    ds_write_addtid_b32 v239 offset:3264
    buffer_load_dwordx2 v[140:141], v148, s[32:35], s67 offen offset:0 sc1
    ds_write_addtid_b32 v239 offset:3536
    v_pk_fma_f32 v[204:205], v[204:205], v[182:183], v[230:231] op_sel:[1,1,0] op_sel_hi:[1,0,1] neg_lo:[1,0,0]
    v_cvt_pk_bf16_f32 v241, v222, v223
    v_cvt_pk_bf16_f32 v236, v204, -v205
    v_pk_mul_f32 v[232:233], v[224:225], v[180:181] op_sel_hi:[0,1]
    v_pk_mul_f32 v[228:229], v[208:209], v[182:183] op_sel_hi:[0,1]
    v_pk_fma_f32 v[224:225], v[224:225], v[180:181], v[232:233] op_sel:[1,1,0] op_sel_hi:[1,0,1] neg_lo:[1,0,0]
    ds_write_addtid_b32 v241 offset:11152
    ds_write_addtid_b32 v236 offset:7072
    v_pk_fma_f32 v[208:209], v[208:209], v[182:183], v[228:229] op_sel:[1,1,0] op_sel_hi:[1,0,1] neg_lo:[1,0,0]
    v_cvt_pk_bf16_f32 v242, v224, v225
    v_cvt_pk_bf16_f32 v237, v208, -v209
    v_pk_mul_f32 v[234:235], v[226:227], v[180:181] op_sel_hi:[0,1]
    v_pk_mul_f32 v[230:231], v[192:193], v[182:183] op_sel_hi:[0,1]
    v_pk_fma_f32 v[226:227], v[226:227], v[180:181], v[234:235] op_sel:[1,1,0] op_sel_hi:[1,0,1] neg_lo:[1,0,0]
    ds_write_addtid_b32 v242 offset:11424
    ds_write_addtid_b32 v237 offset:7344
    ds_write_addtid_b32 v237 offset:5440
    v_pk_fma_f32 v[192:193], v[192:193], v[182:183], v[230:231] op_sel:[1,1,0] op_sel_hi:[1,0,1] neg_lo:[1,0,0]
    v_cvt_pk_bf16_f32 v243, v226, v227
    v_cvt_pk_bf16_f32 v238, v192, -v193
    v_pk_mul_f32 v[232:233], v[180:181], v[180:181] op_sel_hi:[0,1]
    v_pk_mul_f32 v[228:229], v[200:201], v[182:183] op_sel_hi:[0,1]
    v_pk_fma_f32 v[212:213], v[180:181], v[180:181], v[232:233] op_sel:[1,1,0] op_sel_hi:[1,0,1] neg_lo:[1,0,0]
    ds_write_addtid_b32 v243 offset:11696
    ds_write_addtid_b32 v238 offset:4624
    buffer_load_dwordx2 v[142:143], v148, s[32:35], s67 offen offset:16 sc1
    v_pk_fma_f32 v[200:201], v[200:201], v[182:183], v[228:229] op_sel:[1,1,0] op_sel_hi:[1,0,1] neg_lo:[1,0,0]
    v_cvt_pk_bf16_f32 v240, v212, v213
    v_cvt_pk_bf16_f32 v239, v200, -v201
    v_pk_mul_f32 v[234:235], v[214:215], v[180:181] op_sel_hi:[0,1]
    v_pk_mul_f32 v[230:231], v[208:209], v[182:183] op_sel_hi:[0,1]
    v_pk_fma_f32 v[214:215], v[214:215], v[180:181], v[234:235] op_sel:[1,1,0] op_sel_hi:[1,0,1] neg_lo:[1,0,0]
    ds_write_addtid_b32 v240 offset:11968
    ds_write_addtid_b32 v239 offset:4896
    v_pk_fma_f32 v[208:209], v[208:209], v[182:183], v[230:231] op_sel:[1,1,0] op_sel_hi:[1,0,1] neg_lo:[1,0,0]
    v_cvt_pk_bf16_f32 v241, v214, v215
    v_cvt_pk_bf16_f32 v236, v208, -v209
    v_pk_mul_f32 v[232:233], v[216:217], v[180:181] op_sel_hi:[0,1]
    v_pk_mul_f32 v[228:229], v[192:193], v[182:183] op_sel_hi:[0,1]
    v_pk_fma_f32 v[216:217], v[216:217], v[180:181], v[232:233] op_sel:[1,1,0] op_sel_hi:[1,0,1] neg_lo:[1,0,0]
    ds_write_addtid_b32 v241 offset:12240
    ds_write_addtid_b32 v236 offset:5168
    v_pk_fma_f32 v[192:193], v[192:193], v[182:183], v[228:229] op_sel:[1,1,0] op_sel_hi:[1,0,1] neg_lo:[1,0,0]
    v_cvt_pk_bf16_f32 v242, v216, v217
    v_cvt_pk_bf16_f32 v237, v192, -v193
    v_pk_mul_f32 v[234:235], v[218:219], v[180:181] op_sel_hi:[0,1]
    v_pk_mul_f32 v[230:231], v[200:201], v[182:183] op_sel_hi:[0,1]
    v_pk_fma_f32 v[218:219], v[218:219], v[180:181], v[234:235] op_sel:[1,1,0] op_sel_hi:[1,0,1] neg_lo:[1,0,0]
    ds_write_addtid_b32 v242 offset:12512
    ds_write_addtid_b32 v237 offset:5712
    v_pk_fma_f32 v[200:201], v[200:201], v[182:183], v[230:231] op_sel:[1,1,0] op_sel_hi:[1,0,1] neg_lo:[1,0,0]
    v_cvt_pk_bf16_f32 v243, v218, v219
    v_cvt_pk_bf16_f32 v238, v200, -v201
    v_pk_mul_f32 v[232:233], v[220:221], v[180:181] op_sel_hi:[0,1]
    v_pk_mul_f32 v[228:229], v[208:209], v[182:183] op_sel_hi:[0,1]
    v_pk_fma_f32 v[220:221], v[220:221], v[180:181], v[232:233] op_sel:[1,1,0] op_sel_hi:[1,0,1] neg_lo:[1,0,0]
    ds_write_addtid_b32 v243 offset:12784
    ds_write_addtid_b32 v238 offset:5984
    v_pk_fma_f32 v[208:209], v[208:209], v[182:183], v[228:229] op_sel:[1,1,0] op_sel_hi:[1,0,1] neg_lo:[1,0,0]
    v_cvt_pk_bf16_f32 v240, v220, v221
    v_cvt_pk_bf16_f32 v239, v208, -v209
    v_pk_mul_f32 v[234:235], v[222:223], v[180:181] op_sel_hi:[0,1]
    v_pk_mul_f32 v[230:231], v[208:209], v[182:183] op_sel_hi:[0,1]
    v_pk_fma_f32 v[222:223], v[222:223], v[180:181], v[234:235] op_sel:[1,1,0] op_sel_hi:[1,0,1] neg_lo:[1,0,0]
    ds_write_addtid_b32 v240 offset:13056
    ds_write_addtid_b32 v239 offset:6256
    v_pk_fma_f32 v[208:209], v[208:209], v[182:183], v[230:231] op_sel:[1,1,0] op_sel_hi:[1,0,1] neg_lo:[1,0,0]
    v_cvt_pk_bf16_f32 v241, v222, v223
    v_cvt_pk_bf16_f32 v236, v208, -v209
    v_pk_mul_f32 v[232:233], v[224:225], v[180:181] op_sel_hi:[0,1]
    v_pk_mul_f32 v[228:229], v[208:209], v[182:183] op_sel_hi:[0,1]
    v_pk_fma_f32 v[224:225], v[224:225], v[180:181], v[232:233] op_sel:[1,1,0] op_sel_hi:[1,0,1] neg_lo:[1,0,0]
    ds_write_addtid_b32 v241 offset:13328
    ds_write_addtid_b32 v236 offset:6528
    v_pk_fma_f32 v[208:209], v[208:209], v[182:183], v[228:229] op_sel:[1,1,0] op_sel_hi:[1,0,1] neg_lo:[1,0,0]
    v_cvt_pk_bf16_f32 v242, v224, v225
    v_cvt_pk_bf16_f32 v237, v208, -v209
    v_pk_mul_f32 v[234:235], v[226:227], v[180:181] op_sel_hi:[0,1]
    v_pk_mul_f32 v[230:231], v[208:209], v[182:183] op_sel_hi:[0,1]
    v_pk_fma_f32 v[226:227], v[226:227], v[180:181], v[234:235] op_sel:[1,1,0] op_sel_hi:[1,0,1] neg_lo:[1,0,0]
    ds_write_addtid_b32 v242 offset:13600
    ds_write_addtid_b32 v237 offset:3808
    v_pk_fma_f32 v[208:209], v[208:209], v[182:183], v[230:231] op_sel:[1,1,0] op_sel_hi:[1,0,1] neg_lo:[1,0,0]
    v_cvt_pk_bf16_f32 v243, v226, v227
    v_cvt_pk_bf16_f32 v238, v208, -v209
    v_pk_mul_f32 v[232:233], v[212:213], v[180:181] op_sel_hi:[0,1]
    v_pk_mul_f32 v[228:229], v[208:209], v[182:183] op_sel_hi:[0,1]
    v_pk_fma_f32 v[212:213], v[212:213], v[180:181], v[232:233] op_sel:[1,1,0] op_sel_hi:[1,0,1] neg_lo:[1,0,0]
    ds_write_addtid_b32 v243 offset:13872
    ds_write_addtid_b32 v238 offset:6800
    v_pk_fma_f32 v[208:209], v[208:209], v[182:183], v[228:229] op_sel:[1,1,0] op_sel_hi:[1,0,1] neg_lo:[1,0,0]
    v_cvt_pk_bf16_f32 v240, v212, v213
    v_cvt_pk_bf16_f32 v239, v208, -v209
    v_pk_mul_f32 v[234:235], v[214:215], v[180:181] op_sel_hi:[0,1]
    v_pk_fma_f32 v[214:215], v[214:215], v[180:181], v[234:235] op_sel:[1,1,0] op_sel_hi:[1,0,1] neg_lo:[1,0,0]
    ds_write_addtid_b32 v240 offset:14144
    ds_write_addtid_b32 v239 offset:4080
    v_cvt_pk_bf16_f32 v241, v214, v215
    v_pk_mul_f32 v[232:233], v[216:217], v[180:181] op_sel_hi:[0,1]
    v_pk_fma_f32 v[216:217], v[216:217], v[180:181], v[232:233] op_sel:[1,1,0] op_sel_hi:[1,0,1] neg_lo:[1,0,0]
    v_cvt_pk_bf16_f32 v242, v216, v217
    v_pk_mul_f32 v[234:235], v[218:219], v[180:181] op_sel_hi:[0,1]
    ds_write_addtid_b32 v241 offset:14416
    ds_write_addtid_b32 v242 offset:14688
    v_pk_fma_f32 v[218:219], v[218:219], v[180:181], v[234:235] op_sel:[1,1,0] op_sel_hi:[1,0,1] neg_lo:[1,0,0]
    v_cvt_pk_bf16_f32 v243, v218, v219
    v_pk_mul_f32 v[232:233], v[220:221], v[180:181] op_sel_hi:[0,1]
    v_pk_fma_f32 v[220:221], v[220:221], v[180:181], v[232:233] op_sel:[1,1,0] op_sel_hi:[1,0,1] neg_lo:[1,0,0]
    v_cvt_pk_bf16_f32 v240, v220, v221
    v_pk_mul_f32 v[234:235], v[222:223], v[180:181] op_sel_hi:[0,1]
    ds_write_addtid_b32 v243 offset:14960
    ds_write_addtid_b32 v240 offset:15232
    v_pk_fma_f32 v[222:223], v[222:223], v[180:181], v[234:235] op_sel:[1,1,0] op_sel_hi:[1,0,1] neg_lo:[1,0,0]
    v_cvt_pk_bf16_f32 v241, v222, v223
    v_pk_mul_f32 v[232:233], v[224:225], v[180:181] op_sel_hi:[0,1]
    v_pk_fma_f32 v[224:225], v[224:225], v[180:181], v[232:233] op_sel:[1,1,0] op_sel_hi:[1,0,1] neg_lo:[1,0,0]
    v_cvt_pk_bf16_f32 v242, v224, v225
    v_pk_mul_f32 v[234:235], v[226:227], v[180:181] op_sel_hi:[0,1]
    ds_write_addtid_b32 v241 offset:15504
    ds_write_addtid_b32 v242 offset:15776
    v_pk_fma_f32 v[226:227], v[226:227], v[180:181], v[234:235] op_sel:[1,1,0] op_sel_hi:[1,0,1] neg_lo:[1,0,0]
    v_cvt_pk_bf16_f32 v243, v226, v227
    ds_write_addtid_b32 v243 offset:16048
    v_and_b32 v6, 31, v1
    v_mul_u32_u24 v6, 272, v6
    v_lshrrev_b32 v7, 5, v1
    v_lshl_add_u32 v6, v7, 4, v6
    v_add_u32 v6, s83, v6
    s_mov_b32 vcc_lo, 0xc000
    s_mov_b32 vcc_hi, vcc_lo
    v_add_u32 v7, 3264, v6
    v_cndmask_b32 v7, v6, v7, vcc
    s_mov_b32 exec_lo, 0x30000000
    s_mov_b32 exec_hi, exec_lo
    v_subrev_u32 v7, 3808, v6
    s_lshl_b64 exec, exec, 2
    v_subrev_u32 v7, 4352, v6
    s_mov_b64 exec, -1
    s_waitcnt lgkmcnt(0)
    ds_read_b128 v[176:179], v7 offset:0
    ds_read_b128 v[180:183], v6 offset:7616
    ds_read_b128 v[184:187], v7 offset:32
    ds_read_b128 v[188:191], v6 offset:7648
    ds_read_b128 v[192:195], v7 offset:64
    ds_read_b128 v[196:199], v6 offset:7680
    ds_read_b128 v[200:203], v7 offset:96
    ds_read_b128 v[204:207], v6 offset:7712
    ds_read_b128 v[208:211], v7 offset:128
    ds_read_b128 v[212:215], v6 offset:7744
    ds_read_b128 v[216:219], v7 offset:160
    ds_read_b128 v[220:223], v6 offset:7776
    ds_read_b128 v[224:227], v7 offset:192
    ds_read_b128 v[228:231], v6 offset:7808
    s_waitcnt lgkmcnt(12)
    v_mfma_f32_32x32x16_bf16 v[64:79], v[176:179], v[180:183], v[64:79]
    ds_read_b128 v[232:235], v7 offset:224
    ds_read_b128 v[236:239], v6 offset:7840
    v_and_b32 v2, 15, v1
    v_lshrrev_b32 v3, 4, v1
    v_mul_u32_u24 v26, 176, v2
    s_waitcnt lgkmcnt(12)
    v_mfma_f32_32x32x16_bf16 v[64:79], v[184:187], v[188:191], v[64:79]
    v_mul_u32_u24 v27, 40, v3
    s_lshl_b32 s72, s3, 12
    s_add_u32 s72, s72, 94208
    v_add3_u32 v26, v26, v27, s72
    v_mul_u32_u24 v3, 81920, v3
    s_waitcnt lgkmcnt(10)
    v_mfma_f32_32x32x16_bf16 v[64:79], v[192:195], v[196:199], v[64:79]
    v_lshl_add_u32 v27, v2, 2, v3
    s_lshr_b32 s72, s3, 1
    s_mul_i32 s72, s72, 13312
    s_and_b32 s73, s3, 1
    s_lshl_b32 s73, s73, 8
    s_waitcnt lgkmcnt(8)
    v_mfma_f32_32x32x16_bf16 v[64:79], v[200:203], v[204:207], v[64:79]
    s_sub_u32 s72, s72, s73
    s_add_u32 s73, s72, 74112
    s_add_u32 s72, s72, 65822
    v_and_b32 v2, 15, v1
    v_lshrrev_b32 v3, 4, v1
    v_and_b32 v4, 1, v1
    s_waitcnt lgkmcnt(6)
    v_mfma_f32_32x32x16_bf16 v[64:79], v[208:211], v[212:215], v[64:79]
    v_xor_b32 v4, 1, v4
    v_mul_u32_u24 v4, 4162, v4
    v_lshlrev_b32 v5, 4, v3
    v_add3_u32 v4, v4, v5, s72
    v_lshlrev_b32 v20, 1, v2
    s_waitcnt lgkmcnt(4)
    v_mfma_f32_32x32x16_bf16 v[64:79], v[216:219], v[220:223], v[64:79]
    v_sub_u32 v19, v4, v20
    v_add_u32 v18, 1024, v19
    v_add_u32 v17, 2048, v19
    v_add_u32 v16, 3072, v19
    s_sub_u32 s74, s73, 704
    s_waitcnt lgkmcnt(2)
    v_mfma_f32_32x32x16_bf16 v[64:79], v[224:227], v[228:231], v[64:79]
    v_mov_b32 v4, s74
    s_bitcmp1_b32 s3, 0
    s_cselect_b64 vcc, -1, 0
    s_cselect_b32 s74, 192, 0
    v_cndmask_b32 v18, v18, v4, vcc
    s_waitcnt lgkmcnt(0)
    v_mfma_f32_32x32x16_bf16 v[64:79], v[232:235], v[236:239], v[64:79]
    s_add_u32 s74, s74, s73
    s_sub_u32 s74, s74, 8460
    v_lshl_add_u32 v4, v2, 2, s74
    v_sub_u32 v19, v4, v5
    v_lshl_add_u32 v5, v2, 5, v5
    v_add_u32 v20, s73, v5
    v_mul_u32_u24 v3, 320, v3
    v_lshl_add_u32 v3, v2, 4, v3
    s_mul_i32 s72, s3, 10240
    s_add_u32 s72, s72, 92160
    v_add_u32 v21, s72, v3
    v_and_b32 v3, 3, v1
    v_mul_u32_u24 v3, 320, v3
    v_lshrrev_b32 v2, 2, v1
    v_lshl_add_u32 v3, v2, 4, v3
    s_mul_i32 s72, s3, 2560
    s_add_u32 s72, s72, 92160
    v_add_u32 v22, s72, v3
    v_lshrrev_b32 v2, 5, v1
    v_mul_u32_u24 v2, 40960, v2
    v_and_b32 v3, 0x1f0, v8
    v_add_u32 v29, v2, v3
    s_mul_i32 s72, s50, 221184
    s_add_u32 s72, s72, 7520256
    s_mul_i32 s73, s51, 276480
    s_add_u32 s73, s73, 2686976
    s_lshl_b32 s74, s3, 13
    s_add_u32 s52, s72, s74
    s_sub_u32 s53, s72, s74
    s_add_u32 s53, s53, 28672
    s_mul_i32 s74, s3, 10240
    s_add_u32 s54, s73, s74
    s_sub_u32 s55, s73, s74
    s_add_u32 s55, s55, 35840
    s_cmp_eq_u32 s3, 3
    s_cselect_b32 s56, 134217728, 0
    s_cmp_eq_u32 s3, 0
    s_cselect_b32 s57, 134217728, 0
    s_add_u32 s22, s52, 196608
    s_or_b32 s22, s22, s56
    s_add_u32 s23, s53, 196608
    s_or_b32 s23, s23, s57
    s_mov_b32 s62, 0xbfb8aa3b
    s_mov_b32 s63, 0xbfb8aa3b
    s_mul_i32 s77, s44, 1639
    s_lshr_b32 s77, s77, 16
    s_mul_i32 s77, s77, 96
    s_lshl_b32 s19, s44, 2
    s_add_u32 s19, s19, s77
    s_lshl_b32 s77, s3, 11
    s_add_u32 s19, s19, s77
    s_lshl_b32 s19, s19, 3
    s_add_u32 s19, s19, 14745600
    v_and_b32 v96, 15, v1
    v_lshrrev_b32 v97, 1, v1
    v_and_b32 v97, 24, v97
    v_mov_b32 v98, 4064
    v_lshlrev_b32 v98, v96, v98
    v_lshrrev_b32 v98, v97, v98
    v_bfe_u32 v99, v98, 0, 2
    v_mul_u32_u24 v99, 0x8001, v99
    v_and_b32 v99, 0x10001, v99
    v_mul_u32_u24 v40, 0x3f80, v99
    v_bfe_u32 v99, v98, 2, 2
    v_mul_u32_u24 v99, 0x8001, v99
    v_and_b32 v99, 0x10001, v99
    v_mul_u32_u24 v41, 0x3f80, v99
    v_bfe_u32 v99, v98, 4, 2
    v_mul_u32_u24 v99, 0x8001, v99
    v_and_b32 v99, 0x10001, v99
    v_mul_u32_u24 v42, 0x3f80, v99
    v_bfe_u32 v99, v98, 6, 2
    v_mul_u32_u24 v99, 0x8001, v99
    v_and_b32 v99, 0x10001, v99
    v_mul_u32_u24 v43, 0x3f80, v99
    v_mov_b32 v98, 8176
    v_lshlrev_b32 v98, v96, v98
    v_lshrrev_b32 v98, v97, v98
    v_bfe_u32 v99, v98, 0, 2
    v_mul_u32_u24 v99, 0x8001, v99
    v_and_b32 v99, 0x10001, v99
    v_mul_u32_u24 v44, 0x3f80, v99
    v_bfe_u32 v99, v98, 2, 2
    v_mul_u32_u24 v99, 0x8001, v99
    v_and_b32 v99, 0x10001, v99
    v_mul_u32_u24 v45, 0x3f80, v99
    v_bfe_u32 v99, v98, 4, 2
    v_mul_u32_u24 v99, 0x8001, v99
    v_and_b32 v99, 0x10001, v99
    v_mul_u32_u24 v46, 0x3f80, v99
    v_bfe_u32 v99, v98, 6, 2
    v_mul_u32_u24 v99, 0x8001, v99
    v_and_b32 v99, 0x10001, v99
    v_mul_u32_u24 v47, 0x3f80, v99
    s_mul_i32 s77, s82, 1639
    s_lshr_b32 s77, s77, 16
    s_mul_i32 s77, s77, 96
    s_lshl_b32 s61, s82, 2
    s_add_u32 s61, s61, s77
    s_lshl_b32 s77, s3, 11
    s_add_u32 s61, s61, s77
    s_lshl_b32 s61, s61, 3
    s_add_u32 s61, s61, 14745600
    s_cmp_eq_u32 s42, 1
    s_cselect_b32 s61, s61, 134217728
    s_add_u32 s18, s61, 32
    s_mov_b32 s46, 134217728
    s_barrier
    s_mul_i32 s72, s3, 13312
    s_bitcmp1_b32 s3, 1
    s_cselect_b32 s74, s81, s80
    s_bitcmp1_b32 s3, 0
    s_cselect_b32 s75, 0, 16
    s_lshl_b32 s74, s74, s75
    s_and_b32 s74, s74, 0xffff0000
    v_sub_u32 v2, 1008, v8
    v_add_u32 v2, s72, v2
    v_min_u32 v3, 624, v8
    v_add_u32 v3, 8160, v3
    v_mov_b32 v200, 0
    v_mov_b32 v202, 0
    v_cvt_pk_bf16_f32 v204, v76, v77
    v_lshl_add_u32 v205, v1, 1, s72
    s_mov_b64 exec, 0x3ff
    v_subrev_u32 v3, 32, v8
    s_mov_b64 exec, 3
    v_add_u32 v3, 4096, v8
    s_bfm_b64 exec, 4, 60
    v_add_u32 v3, 1024, v8
    s_bfm_b64 exec, 1, 63
    v_cvt_pk_bf16_f32 v202, v75, v75
    s_mov_b64 exec, -1
    v_add_u32 v3, s72, v3
    v_mov_b32 v203, v202
    v_and_b32 v201, 0xffff0000, v202
    ds_write_b16 v205, v204 offset:128
    ds_write_b16_d16_hi v205, v204 offset:256
    ds_write_b128 v3, v[200:203]
    v_mov_b32 v201, 0
    s_mov_b64 exec, 1
    v_add_f32 v64, s74, v64
    v_cvt_pk_bf16_f32 v200, v64, v201
    s_mov_b32 exec_lo, 3
    s_mov_b32 exec_hi, 0xf0000000
    ds_write_b128 v3, v[200:203] offset:4160
    s_mov_b64 exec, -1
    s_lshr_b32 s69, s44, 2
    s_mul_i32 s69, s69, 496
    s_lshl_b32 s77, s44, 2
    s_add_u32 s69, s69, s77
    s_mul_i32 s77, s3, 655360
    s_add_u32 s69, s69, s77
    s_add_u32 s69, s69, 65536
    buffer_load_dwordx4 v[160:163], v29, s[32:35], s69 offen sc1
    s_add_u32 s69, s69, 81920
    s_lshl_b32 s73, s3, 10
    v_lshl_add_u32 v4, v1, 2, s73
    s_mov_b32 s70, 0x05040100
    s_mov_b32 s71, 0x07060302
    v_cvt_pk_bf16_f32 v192, v71, v70
    v_cvt_pk_bf16_f32 v193, v69, v68
    s_waitcnt vmcnt(7)
    v_perm_b32 v206, v130, v128, s70
    buffer_load_dwordx4 v[164:167], v29, s[32:35], s69 offen sc1
    s_add_u32 s69, s69, 81920
    v_perm_b32 v207, v130, v128, s71
    ds_write_b32 v4, v206 offset:8800
    ds_write_b32 v4, v207 offset:22112
    v_cvt_pk_bf16_f32 v194, v67, v66
    v_cvt_pk_bf16_f32 v195, v65, v64
    v_perm_b32 v206, v131, v129, s70
    buffer_load_dwordx4 v[168:171], v29, s[32:35], s69 offen sc1
    s_add_u32 s69, s69, 81920
    v_perm_b32 v207, v131, v129, s71
    ds_write_b32 v4, v206 offset:35424
    ds_write_b32 v4, v207 offset:48736
    ds_write_b128 v2, v[192:195] offset:3072
    buffer_load_dwordx4 v[172:175], v29, s[32:35], s69 offen sc1
    s_add_u32 s69, s69, 81920
    v_cvt_pk_bf16_f32 v196, v75, v75
    v_cvt_pk_bf16_f32 v197, v74, v74
    s_waitcnt vmcnt(8)
    v_perm_b32 v206, v134, v132, s70
    v_perm_b32 v207, v134, v132, s71
    ds_write_b32 v4, v206 offset:9056
    ds_write_b32 v4, v207 offset:22368
    buffer_load_dwordx4 v[176:179], v29, s[32:35], s69 offen sc1
    s_add_u32 s69, s69, 81920
    v_cvt_pk_bf16_f32 v198, v74, v73
    v_cvt_pk_bf16_f32 v199, v73, v73
    v_perm_b32 v206, v135, v133, s70
    v_perm_b32 v207, v135, v133, s71
    ds_write_b32 v4, v206 offset:35680
    ds_write_b32 v4, v207 offset:48992
    buffer_load_dwordx4 v[180:183], v29, s[32:35], s69 offen sc1
    s_add_u32 s69, s69, 81920
    ds_write_b128 v2, v[196:199] offset:2048
    v_cvt_pk_bf16_f32 v192, v72, v71
    v_cvt_pk_bf16_f32 v193, v70, v69
    s_waitcnt vmcnt(8)
    v_perm_b32 v206, v138, v136, s70
    v_perm_b32 v207, v138, v136, s71
    buffer_load_dwordx4 v[184:187], v29, s[32:35], s69 offen sc1
    s_add_u32 s69, s69, 81920
    ds_write_b32 v4, v206 offset:9312
    ds_write_b32 v4, v207 offset:22624
    v_cvt_pk_bf16_f32 v194, v68, v67
    v_cvt_pk_bf16_f32 v195, v66, v65
    v_perm_b32 v206, v139, v137, s70
    v_perm_b32 v207, v139, v137, s71
    buffer_load_dwordx4 v[188:191], v29, s[32:35], s69 offen sc1
    ds_write_b32 v4, v206 offset:35936
    ds_write_b32 v4, v207 offset:49248
    ds_write_b128 v2, v[192:195] offset:7232
    v_cvt_pk_bf16_f32 v196, v75, v75
    v_cvt_pk_bf16_f32 v197, v75, v74
    s_waitcnt vmcnt(8)
    v_perm_b32 v206, v142, v140, s70
    v_perm_b32 v207, v142, v140, s71
    ds_write_b32 v4, v206 offset:9568
    ds_write_b32 v4, v207 offset:22880
    v_cvt_pk_bf16_f32 v198, v74, v74
    v_cvt_pk_bf16_f32 v199, v73, v73
    v_perm_b32 v206, v143, v141, s70
    v_perm_b32 v207, v143, v141, s71
    ds_write_b32 v4, v206 offset:36192
    ds_write_b32 v4, v207 offset:49504
    ds_write_b128 v2, v[196:199] offset:6208
    s_add_u32 s73, s3, 1
    s_lshr_b32 s73, s73, 1
    s_mul_i32 s73, s73, 13312
    s_and_b32 s74, s3, 1
    s_lshl_b32 s74, s74, 8
    s_add_u32 s73, s73, s74
    s_sub_u32 s73, s73, 65792
    v_add_u32 v148, s73, v16
    v_add_u32 v149, s73, v17
    v_add_u32 v152, s73, v20
    v_subrev_u32 v150, 1024, v149
    s_mul_i32 s74, s74, 3
    s_lshr_b32 s74, s74, 2
    s_sub_u32 s73, s73, s74
    s_add_u32 s73, s73, 256
    v_add_u32 v151, s73, v19
    s_waitcnt lgkmcnt(0)
    s_barrier
    ds_read_b128 a[80:83], v152 offset:448
    ds_read2_b32 a[64:65], v148 offset0:240 offset1:241
    ds_read2_b32 a[66:67], v148 offset0:242 offset1:243
    ds_read_b128 a[164:167], v152 offset:448
    ds_read_b128 a[168:171], v152 offset:432
    ds_read_b128 a[84:87], v152 offset:960
    ds_read2_b32 a[68:69], v148 offset0:112 offset1:113
    ds_read2_b32 a[70:71], v148 offset0:114 offset1:115
    ds_read_b128 a[88:91], v152 offset:1472
    ds_read2_b32 a[72:73], v149 offset0:240 offset1:241
    ds_read2_b32 a[74:75], v149 offset0:242 offset1:243
    ds_read_b128 a[92:95], v152 offset:1984
    ds_read2_b32 a[76:77], v149 offset0:112 offset1:113
    ds_read2_b32 a[78:79], v149 offset0:114 offset1:115
    s_waitcnt lgkmcnt(11)
    v_mfma_f32_16x16x32_bf16 v[224:227], a[64:67], a[80:83], 0
    ds_read_b128 a[96:99], v152 offset:2496
    s_waitcnt lgkmcnt(11)
    v_mfma_f32_16x16x32_bf16 v[192:195], a[164:167], v[40:43], 0
    ds_read_b128 a[100:103], v152 offset:3008
    s_waitcnt lgkmcnt(11)
    v_mfma_f32_16x16x32_bf16 v[196:199], a[168:171], v[44:47], 0
    ds_read_b128 a[104:107], v152 offset:3520
    s_waitcnt lgkmcnt(9)
    v_mfma_f32_16x16x32_bf16 v[228:231], a[68:71], a[80:83], 0
    ds_read_b128 a[108:111], v152 offset:4032
    v_mfma_f32_16x16x32_bf16 v[228:231], a[64:67], a[84:87], v[228:231]
    ds_read_b128 a[164:167], v152 offset:1472
    s_lshl_b32 s65, s51, 10
    s_waitcnt lgkmcnt(8)
    v_mfma_f32_16x16x32_bf16 v[232:235], a[72:75], a[80:83], 0
    ds_read_b128 a[168:171], v152 offset:1456
    s_add_u32 s65, s65, 32768
    v_mfma_f32_16x16x32_bf16 v[232:235], a[68:71], a[84:87], v[232:235]
    ds_read2_b32 a[160:161], v150 offset0:240 offset1:241
    v_min_u32 v28, 53, v1
    v_mfma_f32_16x16x32_bf16 v[232:235], a[64:67], a[88:91], v[232:235]
    ds_read2_b32 a[162:163], v150 offset0:242 offset1:243
    v_lshlrev_b32 v28, 4, v28
    s_waitcnt lgkmcnt(8)
    v_mfma_f32_16x16x32_bf16 v[236:239], a[76:79], a[80:83], 0
    ds_read_b128 a[172:175], v152 offset:960
    buffer_load_dword v24, v28, s[32:35], s65 offen sc1
    v_mfma_f32_16x16x32_bf16 v[236:239], a[72:75], a[84:87], v[236:239]
    ds_read_b128 a[176:179], v152 offset:944
    s_lshl_b32 s73, s50, 2
    v_mfma_f32_16x16x32_bf16 v[236:239], a[68:71], a[88:91], v[236:239]
    s_add_u32 s73, s73, s3
    v_cvt_pk_bf16_f32 v200, v192, v196
    ds_read_b128 a[128:131], v152 offset:384
    v_mfma_f32_16x16x32_bf16 v[236:239], a[64:67], a[92:95], v[236:239]
    ds_read2_b32 a[112:113], v148 offset0:224 offset1:225
    s_mul_i32 s73, s73, 20480
    v_mfma_f32_16x16x32_bf16 v[240:243], a[76:79], a[84:87], 0
    ds_read2_b32 a[114:115], v148 offset0:226 offset1:227
    s_mul_i32 s74, s51, 160
    v_mfma_f32_16x16x32_bf16 v[240:243], a[72:75], a[88:91], v[240:243]
    s_add_u32 s73, s73, s74
    v_cvt_pk_bf16_f32 v201, v193, v197
    ds_read_b128 a[132:135], v152 offset:896
    v_mfma_f32_16x16x32_bf16 v[240:243], a[68:71], a[92:95], v[240:243]
    s_waitcnt lgkmcnt(6)
    ds_read2_b32 a[116:117], v148 offset0:96 offset1:97
    v_mfma_f32_16x16x32_bf16 v[240:243], a[64:67], a[96:99], v[240:243]
    ds_read2_b32 a[118:119], v148 offset0:98 offset1:99
    s_lshl_b32 s74, s3, 12
    v_mfma_f32_16x16x32_bf16 v[244:247], a[76:79], a[88:91], 0
    s_add_u32 s74, s74, 94208
    v_cvt_pk_bf16_f32 v202, v194, v198
    ds_read_b128 a[136:139], v152 offset:1408
    v_mfma_f32_16x16x32_bf16 v[244:247], a[72:75], a[92:95], v[244:247]
    ds_read2_b32 a[120:121], v149 offset0:224 offset1:225
    v_add_u32 v2, 0, v1
    v_mfma_f32_16x16x32_bf16 v[244:247], a[68:71], a[96:99], v[244:247]
    ds_read2_b32 a[122:123], v149 offset0:226 offset1:227
    v_min_u32 v2, 159, v2
    v_mfma_f32_16x16x32_bf16 v[244:247], a[64:67], a[100:103], v[244:247]
    v_cvt_pk_bf16_f32 v203, v195, v199
    ds_read_b128 a[140:143], v152 offset:1920
    v_mfma_f32_16x16x32_bf16 v[248:251], a[76:79], a[92:95], 0
    ds_read2_b32 a[124:125], v149 offset0:96 offset1:97
    v_mul_u32_u24 v5, 6554, v2
    v_mfma_f32_16x16x32_bf16 v[248:251], a[72:75], a[96:99], v[248:251]
    ds_read2_b32 a[126:127], v149 offset0:98 offset1:99
    v_lshrrev_b32 v5, 16, v5
    v_mfma_f32_16x16x32_bf16 v[248:251], a[68:71], a[100:103], v[248:251]
    ds_read_b128 a[144:147], v152 offset:2432
    v_add_lshl_u32 v2, v2, v5, 4
    v_mfma_f32_16x16x32_bf16 v[248:251], a[64:67], a[104:107], v[248:251]
    ds_read_b128 a[148:151], v152 offset:2944
    v_mul_u32_u24 v30, 1104, v5
    v_mfma_f32_16x16x32_bf16 v[252:255], a[76:79], a[96:99], 0
    ds_read_b128 a[152:155], v152 offset:3456
    v_add_u32 v5, s74, v2
    v_mfma_f32_16x16x32_bf16 v[252:255], a[72:75], a[100:103], v[252:255]
    ds_read_b128 a[156:159], v152 offset:3968
    v_add3_u32 v2, v2, v30, s73
    v_mfma_f32_16x16x32_bf16 v[252:255], a[68:71], a[104:107], v[252:255]
    v_add_u32 v3, 64, v1
    v_min_u32 v3, 159, v3
    v_mfma_f32_16x16x32_bf16 v[252:255], a[64:67], a[108:111], v[252:255]
    v_mul_u32_u24 v6, 6554, v3
    v_lshrrev_b32 v6, 16, v6
    v_mfma_f32_16x16x32_bf16 v[240:243], a[160:163], a[80:83], v[240:243]
    v_add_lshl_u32 v3, v3, v6, 4
    v_mul_u32_u24 v30, 1104, v6
    v_mfma_f32_16x16x32_bf16 v[244:247], a[160:163], a[84:87], v[244:247]
    v_add_u32 v6, s74, v3
    v_add3_u32 v3, v3, v30, s73
    v_mfma_f32_16x16x32_bf16 v[248:251], a[160:163], a[88:91], v[248:251]
    v_add_u32 v4, 128, v1
    v_min_u32 v4, 159, v4
    v_mfma_f32_16x16x32_bf16 v[252:255], a[160:163], a[92:95], v[252:255]
    s_waitcnt lgkmcnt(4)
    v_mul_u32_u24 v7, 6554, v4
    v_lshrrev_b32 v7, 16, v7
    v_mfma_f32_16x16x32_bf16 v[224:227], a[112:115], a[128:131], v[224:227]
    ds_read2_b32 a[180:181], v151 offset0:3 offset1:2
    v_add_lshl_u32 v4, v4, v7, 4
    v_mfma_f32_16x16x32_bf16 v[192:195], a[172:175], v[40:43], 0
    ds_read2_b32 a[182:183], v151 offset0:1 offset1:0
    v_mul_u32_u24 v30, 1104, v7
    v_mfma_f32_16x16x32_bf16 v[196:199], a[176:179], v[44:47], 0
    ds_read2_b32 a[184:185], v151 offset0:19 offset1:18
    v_add_u32 v7, s74, v4
    v_mfma_f32_16x16x32_bf16 v[228:231], a[116:119], a[128:131], v[228:231]
    ds_read2_b32 a[186:187], v151 offset0:17 offset1:16
    v_add3_u32 v4, v4, v30, s73
    v_mfma_f32_16x16x32_bf16 v[228:231], a[112:115], a[132:135], v[228:231]
    ds_read_b128 a[172:175], v152 offset:1984
    v_mfma_f32_16x16x32_bf16 v[232:235], a[120:123], a[128:131], v[232:235]
    ds_read_b128 a[176:179], v152 offset:1968
    v_mfma_f32_16x16x32_bf16 v[232:235], a[116:119], a[132:135], v[232:235]
    ds_read2_b32 a[188:189], v151 offset0:35 offset1:34
    v_mfma_f32_16x16x32_bf16 v[232:235], a[112:115], a[136:139], v[232:235]
    s_waitcnt lgkmcnt(7)
    ds_read2_b32 a[190:191], v151 offset0:33 offset1:32
    v_mfma_f32_16x16x32_bf16 v[236:239], a[124:127], a[128:131], v[236:239]
    ds_read2_b32 a[60:61], v151 offset0:51 offset1:50
    v_mfma_f32_16x16x32_bf16 v[236:239], a[120:123], a[132:135], v[236:239]
    ds_read2_b32 a[62:63], v151 offset0:49 offset1:48
    ds_write_b128 v5, v[100:103]
    v_mfma_f32_16x16x32_bf16 v[236:239], a[116:119], a[136:139], v[236:239]
    v_cvt_pk_bf16_f32 v204, v192, v196
    ds_read_b128 a[80:83], v152 offset:320
    v_mfma_f32_16x16x32_bf16 v[236:239], a[112:115], a[140:143], v[236:239]
    ds_read2_b32 a[64:65], v148 offset0:208 offset1:209
    v_mfma_f32_16x16x32_bf16 v[240:243], a[124:127], a[132:135], v[240:243]
    ds_read2_b32 a[66:67], v148 offset0:210 offset1:211
    v_mfma_f32_16x16x32_bf16 v[240:243], a[120:123], a[136:139], v[240:243]
    v_cvt_pk_bf16_f32 v205, v193, v197
    ds_read_b128 a[84:87], v152 offset:832
    v_mfma_f32_16x16x32_bf16 v[240:243], a[116:119], a[140:143], v[240:243]
    ds_read2_b32 a[68:69], v148 offset0:80 offset1:81
    v_mfma_f32_16x16x32_bf16 v[240:243], a[112:115], a[144:147], v[240:243]
    ds_read2_b32 a[70:71], v148 offset0:82 offset1:83
    ds_write_b128 v6, v[104:107]
    v_mfma_f32_16x16x32_bf16 v[244:247], a[124:127], a[136:139], v[244:247]
    v_cvt_pk_bf16_f32 v206, v194, v198
    ds_read_b128 a[88:91], v152 offset:1344
    v_mfma_f32_16x16x32_bf16 v[244:247], a[120:123], a[140:143], v[244:247]
    ds_read2_b32 a[72:73], v149 offset0:208 offset1:209
    v_mfma_f32_16x16x32_bf16 v[244:247], a[116:119], a[144:147], v[244:247]
    ds_read2_b32 a[74:75], v149 offset0:210 offset1:211
    v_mfma_f32_16x16x32_bf16 v[244:247], a[112:115], a[148:151], v[244:247]
    v_cvt_pk_bf16_f32 v207, v195, v199
    ds_read_b128 a[92:95], v152 offset:1856
    v_mfma_f32_16x16x32_bf16 v[248:251], a[124:127], a[140:143], v[248:251]
    ds_read2_b32 a[76:77], v149 offset0:80 offset1:81
    v_mfma_f32_16x16x32_bf16 v[248:251], a[120:123], a[144:147], v[248:251]
    s_waitcnt lgkmcnt(13)
    ds_read2_b32 a[78:79], v149 offset0:82 offset1:83
    s_waitcnt vmcnt(0)
    v_cmp_ne_u32 vcc, v25, v24
    s_cbranch_vccnz c3h_slow
c3h_ok:
    v_mfma_f32_16x16x32_bf16 v[248:251], a[116:119], a[148:151], v[248:251]
    ds_read_b128 a[96:99], v152 offset:2368
    s_add_u32 s66, s54, 81920
    v_mfma_f32_16x16x32_bf16 v[248:251], a[112:115], a[152:155], v[248:251]
    ds_read_b128 a[100:103], v152 offset:2880
    buffer_load_dwordx4 a[192:195], v8, s[32:35], s66 offen offset:0 sc1
    v_mfma_f32_16x16x32_bf16 v[252:255], a[124:127], a[144:147], v[252:255]
    ds_read_b128 a[104:107], v152 offset:3392
    ds_write_b128 v7, v[108:111]
    v_mfma_f32_16x16x32_bf16 v[252:255], a[120:123], a[148:151], v[252:255]
    ds_read_b128 a[108:111], v152 offset:3904
    ds_read_b64 v[30:31], v26 offset:0
    v_mfma_f32_16x16x32_bf16 v[240:243], v[200:203], a[180:183], v[240:243]
    buffer_load_dwordx4 a[196:199], v8, s[32:35], s66 offen offset:1024 sc1
    ds_read_b64 v[32:33], v26 offset:8
    v_mfma_f32_16x16x32_bf16 v[244:247], v[200:203], a[184:187], v[244:247]
    ds_read_b64 v[34:35], v26 offset:16
    ds_read_b64 v[36:37], v26 offset:24
    v_mfma_f32_16x16x32_bf16 v[248:251], v[200:203], a[188:191], v[248:251]
    ds_read_b64 v[38:39], v26 offset:32
    s_lshr_b32 s72, s3, 1
    v_mfma_f32_16x16x32_bf16 v[252:255], v[200:203], a[60:63], v[252:255]
    s_mul_i32 s72, s72, 13312
    s_add_u32 s72, s72, 65536
    s_and_b32 s73, s3, 1
    v_mfma_f32_16x16x32_bf16 v[252:255], a[116:119], a[152:155], v[252:255]
    buffer_load_dwordx4 a[200:203], v8, s[32:35], s66 offen offset:2048 sc1
    s_mul_i32 s73, s73, 4160
    v_mfma_f32_16x16x32_bf16 v[252:255], a[112:115], a[156:159], v[252:255]
    s_waitcnt lgkmcnt(10)
    s_add_u32 s73, s73, s72
    v_mfma_f32_16x16x32_bf16 v[224:227], a[64:67], a[80:83], v[224:227]
    ds_read_b128 a[128:131], v152 offset:256
    v_mfma_f32_16x16x32_bf16 v[192:195], a[164:167], v[40:43], 0
    ds_read2_b32 a[112:113], v148 offset0:192 offset1:193
    v_mfma_f32_16x16x32_bf16 v[196:199], a[168:171], v[44:47], 0
    ds_read2_b32 a[114:115], v148 offset0:194 offset1:195
    buffer_load_dwordx4 a[204:207], v8, s[32:35], s66 offen offset:3072 sc1
    v_mfma_f32_16x16x32_bf16 v[228:231], a[68:71], a[80:83], v[228:231]
    s_add_u32 s66, s66, 4096
    v_mfma_f32_16x16x32_bf16 v[244:247], v[204:207], a[180:183], v[244:247]
    ds_read_b128 a[132:135], v152 offset:768
    v_mfma_f32_16x16x32_bf16 v[248:251], v[204:207], a[184:187], v[248:251]
    ds_read2_b32 a[116:117], v148 offset0:64 offset1:65
    s_bitcmp1_b32 s3, 1
    s_cselect_b32 s74, 0, 16
    s_lshl_b32 s74, s49, s74
    s_and_b32 s74, s74, 0xffff0000
    v_mfma_f32_16x16x32_bf16 v[252:255], v[204:207], a[188:191], v[252:255]
    ds_read2_b32 a[118:119], v148 offset0:66 offset1:67
    buffer_load_dwordx4 a[208:211], v8, s[32:35], s66 offen offset:0 sc1
    v_mfma_f32_16x16x32_bf16 v[228:231], a[64:67], a[84:87], v[228:231]
    s_waitcnt lgkmcnt(11)
    s_add_u32 s66, s54, 122880
    v_mfma_f32_16x16x32_bf16 v[232:235], a[72:75], a[80:83], v[232:235]
    ds_read_b128 a[136:139], v152 offset:1280
    v_mfma_f32_16x16x32_bf16 v[232:235], a[68:71], a[84:87], v[232:235]
    ds_read2_b32 a[120:121], v149 offset0:192 offset1:193
    s_mov_b64 exec, 1
    v_add_f32 v112, s74, v112
    s_mov_b64 exec, -1
    v_mfma_f32_16x16x32_bf16 v[232:235], a[64:67], a[88:91], v[232:235]
    buffer_load_dwordx4 a[212:215], v8, s[32:35], s66 offen offset:0 sc1
    v_cvt_pk_bf16_f32 v200, v192, v196
    v_mfma_f32_16x16x32_bf16 v[236:239], a[76:79], a[80:83], v[236:239]
    v_sub_u32 v52, 1008, v8
    v_add_u32 v52, s73, v52
    v_mfma_f32_16x16x32_bf16 v[236:239], a[72:75], a[84:87], v[236:239]
    ds_read2_b32 a[122:123], v149 offset0:194 offset1:195
    v_min_u32 v53, 624, v8
    v_mfma_f32_16x16x32_bf16 v[236:239], a[68:71], a[88:91], v[236:239]
    s_add_u32 s74, s72, 8160
    v_cvt_pk_bf16_f32 v201, v193, v197
    v_add_u32 v53, s74, v53
    v_mfma_f32_16x16x32_bf16 v[236:239], a[64:67], a[92:95], v[236:239]
    ds_read_b128 a[140:143], v152 offset:1792
    buffer_load_dwordx4 a[216:219], v8, s[32:35], s66 offen offset:1024 sc1
    v_mfma_f32_16x16x32_bf16 v[240:243], a[76:79], a[84:87], v[240:243]
    v_mov_b32 v104, 0
    v_mov_b32 v105, 0
    v_mfma_f32_16x16x32_bf16 v[240:243], a[72:75], a[88:91], v[240:243]
    v_cvt_pk_bf16_f32 v202, v194, v198
    v_mov_b32 v106, 0
    v_mfma_f32_16x16x32_bf16 v[240:243], a[68:71], a[92:95], v[240:243]
    ds_read2_b32 a[124:125], v149 offset0:64 offset1:65
    v_cvt_pk_bf16_f32 v108, v124, v125
    v_mfma_f32_16x16x32_bf16 v[240:243], a[64:67], a[96:99], v[240:243]
    ds_read2_b32 a[126:127], v149 offset0:66 offset1:67
    buffer_load_dwordx4 a[220:223], v8, s[32:35], s66 offen offset:2048 sc1
    v_mfma_f32_16x16x32_bf16 v[244:247], a[76:79], a[88:91], v[244:247]
    v_cvt_pk_bf16_f32 v203, v195, v199
    v_lshl_add_u32 v109, v1, 1, s72
    v_mfma_f32_16x16x32_bf16 v[244:247], a[72:75], a[92:95], v[244:247]
    ds_read_b128 a[144:147], v152 offset:2304
    v_mfma_f32_16x16x32_bf16 v[244:247], a[68:71], a[96:99], v[244:247]
    ds_read_b128 a[148:151], v152 offset:2816
    v_mfma_f32_16x16x32_bf16 v[244:247], a[64:67], a[100:103], v[244:247]
    ds_read_b128 a[152:155], v152 offset:3328
    buffer_load_dwordx4 a[224:227], v8, s[32:35], s66 offen offset:3072 sc1
    v_mfma_f32_16x16x32_bf16 v[248:251], a[76:79], a[92:95], v[248:251]
    s_add_u32 s66, s66, 4096
    v_mfma_f32_16x16x32_bf16 v[248:251], a[72:75], a[96:99], v[248:251]
    ds_read_b128 a[156:159], v152 offset:3840
    ds_write_b16 v109, v108 offset:128
    v_mfma_f32_16x16x32_bf16 v[248:251], a[68:71], a[100:103], v[248:251]
    ds_write_b16_d16_hi v109, v108 offset:256
    v_mfma_f32_16x16x32_bf16 v[248:251], a[64:67], a[104:107], v[248:251]
    buffer_load_dwordx4 a[228:231], v8, s[32:35], s66 offen offset:0 sc1
    s_add_u32 s74, s72, 0xffffffe0
    v_mfma_f32_16x16x32_bf16 v[252:255], a[76:79], a[96:99], v[252:255]
    s_add_u32 s66, s54, 163840
    v_mfma_f32_16x16x32_bf16 v[252:255], a[72:75], a[100:103], v[252:255]
    s_mov_b64 exec, 0x3ff
    v_add_u32 v53, s74, v8
    s_mov_b64 exec, -1
    v_mfma_f32_16x16x32_bf16 v[252:255], a[68:71], a[104:107], v[252:255]
    s_add_u32 s74, s73, 0x1000
    v_mfma_f32_16x16x32_bf16 v[252:255], a[64:67], a[108:111], v[252:255]
    s_waitcnt lgkmcnt(6)
    buffer_load_dwordx4 a[232:235], v8, s[32:35], s66 offen offset:0 sc1
    v_mfma_f32_16x16x32_bf16 v[224:227], a[112:115], a[128:131], v[224:227]
    ds_read_b128 a[80:83], v152 offset:192
    v_mfma_f32_16x16x32_bf16 v[192:195], a[172:175], v[40:43], 0
    ds_read2_b32 a[64:65], v148 offset0:176 offset1:177
    v_mfma_f32_16x16x32_bf16 v[196:199], a[176:179], v[44:47], 0
    ds_read2_b32 a[66:67], v148 offset0:178 offset1:179
    s_mov_b64 exec, 3
    v_add_u32 v53, s74, v8
    s_mov_b64 exec, -1
    v_mfma_f32_16x16x32_bf16 v[228:231], a[116:119], a[128:131], v[228:231]
    buffer_load_dwordx4 a[236:239], v8, s[32:35], s66 offen offset:1024 sc1
    s_add_u32 s74, s73, 0x400
    v_mfma_f32_16x16x32_bf16 v[248:251], v[200:203], a[180:183], v[248:251]
    ds_read_b128 a[84:87], v152 offset:704
    v_mfma_f32_16x16x32_bf16 v[252:255], v[200:203], a[184:187], v[252:255]
    ds_read2_b32 a[68:69], v148 offset0:48 offset1:49
    v_mfma_f32_16x16x32_bf16 v[228:231], a[112:115], a[132:135], v[228:231]
    ds_read2_b32 a[70:71], v148 offset0:50 offset1:51
    v_mfma_f32_16x16x32_bf16 v[232:235], a[120:123], a[128:131], v[232:235]
    s_waitcnt lgkmcnt(8)
    buffer_load_dwordx4 a[240:243], v8, s[32:35], s66 offen offset:2048 sc1
    v_mfma_f32_16x16x32_bf16 v[232:235], a[116:119], a[132:135], v[232:235]
    ds_read_b128 a[88:91], v152 offset:1216
    s_bfm_b64 exec, 4, 60
    v_add_u32 v53, s74, v8
    s_mov_b64 exec, -1
    v_mfma_f32_16x16x32_bf16 v[232:235], a[112:115], a[136:139], v[232:235]
    ds_read2_b32 a[72:73], v149 offset0:176 offset1:177
    v_mfma_f32_16x16x32_bf16 v[236:239], a[124:127], a[128:131], v[236:239]
    buffer_load_dwordx4 a[244:247], v8, s[32:35], s66 offen offset:3072 sc1
    v_cvt_pk_bf16_f32 v204, v192, v196
    v_mfma_f32_16x16x32_bf16 v[236:239], a[120:123], a[132:135], v[236:239]
    s_add_u32 s66, s66, 4096
    s_bitcmp1_b32 s3, 0
    s_cselect_b64 s[74:75], -1, 0
    v_mfma_f32_16x16x32_bf16 v[236:239], a[116:119], a[136:139], v[236:239]
    ds_read2_b32 a[74:75], v149 offset0:178 offset1:179
    v_mfma_f32_16x16x32_bf16 v[236:239], a[112:115], a[140:143], v[236:239]
    v_cvt_pk_bf16_f32 v205, v193, v197
    v_mfma_f32_16x16x32_bf16 v[240:243], a[124:127], a[132:135], v[240:243]
    ds_read_b128 a[92:95], v152 offset:1728
    buffer_load_dwordx4 a[248:251], v8, s[32:35], s66 offen offset:0 sc1
    v_mfma_f32_16x16x32_bf16 v[240:243], a[120:123], a[136:139], v[240:243]
    s_add_u32 s66, s54, 40960
    v_mfma_f32_16x16x32_bf16 v[240:243], a[116:119], a[140:143], v[240:243]
    s_and_b64 exec, s[74:75], 1
    v_cvt_pk_bf16_f32 v104, v112, v105
    s_mov_b64 exec, -1
    v_cvt_pk_bf16_f32 v206, v194, v198
    v_mfma_f32_16x16x32_bf16 v[240:243], a[112:115], a[144:147], v[240:243]
    ds_read2_b32 a[76:77], v149 offset0:48 offset1:49
    v_mfma_f32_16x16x32_bf16 v[244:247], a[124:127], a[136:139], v[244:247]
    ds_read2_b32 a[78:79], v149 offset0:50 offset1:51
    buffer_load_dwordx4 v[68:71], v8, s[32:35], s66 offen offset:0 sc1
    v_mfma_f32_16x16x32_bf16 v[244:247], a[120:123], a[140:143], v[244:247]
    v_cvt_pk_bf16_f32 v207, v195, v199
    v_mfma_f32_16x16x32_bf16 v[244:247], a[116:119], a[144:147], v[244:247]
    ds_read_b128 a[96:99], v152 offset:2240
    s_bfm_b64 exec, 1, 63
    v_cvt_pk_bf16_f32 v106, v123, v123
    s_mov_b64 exec, -1
    v_mfma_f32_16x16x32_bf16 v[244:247], a[112:115], a[148:151], v[244:247]
    ds_read_b128 a[100:103], v152 offset:2752
    buffer_load_dwordx4 v[72:75], v8, s[32:35], s66 offen offset:1024 sc1
    v_mfma_f32_16x16x32_bf16 v[248:251], a[124:127], a[140:143], v[248:251]
    ds_read_b128 a[104:107], v152 offset:3264
    v_mov_b32 v107, v106
    v_mfma_f32_16x16x32_bf16 v[248:251], a[120:123], a[144:147], v[248:251]
    v_and_b32 v110, 0xffff0000, v106
    v_cndmask_b32 v105, v110, v105, s[74:75]
    v_mfma_f32_16x16x32_bf16 v[248:251], a[116:119], a[148:151], v[248:251]
    ds_read_b128 a[108:111], v152 offset:3776
    v_mfma_f32_16x16x32_bf16 v[248:251], a[112:115], a[152:155], v[248:251]
    buffer_load_dwordx4 v[76:79], v8, s[32:35], s66 offen offset:2048 sc1
    v_mfma_f32_16x16x32_bf16 v[252:255], a[124:127], a[144:147], v[252:255]
    ds_write_b128 v53, v[104:107]
    v_mfma_f32_16x16x32_bf16 v[252:255], a[120:123], a[148:151], v[252:255]
    v_cvt_pk_bf16_f32 v96, v123, v123
    v_cndmask_b32 v110, v122, v123, s[74:75]
    v_mfma_f32_16x16x32_bf16 v[252:255], a[116:119], a[152:155], v[252:255]
    buffer_load_dwordx4 v[80:83], v8, s[32:35], s66 offen offset:3072 sc1
    v_cvt_pk_bf16_f32 v97, v110, v122
    v_mfma_f32_16x16x32_bf16 v[252:255], a[112:115], a[156:159], v[252:255]
    s_waitcnt lgkmcnt(5)
    s_add_u32 s66, s66, 4096
    v_cndmask_b32 v111, v121, v122, s[74:75]
    v_mfma_f32_16x16x32_bf16 v[224:227], a[64:67], a[80:83], v[224:227]
    ds_read_b128 a[128:131], v152 offset:128
    v_cvt_pk_bf16_f32 v98, v122, v111
    v_mfma_f32_16x16x32_bf16 v[228:231], a[68:71], a[80:83], v[228:231]
    ds_read2_b32 a[112:113], v148 offset0:160 offset1:161
    v_cvt_pk_bf16_f32 v99, v121, v121
    v_mfma_f32_16x16x32_bf16 v[228:231], a[64:67], a[84:87], v[228:231]
    ds_read2_b32 a[114:115], v148 offset0:162 offset1:163
    buffer_load_dwordx4 v[84:87], v8, s[32:35], s66 offen offset:0 sc1
    v_mfma_f32_16x16x32_bf16 v[232:235], a[72:75], a[80:83], v[232:235]
    s_add_u32 s66, s55, 0
    v_mfma_f32_16x16x32_bf16 v[252:255], v[204:207], a[180:183], v[252:255]
    ds_read_b128 a[132:135], v152 offset:640
    v_mfma_f32_16x16x32_bf16 v[232:235], a[68:71], a[84:87], v[232:235]
    ds_read2_b32 a[116:117], v148 offset0:32 offset1:33
    v_mfma_f32_16x16x32_bf16 v[232:235], a[64:67], a[88:91], v[232:235]
    ds_read2_b32 a[118:119], v148 offset0:34 offset1:35
    buffer_load_dwordx4 a[0:3], v8, s[32:35], s66 offen offset:0 sc1
    v_mfma_f32_16x16x32_bf16 v[236:239], a[76:79], a[80:83], v[236:239]
    s_waitcnt lgkmcnt(7)
    ds_write_b128 v52, v[96:99] offset:2048
    v_mfma_f32_16x16x32_bf16 v[236:239], a[72:75], a[84:87], v[236:239]
    ds_read_b128 a[136:139], v152 offset:1152
    v_cndmask_b32 v110, v119, v120, s[74:75]
    v_mfma_f32_16x16x32_bf16 v[236:239], a[68:71], a[88:91], v[236:239]
    ds_read2_b32 a[120:121], v149 offset0:160 offset1:161
    buffer_load_dwordx4 a[4:7], v8, s[32:35], s66 offen offset:1024 sc1
    v_mfma_f32_16x16x32_bf16 v[236:239], a[64:67], a[92:95], v[236:239]
    ds_read2_b32 a[122:123], v149 offset0:162 offset1:163
    v_cndmask_b32 v111, v118, v119, s[74:75]
    v_mfma_f32_16x16x32_bf16 v[240:243], a[76:79], a[84:87], v[240:243]
    v_cvt_pk_bf16_f32 v100, v110, v111
    v_cndmask_b32 v110, v117, v118, s[74:75]
    v_mfma_f32_16x16x32_bf16 v[240:243], a[72:75], a[88:91], v[240:243]
    ds_read_b128 a[140:143], v152 offset:1664
    v_cndmask_b32 v111, v116, v117, s[74:75]
    v_mfma_f32_16x16x32_bf16 v[240:243], a[68:71], a[92:95], v[240:243]
    ds_read2_b32 a[124:125], v149 offset0:32 offset1:33
    buffer_load_dwordx4 a[8:11], v8, s[32:35], s66 offen offset:2048 sc1
    v_mfma_f32_16x16x32_bf16 v[240:243], a[64:67], a[96:99], v[240:243]
    ds_read2_b32 a[126:127], v149 offset0:34 offset1:35
    v_cvt_pk_bf16_f32 v101, v110, v111
    v_mfma_f32_16x16x32_bf16 v[244:247], a[76:79], a[88:91], v[244:247]
    v_cndmask_b32 v110, v115, v116, s[74:75]
    v_cndmask_b32 v111, v114, v115, s[74:75]
    v_mfma_f32_16x16x32_bf16 v[244:247], a[72:75], a[92:95], v[244:247]
    ds_read_b128 a[144:147], v152 offset:2176
    v_cvt_pk_bf16_f32 v102, v110, v111
    v_mfma_f32_16x16x32_bf16 v[244:247], a[68:71], a[96:99], v[244:247]
    ds_read_b128 a[148:151], v152 offset:2688
    buffer_load_dwordx4 a[12:15], v8, s[32:35], s66 offen offset:3072 sc1
    v_mfma_f32_16x16x32_bf16 v[244:247], a[64:67], a[100:103], v[244:247]
    ds_read_b128 a[152:155], v152 offset:3200
    s_add_u32 s66, s66, 4096
    v_mfma_f32_16x16x32_bf16 v[248:251], a[76:79], a[92:95], v[248:251]
    v_cndmask_b32 v110, v113, v114, s[74:75]
    v_cndmask_b32 v111, v112, v113, s[74:75]
    v_mfma_f32_16x16x32_bf16 v[248:251], a[72:75], a[96:99], v[248:251]
    ds_read_b128 a[156:159], v152 offset:3712
    v_cvt_pk_bf16_f32 v103, v110, v111
    v_mfma_f32_16x16x32_bf16 v[248:251], a[68:71], a[100:103], v[248:251]
    buffer_load_dwordx4 a[16:19], v8, s[32:35], s66 offen offset:0 sc1
    s_add_u32 s66, s55, 40960
    v_mfma_f32_16x16x32_bf16 v[248:251], a[64:67], a[104:107], v[248:251]
    ds_write_b128 v52, v[100:103] offset:3072
    v_mfma_f32_16x16x32_bf16 v[252:255], a[76:79], a[96:99], v[252:255]
    s_lshl_b32 s72, s3, 10
    s_add_u32 s72, s72, 65536
    v_lshl_add_u32 v52, v1, 1, s72
    v_mfma_f32_16x16x32_bf16 v[252:255], a[72:75], a[100:103], v[252:255]
    buffer_load_dwordx4 a[20:23], v8, s[32:35], s66 offen offset:0 sc1
    v_mfma_f32_16x16x32_bf16 v[252:255], a[68:71], a[104:107], v[252:255]
    s_barrier
    v_mfma_f32_16x16x32_bf16 v[252:255], a[64:67], a[108:111], v[252:255]
    s_waitcnt lgkmcnt(5)
    v_mfma_f32_16x16x32_bf16 v[224:227], a[112:115], a[128:131], v[224:227]
    ds_read_b128 a[80:83], v152 offset:64
    ds_write_b16 v52, v160 offset:8800
    v_mfma_f32_16x16x32_bf16 v[228:231], a[116:119], a[128:131], v[228:231]
    ds_read2_b32 a[64:65], v148 offset0:144 offset1:145
    buffer_load_dwordx4 a[24:27], v8, s[32:35], s66 offen offset:1024 sc1
    v_mfma_f32_16x16x32_bf16 v[228:231], a[112:115], a[132:135], v[228:231]
    ds_read2_b32 a[66:67], v148 offset0:146 offset1:147
    v_mfma_f32_16x16x32_bf16 v[232:235], a[120:123], a[128:131], v[232:235]
    ds_write_b16_d16_hi v52, v160 offset:22112
    v_mfma_f32_16x16x32_bf16 v[232:235], a[116:119], a[132:135], v[232:235]
    ds_read_b128 a[84:87], v152 offset:576
    v_mfma_f32_16x16x32_bf16 v[232:235], a[112:115], a[136:139], v[232:235]
    ds_read2_b32 a[68:69], v148 offset0:16 offset1:17
    buffer_load_dwordx4 a[28:31], v8, s[32:35], s66 offen offset:2048 sc1
    v_mfma_f32_16x16x32_bf16 v[236:239], a[124:127], a[128:131], v[236:239]
    ds_read2_b32 a[70:71], v148 offset0:18 offset1:19
    v_mfma_f32_16x16x32_bf16 v[236:239], a[120:123], a[132:135], v[236:239]
    s_waitcnt lgkmcnt(9)
    ds_write_b16 v52, v164 offset:8928
    v_mfma_f32_16x16x32_bf16 v[236:239], a[116:119], a[136:139], v[236:239]
    ds_read_b128 a[88:91], v152 offset:1088
    v_mfma_f32_16x16x32_bf16 v[236:239], a[112:115], a[140:143], v[236:239]
    ds_read2_b32 a[72:73], v149 offset0:144 offset1:145
    buffer_load_dwordx4 a[32:35], v8, s[32:35], s66 offen offset:3072 sc1
    v_mfma_f32_16x16x32_bf16 v[240:243], a[124:127], a[132:135], v[240:243]
    ds_read2_b32 a[74:75], v149 offset0:146 offset1:147
    s_add_u32 s66, s66, 4096
    v_mfma_f32_16x16x32_bf16 v[240:243], a[120:123], a[136:139], v[240:243]
    ds_write_b16_d16_hi v52, v164 offset:22240
    v_mfma_f32_16x16x32_bf16 v[240:243], a[116:119], a[140:143], v[240:243]
    ds_read_b128 a[92:95], v152 offset:1600
    v_mfma_f32_16x16x32_bf16 v[240:243], a[112:115], a[144:147], v[240:243]
    ds_read2_b32 a[76:77], v149 offset0:16 offset1:17
    buffer_load_dwordx4 a[36:39], v8, s[32:35], s66 offen offset:0 sc1
    v_mfma_f32_16x16x32_bf16 v[244:247], a[124:127], a[136:139], v[244:247]
    ds_read2_b32 a[78:79], v149 offset0:18 offset1:19
    s_add_u32 s66, s55, 81920
    v_mfma_f32_16x16x32_bf16 v[244:247], a[120:123], a[140:143], v[244:247]
    ds_write_b16 v52, v168 offset:9056
    v_mfma_f32_16x16x32_bf16 v[244:247], a[116:119], a[144:147], v[244:247]
    ds_read_b128 a[96:99], v152 offset:2112
    v_mfma_f32_16x16x32_bf16 v[244:247], a[112:115], a[148:151], v[244:247]
    ds_read_b128 a[100:103], v152 offset:2624
    buffer_load_dwordx4 a[40:43], v8, s[32:35], s66 offen offset:0 sc1
    v_mfma_f32_16x16x32_bf16 v[248:251], a[124:127], a[140:143], v[248:251]
    ds_read_b128 a[104:107], v152 offset:3136
    v_mfma_f32_16x16x32_bf16 v[248:251], a[120:123], a[144:147], v[248:251]
    ds_write_b16_d16_hi v52, v168 offset:22368
    v_mfma_f32_16x16x32_bf16 v[248:251], a[116:119], a[148:151], v[248:251]
    ds_read_b128 a[108:111], v152 offset:3648
    v_mfma_f32_16x16x32_bf16 v[248:251], a[112:115], a[152:155], v[248:251]
    buffer_load_dwordx4 a[44:47], v8, s[32:35], s66 offen offset:1024 sc1
    v_mfma_f32_16x16x32_bf16 v[252:255], a[124:127], a[144:147], v[252:255]
    ds_write_b16 v52, v172 offset:9184
    v_mfma_f32_16x16x32_bf16 v[252:255], a[120:123], a[148:151], v[252:255]
    ds_write_b16_d16_hi v52, v172 offset:22496
    v_mfma_f32_16x16x32_bf16 v[252:255], a[116:119], a[152:155], v[252:255]
    ds_write_b16 v52, v176 offset:9312
    v_mfma_f32_16x16x32_bf16 v[252:255], a[112:115], a[156:159], v[252:255]
    s_waitcnt lgkmcnt(9)
    buffer_load_dwordx4 a[48:51], v8, s[32:35], s66 offen offset:2048 sc1
    v_mfma_f32_16x16x32_bf16 v[224:227], a[64:67], a[80:83], v[224:227]
    ds_read_b128 a[128:131], v152 offset:0
    v_mfma_f32_16x16x32_bf16 v[228:231], a[68:71], a[80:83], v[228:231]
    ds_read2_b32 a[112:113], v148 offset0:128 offset1:129
    v_mfma_f32_16x16x32_bf16 v[228:231], a[64:67], a[84:87], v[228:231]
    ds_read2_b32 a[114:115], v148 offset0:130 offset1:131
    ds_write_b16_d16_hi v52, v176 offset:22624
    v_mfma_f32_16x16x32_bf16 v[232:235], a[72:75], a[80:83], v[232:235]
    buffer_load_dwordx4 a[52:55], v8, s[32:35], s66 offen offset:3072 sc1
    s_add_u32 s66, s66, 4096
    v_mfma_f32_16x16x32_bf16 v[232:235], a[68:71], a[84:87], v[232:235]
    ds_read_b128 a[132:135], v152 offset:512
    v_mfma_f32_16x16x32_bf16 v[232:235], a[64:67], a[88:91], v[232:235]
    ds_read2_b32 a[116:117], v148 offset0:0 offset1:1
    v_mfma_f32_16x16x32_bf16 v[236:239], a[76:79], a[80:83], v[236:239]
    ds_read2_b32 a[118:119], v148 offset0:2 offset1:3
    ds_write_b16 v52, v180 offset:9440
    v_mfma_f32_16x16x32_bf16 v[236:239], a[72:75], a[84:87], v[236:239]
    s_waitcnt lgkmcnt(11)
    buffer_load_dwordx4 a[56:59], v8, s[32:35], s66 offen offset:0 sc1
    v_mfma_f32_16x16x32_bf16 v[236:239], a[68:71], a[88:91], v[236:239]
    ds_read_b128 a[136:139], v152 offset:1024
    v_mfma_f32_16x16x32_bf16 v[236:239], a[64:67], a[92:95], v[236:239]
    ds_read2_b32 a[120:121], v149 offset0:128 offset1:129
    v_mfma_f32_16x16x32_bf16 v[240:243], a[76:79], a[84:87], v[240:243]
    ds_read2_b32 a[122:123], v149 offset0:130 offset1:131
    ds_write_b16_d16_hi v52, v180 offset:22752
    v_mfma_f32_16x16x32_bf16 v[240:243], a[72:75], a[88:91], v[240:243]
    ds_write_b16 v52, v184 offset:9568
    v_mfma_f32_16x16x32_bf16 v[240:243], a[68:71], a[92:95], v[240:243]
    ds_read_b128 a[140:143], v152 offset:1536
    v_mfma_f32_16x16x32_bf16 v[240:243], a[64:67], a[96:99], v[240:243]
    ds_read2_b32 a[124:125], v149 offset0:0 offset1:1
    v_mfma_f32_16x16x32_bf16 v[244:247], a[76:79], a[88:91], v[244:247]
    ds_read2_b32 a[126:127], v149 offset0:2 offset1:3
    v_mfma_f32_16x16x32_bf16 v[244:247], a[72:75], a[92:95], v[244:247]
    ds_write_b16_d16_hi v52, v184 offset:22880
    v_mfma_f32_16x16x32_bf16 v[244:247], a[68:71], a[96:99], v[244:247]
    ds_read_b128 a[144:147], v152 offset:2048
    v_mfma_f32_16x16x32_bf16 v[244:247], a[64:67], a[100:103], v[244:247]
    ds_read_b128 a[148:151], v152 offset:2560
    v_mfma_f32_16x16x32_bf16 v[248:251], a[76:79], a[92:95], v[248:251]
    ds_read_b128 a[152:155], v152 offset:3072
    v_mfma_f32_16x16x32_bf16 v[248:251], a[72:75], a[96:99], v[248:251]
    ds_write_b16 v52, v188 offset:9696
    v_mfma_f32_16x16x32_bf16 v[248:251], a[68:71], a[100:103], v[248:251]
    ds_read_b128 a[156:159], v152 offset:3584
    v_mfma_f32_16x16x32_bf16 v[248:251], a[64:67], a[104:107], v[248:251]
    ds_write_b16_d16_hi v52, v188 offset:23008
    v_mfma_f32_16x16x32_bf16 v[252:255], a[76:79], a[96:99], v[252:255]
    s_lshl_b32 s69, s44, 13
    s_lshl_b32 s72, s3, 11
    s_add_u32 s69, s69, s72
    v_mfma_f32_16x16x32_bf16 v[252:255], a[72:75], a[100:103], v[252:255]
    s_add_u32 s66, s54, 0
    s_add_u32 s69, s69, 4898816
    s_add_u32 s11, s69, 1024
    v_mfma_f32_16x16x32_bf16 v[252:255], a[68:71], a[104:107], v[252:255]
    buffer_load_dwordx4 v[48:51], v8, s[32:35], s66 offen offset:0 sc1
    s_mul_i32 s10, s51, 327680
    v_mfma_f32_16x16x32_bf16 v[252:255], a[64:67], a[108:111], v[252:255]
    s_waitcnt lgkmcnt(1)
    s_lshl2_add_u32 s72, s50, s3
    s_mul_i32 s72, s72, 64
    v_mfma_f32_16x16x32_bf16 v[224:227], a[112:115], a[128:131], v[224:227]
    s_add_u32 s10, s10, s72
    s_add_u32 s10, s10, 4898816
    s_lshl3_add_u32 s12, s50, s3
    v_mfma_f32_16x16x32_bf16 v[228:231], a[116:119], a[128:131], v[228:231]
    s_lshl_b32 s12, s12, 9
    s_add_u32 s12, s12, 14614528
    s_add_u32 s13, s12, 2048
    v_mfma_f32_16x16x32_bf16 v[228:231], a[112:115], a[132:135], v[228:231]
    buffer_load_dwordx4 v[52:55], v8, s[32:35], s66 offen offset:1024 sc1
    s_and_b32 s14, s50, 24
    v_mfma_f32_16x16x32_bf16 v[232:235], a[120:123], a[128:131], v[232:235]
    s_add_u32 s14, s14, s51
    s_lshl_b32 s14, s14, 11
    s_add_u32 s14, s14, 14745600
    v_mfma_f32_16x16x32_bf16 v[232:235], a[116:119], a[132:135], v[232:235]
    s_cmp_eq_u32 s3, 3
    s_cselect_b32 s70, 5, 6
    v_mfma_f32_16x16x32_bf16 v[232:235], a[112:115], a[136:139], v[232:235]
    ds_write_b128 v21, v[224:227] offset:0
    v_mfma_f32_16x16x32_bf16 v[236:239], a[124:127], a[128:131], v[236:239]
    buffer_load_dwordx4 v[56:59], v8, s[32:35], s66 offen offset:2048 sc1
    v_mfma_f32_16x16x32_bf16 v[236:239], a[120:123], a[132:135], v[236:239]
    ds_write_b128 v21, v[228:231] offset:1280
    v_mfma_f32_16x16x32_bf16 v[236:239], a[116:119], a[136:139], v[236:239]
    s_cmp_eq_u32 s3, 0
    s_cselect_b32 s71, 5, 6
    s_add_u32 s67, s54, 204800
    v_mfma_f32_16x16x32_bf16 v[236:239], a[112:115], a[140:143], v[236:239]
    buffer_load_dwordx4 v[60:63], v8, s[32:35], s66 offen offset:3072 sc1
    s_add_u32 s66, s66, 4096
    v_mfma_f32_16x16x32_bf16 v[240:243], a[124:127], a[132:135], v[240:243]
    ds_write_b128 v21, v[232:235] offset:2560
    v_mfma_f32_16x16x32_bf16 v[240:243], a[120:123], a[136:139], v[240:243]
    v_mfma_f32_16x16x32_bf16 v[240:243], a[116:119], a[140:143], v[240:243]
    buffer_load_dwordx4 v[64:67], v8, s[32:35], s66 offen offset:0 sc1
    v_mfma_f32_16x16x32_bf16 v[240:243], a[112:115], a[144:147], v[240:243]
    v_mfma_f32_16x16x32_bf16 v[244:247], a[124:127], a[136:139], v[244:247]
    ds_write_b128 v21, v[236:239] offset:3840
    v_mfma_f32_16x16x32_bf16 v[244:247], a[120:123], a[140:143], v[244:247]
    buffer_load_dwordx4 v[88:91], v8, s[32:35], s67 offen offset:0 sc1
    v_mfma_f32_16x16x32_bf16 v[244:247], a[116:119], a[144:147], v[244:247]
    v_mfma_f32_16x16x32_bf16 v[244:247], a[112:115], a[148:151], v[244:247]
    v_mfma_f32_16x16x32_bf16 v[248:251], a[124:127], a[140:143], v[248:251]
    s_nop 0
    ds_write_b128 v21, v[240:243] offset:5120
    v_mfma_f32_16x16x32_bf16 v[248:251], a[120:123], a[144:147], v[248:251]
    buffer_load_dwordx4 v[92:95], v8, s[32:35], s67 offen offset:1024 sc1
    v_mfma_f32_16x16x32_bf16 v[248:251], a[116:119], a[148:151], v[248:251]
    v_mfma_f32_16x16x32_bf16 v[248:251], a[112:115], a[152:155], v[248:251]
    v_mfma_f32_16x16x32_bf16 v[252:255], a[124:127], a[144:147], v[252:255]
    ds_write_b128 v21, v[244:247] offset:6400
    v_mfma_f32_16x16x32_bf16 v[252:255], a[120:123], a[148:151], v[252:255]
    buffer_load_dwordx4 v[96:99], v8, s[32:35], s67 offen offset:2048 sc1
    v_mfma_f32_16x16x32_bf16 v[252:255], a[116:119], a[152:155], v[252:255]
    v_mfma_f32_16x16x32_bf16 v[252:255], a[112:115], a[156:159], v[252:255]
    s_lshl_b32 s72, s82, 13
    s_lshl_b32 s73, s3, 11
    s_add_u32 s72, s72, s73
    s_add_u32 s72, s72, 4898816
    s_add_u32 s73, s72, 8192
    buffer_load_dwordx4 v[100:103], v8, s[32:35], s67 offen offset:3072 sc1
    ds_write_b128 v21, v[248:251] offset:7680
    s_nop 0
    ds_write_b128 v21, v[252:255] offset:8960
    s_waitcnt lgkmcnt(0)
    s_barrier
    ds_read_b128 v[224:227], v22 offset:0
    ds_read_b128 v[228:231], v22 offset:10240
    ds_read_b128 v[232:235], v22 offset:20480
    ds_read_b128 v[236:239], v22 offset:30720
    ds_read_b128 v[240:243], v22 offset:1280
    s_add_u32 s67, s67, 4096
    buffer_load_dwordx4 v[104:107], v8, s[32:35], s67 offen offset:0 sc1
    ds_read_b128 v[244:247], v22 offset:11520
    ds_read_b128 v[248:251], v22 offset:21760
    ds_read_b128 v[252:255], v22 offset:32000
    s_and_b32 s76, s3, 1
    s_mul_i32 s76, s76, 768
    v_add_u32 v9, s76, v20
    ds_read_b128 a[80:83], v20 offset:192
    ds_read2_b32 a[64:65], v16 offset0:176 offset1:177
    s_waitcnt lgkmcnt(8)
    v_cvt_pk_bf16_f32 v208, v224, v228
    v_cvt_pk_bf16_f32 v209, v225, v229
    v_cvt_pk_bf16_f32 v210, v226, v230
    v_cvt_pk_bf16_f32 v211, v227, v231
    buffer_store_dwordx4 v[208:211], v8, s[32:35], s72 offen offset:0 sc1
    ds_read2_b32 a[66:67], v16 offset0:178 offset1:179
    ds_read_b128 a[164:167], v9 offset:192
    ds_read_b128 a[168:171], v9 offset:176
    ds_read_b128 a[84:87], v20 offset:704
    ds_read2_b32 a[68:69], v16 offset0:48 offset1:49
    s_waitcnt lgkmcnt(11)
    v_cvt_pk_bf16_f32 v212, v232, v236
    v_cvt_pk_bf16_f32 v213, v233, v237
    v_cvt_pk_bf16_f32 v214, v234, v238
    v_cvt_pk_bf16_f32 v215, v235, v239
    buffer_store_dwordx4 v[212:215], v8, s[32:35], s73 offen offset:0 sc1
    ds_read2_b32 a[70:71], v16 offset0:50 offset1:51
    ds_read_b128 a[88:91], v20 offset:1216
    ds_read2_b32 a[72:73], v17 offset0:176 offset1:177
    ds_read2_b32 a[74:75], v17 offset0:178 offset1:179
    ds_read_b128 a[92:95], v20 offset:1728
    s_waitcnt lgkmcnt(14)
    v_cvt_pk_bf16_f32 v216, v240, v244
    v_cvt_pk_bf16_f32 v217, v241, v245
    v_cvt_pk_bf16_f32 v218, v242, v246
    v_cvt_pk_bf16_f32 v219, v243, v247
    buffer_store_dwordx4 v[216:219], v8, s[32:35], s72 offen offset:1024 sc1
    ds_read2_b32 a[76:77], v17 offset0:48 offset1:49
    ds_read2_b32 a[78:79], v17 offset0:50 offset1:51
    s_waitcnt lgkmcnt(14)
    v_cvt_pk_bf16_f32 v220, v248, v252
    v_cvt_pk_bf16_f32 v221, v249, v253
    v_cvt_pk_bf16_f32 v222, v250, v254
    v_cvt_pk_bf16_f32 v223, v251, v255
    buffer_store_dwordx4 v[220:223], v8, s[32:35], s73 offen offset:1024 sc1
    s_add_u32 s67, s54, 245760
    s_or_b32 s67, s67, s56
    buffer_load_dwordx4 v[108:111], v8, s[32:35], s67 offen offset:0 sc1
    buffer_load_dwordx4 v[112:115], v8, s[32:35], s67 offen offset:1024 sc1
    buffer_load_dwordx4 v[116:119], v8, s[32:35], s67 offen offset:2048 sc1
    buffer_load_dwordx4 v[120:123], v8, s[32:35], s67 offen offset:3072 sc1
    s_add_u32 s67, s67, 4096
    buffer_load_dwordx4 v[124:127], v8, s[32:35], s67 offen offset:0 sc1
    s_waitcnt lgkmcnt(0)
    s_barrier
    s_mov_b32 s60, 134217728
    s_add_u32 s66, s55, 122880
    buffer_load_dwordx4 v[128:131], v8, s[32:35], s66 offen offset:0 sc1
    buffer_load_dwordx4 v[132:135], v8, s[32:35], s66 offen offset:1024 sc1
    buffer_load_dwordx4 v[136:139], v8, s[32:35], s66 offen offset:2048 sc1
    buffer_load_dwordx4 v[140:143], v8, s[32:35], s66 offen offset:3072 sc1
    s_branch join
role_light:
    s_lshl_b32 s68, s3, 11
    s_add_u32 s68, s68, 4096
    v_min_u32 v28, 63, v1
    v_lshlrev_b32 v28, 5, v28
    buffer_load_dword v24, v28, s[32:35], s68 offen sc1
    v_and_b32 v2, 15, v1
    v_lshrrev_b32 v3, 4, v1
    v_mul_u32_u24 v26, 176, v2
    v_mul_u32_u24 v27, 40, v3
    s_lshl_b32 s72, s3, 12
    s_add_u32 s72, s72, 94208
    v_add3_u32 v26, v26, v27, s72
    v_mul_u32_u24 v3, 81920, v3
    v_lshl_add_u32 v27, v2, 2, v3
    s_lshr_b32 s72, s3, 1
    s_mul_i32 s72, s72, 13312
    s_and_b32 s73, s3, 1
    s_lshl_b32 s73, s73, 8
    s_sub_u32 s72, s72, s73
    s_add_u32 s73, s72, 74112
    s_add_u32 s72, s72, 65822
    v_and_b32 v2, 15, v1
    v_lshrrev_b32 v3, 4, v1
    v_and_b32 v4, 1, v1
    v_xor_b32 v4, 1, v4
    v_mul_u32_u24 v4, 4162, v4
    v_lshlrev_b32 v5, 4, v3
    v_add3_u32 v4, v4, v5, s72
    v_lshlrev_b32 v20, 1, v2
    v_sub_u32 v19, v4, v20
    v_add_u32 v18, 1024, v19
    v_add_u32 v17, 2048, v19
    v_add_u32 v16, 3072, v19
    s_sub_u32 s74, s73, 704
    v_mov_b32 v4, s74
    s_bitcmp1_b32 s3, 0
    s_cselect_b64 vcc, -1, 0
    s_cselect_b32 s74, 192, 0
    v_cndmask_b32 v18, v18, v4, vcc
    s_add_u32 s74, s74, s73
    s_sub_u32 s74, s74, 8460
    v_lshl_add_u32 v4, v2, 2, s74
    v_sub_u32 v19, v4, v5
    v_lshl_add_u32 v5, v2, 5, v5
    v_add_u32 v20, s73, v5
    v_mul_u32_u24 v3, 320, v3
    v_lshl_add_u32 v3, v2, 4, v3
    s_mul_i32 s72, s3, 10240
    s_add_u32 s72, s72, 92160
    v_add_u32 v21, s72, v3
    v_and_b32 v3, 3, v1
    v_mul_u32_u24 v3, 320, v3
    v_lshrrev_b32 v2, 2, v1
    v_lshl_add_u32 v3, v2, 4, v3
    s_mul_i32 s72, s3, 2560
    s_add_u32 s72, s72, 92160
    v_add_u32 v22, s72, v3
    v_lshrrev_b32 v2, 5, v1
    v_mul_u32_u24 v2, 40960, v2
    v_and_b32 v3, 0x1f0, v8
    v_add_u32 v29, v2, v3
    s_mul_i32 s72, s50, 221184
    s_add_u32 s72, s72, 7520256
    s_mul_i32 s73, s51, 276480
    s_add_u32 s73, s73, 2686976
    s_lshl_b32 s74, s3, 13
    s_add_u32 s52, s72, s74
    s_sub_u32 s53, s72, s74
    s_add_u32 s53, s53, 28672
    s_mul_i32 s74, s3, 10240
    s_add_u32 s54, s73, s74
    s_sub_u32 s55, s73, s74
    s_add_u32 s55, s55, 35840
    s_cmp_eq_u32 s3, 3
    s_cselect_b32 s56, 134217728, 0
    s_cmp_eq_u32 s3, 0
    s_cselect_b32 s57, 134217728, 0
    s_add_u32 s22, s52, 196608
    s_or_b32 s22, s22, s56
    s_add_u32 s23, s53, 196608
    s_or_b32 s23, s23, s57
    s_mov_b32 s62, 0xbfb8aa3b
    s_mov_b32 s63, 0xbfb8aa3b
    s_mul_i32 s77, s44, 1639
    s_lshr_b32 s77, s77, 16
    s_mul_i32 s77, s77, 96
    s_lshl_b32 s19, s44, 2
    s_add_u32 s19, s19, s77
    s_lshl_b32 s77, s3, 11
    s_add_u32 s19, s19, s77
    s_lshl_b32 s19, s19, 3
    s_add_u32 s19, s19, 14745600
    v_and_b32 v96, 15, v1
    v_lshrrev_b32 v97, 1, v1
    v_and_b32 v97, 24, v97
    v_mov_b32 v98, 4064
    v_lshlrev_b32 v98, v96, v98
    v_lshrrev_b32 v98, v97, v98
    v_bfe_u32 v99, v98, 0, 2
    v_mul_u32_u24 v99, 0x8001, v99
    v_and_b32 v99, 0x10001, v99
    v_mul_u32_u24 v40, 0x3f80, v99
    v_bfe_u32 v99, v98, 2, 2
    v_mul_u32_u24 v99, 0x8001, v99
    v_and_b32 v99, 0x10001, v99
    v_mul_u32_u24 v41, 0x3f80, v99
    v_bfe_u32 v99, v98, 4, 2
    v_mul_u32_u24 v99, 0x8001, v99
    v_and_b32 v99, 0x10001, v99
    v_mul_u32_u24 v42, 0x3f80, v99
    v_bfe_u32 v99, v98, 6, 2
    v_mul_u32_u24 v99, 0x8001, v99
    v_and_b32 v99, 0x10001, v99
    v_mul_u32_u24 v43, 0x3f80, v99
    v_mov_b32 v98, 8176
    v_lshlrev_b32 v98, v96, v98
    v_lshrrev_b32 v98, v97, v98
    v_bfe_u32 v99, v98, 0, 2
    v_mul_u32_u24 v99, 0x8001, v99
    v_and_b32 v99, 0x10001, v99
    v_mul_u32_u24 v44, 0x3f80, v99
    v_bfe_u32 v99, v98, 2, 2
    v_mul_u32_u24 v99, 0x8001, v99
    v_and_b32 v99, 0x10001, v99
    v_mul_u32_u24 v45, 0x3f80, v99
    v_bfe_u32 v99, v98, 4, 2
    v_mul_u32_u24 v99, 0x8001, v99
    v_and_b32 v99, 0x10001, v99
    v_mul_u32_u24 v46, 0x3f80, v99
    v_bfe_u32 v99, v98, 6, 2
    v_mul_u32_u24 v99, 0x8001, v99
    v_and_b32 v99, 0x10001, v99
    v_mul_u32_u24 v47, 0x3f80, v99
    s_mul_i32 s77, s82, 1639
    s_lshr_b32 s77, s77, 16
    s_mul_i32 s77, s77, 96
    s_lshl_b32 s61, s82, 2
    s_add_u32 s61, s61, s77
    s_lshl_b32 s77, s3, 11
    s_add_u32 s61, s61, s77
    s_lshl_b32 s61, s61, 3
    s_add_u32 s61, s61, 14745600
    s_cmp_eq_u32 s42, 1
    s_cselect_b32 s61, s61, 134217728
    s_add_u32 s18, s61, 32
    s_mov_b32 s46, 134217728
    s_waitcnt vmcnt(1)
    s_barrier
    v_add_u32 v4, 65536, v86
    ds_read_b64_tr_b16 a[0:1], v4 offset:0
    ds_read_b64_tr_b16 a[2:3], v4 offset:10752
    ds_read_b64_tr_b16 a[4:5], v4 offset:8
    ds_read_b64_tr_b16 a[6:7], v4 offset:10760
    ds_read_b64_tr_b16 a[8:9], v4 offset:16
    ds_read_b64_tr_b16 a[10:11], v4 offset:10768
    ds_read_b64_tr_b16 a[12:13], v4 offset:24
    ds_read_b64_tr_b16 a[14:15], v4 offset:10776
    ds_read_b64_tr_b16 a[16:17], v4 offset:32
    ds_read_b64_tr_b16 a[18:19], v4 offset:10784
    v_add_u32 v4, 90112, v86
    ds_read_b64_tr_b16 a[20:21], v4 offset:0
    ds_read_b64_tr_b16 a[22:23], v4 offset:10752
    ds_read_b64_tr_b16 a[24:25], v4 offset:8
    ds_read_b64_tr_b16 a[26:27], v4 offset:10760
    ds_read_b64_tr_b16 a[28:29], v4 offset:16
    ds_read_b64_tr_b16 a[30:31], v4 offset:10768
    ds_read_b64_tr_b16 a[32:33], v4 offset:24
    ds_read_b64_tr_b16 a[34:35], v4 offset:10776
    ds_read_b64_tr_b16 a[36:37], v4 offset:32
    ds_read_b64_tr_b16 a[38:39], v4 offset:10784
    v_add_u32 v4, 114688, v86
    ds_read_b64_tr_b16 a[40:41], v4 offset:0
    ds_read_b64_tr_b16 a[42:43], v4 offset:10752
    ds_read_b64_tr_b16 a[44:45], v4 offset:8
    ds_read_b64_tr_b16 a[46:47], v4 offset:10760
    ds_read_b64_tr_b16 a[48:49], v4 offset:16
    ds_read_b64_tr_b16 a[50:51], v4 offset:10768
    ds_read_b64_tr_b16 a[52:53], v4 offset:24
    ds_read_b64_tr_b16 a[54:55], v4 offset:10776
    ds_read_b64_tr_b16 a[56:57], v4 offset:32
    ds_read_b64_tr_b16 a[58:59], v4 offset:10784
    s_add_u32 s75, s64, 0
    s_and_b32 s74, s75, 1
    s_lshl2_add_u32 s74, s74, s3
    s_lshr_b32 s73, s75, 1
    s_mul_i32 s66, s74, 276480
    s_mul_i32 s72, s73, 5120
    s_add_u32 s66, s66, s72
    s_add_u32 s66, s66, 2686976
    s_lshl_b32 s74, s74, 8
    s_lshl2_add_u32 s74, s73, s74
    s_lshl_b32 s74, s74, 2
    s_add_u32 s6, s74, 32768
    s_cmp_ge_u32 s75, 108
    s_cselect_b32 s66, 134217728, s66
    s_cselect_b32 s6, 134217728, s6
    buffer_store_dwordx4 a[0:3], v8, s[32:35], s66 offen offset:0 sc1
    buffer_store_dwordx4 a[4:7], v8, s[32:35], s66 offen offset:1024 sc1
    buffer_store_dwordx4 a[8:11], v8, s[32:35], s66 offen offset:2048 sc1
    buffer_store_dwordx4 a[12:15], v8, s[32:35], s66 offen offset:3072 sc1
    s_add_u32 s66, s66, 4096
    buffer_store_dwordx4 a[16:19], v8, s[32:35], s66 offen offset:0 sc1
    s_add_u32 s75, s64, 40
    s_and_b32 s74, s75, 1
    s_lshl2_add_u32 s74, s74, s3
    s_lshr_b32 s73, s75, 1
    s_mul_i32 s66, s74, 276480
    s_mul_i32 s72, s73, 5120
    s_add_u32 s66, s66, s72
    s_add_u32 s66, s66, 2686976
    s_lshl_b32 s74, s74, 8
    s_lshl2_add_u32 s74, s73, s74
    s_lshl_b32 s74, s74, 2
    s_add_u32 s7, s74, 32768
    s_cmp_ge_u32 s75, 108
    s_cselect_b32 s66, 134217728, s66
    s_cselect_b32 s7, 134217728, s7
    buffer_store_dwordx4 a[20:23], v8, s[32:35], s66 offen offset:0 sc1
    buffer_store_dwordx4 a[24:27], v8, s[32:35], s66 offen offset:1024 sc1
    s_waitcnt lgkmcnt(14)
    buffer_store_dwordx4 a[28:31], v8, s[32:35], s66 offen offset:2048 sc1
    s_waitcnt lgkmcnt(12)
    buffer_store_dwordx4 a[32:35], v8, s[32:35], s66 offen offset:3072 sc1
    s_add_u32 s66, s66, 4096
    s_waitcnt lgkmcnt(10)
    buffer_store_dwordx4 a[36:39], v8, s[32:35], s66 offen offset:0 sc1
    s_add_u32 s75, s64, 80
    s_and_b32 s74, s75, 1
    s_lshl2_add_u32 s74, s74, s3
    s_lshr_b32 s73, s75, 1
    s_mul_i32 s66, s74, 276480
    s_mul_i32 s72, s73, 5120
    s_add_u32 s66, s66, s72
    s_add_u32 s66, s66, 2686976
    s_lshl_b32 s74, s74, 8
    s_lshl2_add_u32 s74, s73, s74
    s_lshl_b32 s74, s74, 2
    s_add_u32 s8, s74, 32768
    s_cmp_ge_u32 s75, 108
    s_cselect_b32 s66, 134217728, s66
    s_cselect_b32 s8, 134217728, s8
    s_waitcnt lgkmcnt(8)
    buffer_store_dwordx4 a[40:43], v8, s[32:35], s66 offen offset:0 sc1
    s_waitcnt lgkmcnt(6)
    buffer_store_dwordx4 a[44:47], v8, s[32:35], s66 offen offset:1024 sc1
    s_waitcnt lgkmcnt(4)
    buffer_store_dwordx4 a[48:51], v8, s[32:35], s66 offen offset:2048 sc1
    s_waitcnt lgkmcnt(2)
    buffer_store_dwordx4 a[52:55], v8, s[32:35], s66 offen offset:3072 sc1
    s_add_u32 s66, s66, 4096
    s_waitcnt lgkmcnt(0)
    buffer_store_dwordx4 a[56:59], v8, s[32:35], s66 offen offset:0 sc1
    s_waitcnt vmcnt(15)
    v_cmp_ne_u32 vcc, v25, v24
    s_cbranch_vccnz c2l_slow
c2l_ok:
    s_lshr_b32 s69, s44, 2
    s_mul_i32 s69, s69, 496
    s_lshl_b32 s77, s44, 2
    s_add_u32 s69, s69, s77
    s_mul_i32 s77, s3, 655360
    s_add_u32 s69, s69, s77
    s_add_u32 s69, s69, 65536
    buffer_load_dwordx4 v[160:163], v29, s[32:35], s69 offen sc1
    s_add_u32 s69, s69, 81920
    buffer_load_dwordx4 v[164:167], v29, s[32:35], s69 offen sc1
    s_add_u32 s69, s69, 81920
    buffer_load_dwordx4 v[168:171], v29, s[32:35], s69 offen sc1
    s_add_u32 s69, s69, 81920
    buffer_load_dwordx4 v[172:175], v29, s[32:35], s69 offen sc1
    s_add_u32 s69, s69, 81920
    buffer_load_dwordx4 v[176:179], v29, s[32:35], s69 offen sc1
    s_add_u32 s69, s69, 81920
    buffer_load_dwordx4 v[180:183], v29, s[32:35], s69 offen sc1
    s_add_u32 s69, s69, 81920
    buffer_load_dwordx4 v[184:187], v29, s[32:35], s69 offen sc1
    s_add_u32 s69, s69, 81920
    buffer_load_dwordx4 v[188:191], v29, s[32:35], s69 offen sc1
    s_waitcnt vmcnt(8)
    s_mov_b64 exec, 1
    buffer_store_dword v25, off, s[32:35], s6 sc1
    s_mov_b64 exec, -1
    s_mov_b64 exec, 1
    buffer_store_dword v25, off, s[32:35], s7 sc1
    s_mov_b64 exec, -1
    s_mov_b64 exec, 1
    buffer_store_dword v25, off, s[32:35], s8 sc1
    s_mov_b64 exec, -1
    s_barrier
    s_lshl_b32 s73, s50, 2
    s_add_u32 s73, s73, s3
    s_mul_i32 s73, s73, 20480
    s_mul_i32 s74, s51, 160
    s_add_u32 s73, s73, s74
    s_lshl_b32 s74, s3, 12
    s_add_u32 s74, s74, 94208
    v_add_u32 v2, 0, v1
    v_min_u32 v2, 159, v2
    v_mul_u32_u24 v5, 6554, v2
    v_lshrrev_b32 v5, 16, v5
    v_add_lshl_u32 v2, v2, v5, 4
    v_mul_u32_u24 v30, 1104, v5
    v_add_u32 v5, s74, v2
    v_add3_u32 v2, v2, v30, s73
    v_add_u32 v3, 64, v1
    v_min_u32 v3, 159, v3
    v_mul_u32_u24 v6, 6554, v3
    v_lshrrev_b32 v6, 16, v6
    v_add_lshl_u32 v3, v3, v6, 4
    v_mul_u32_u24 v30, 1104, v6
    v_add_u32 v6, s74, v3
    v_add3_u32 v3, v3, v30, s73
    v_add_u32 v4, 128, v1
    v_min_u32 v4, 159, v4
    v_mul_u32_u24 v7, 6554, v4
    v_lshrrev_b32 v7, 16, v7
    v_add_lshl_u32 v4, v4, v7, 4
    v_mul_u32_u24 v30, 1104, v7
    v_add_u32 v7, s74, v4
    v_add3_u32 v4, v4, v30, s73
    ds_write_b128 v5, v[100:103]
    ds_write_b128 v6, v[104:107]
    ds_write_b128 v7, v[108:111]
    ds_read_b64 v[30:31], v26 offset:0
    ds_read_b64 v[32:33], v26 offset:8
    ds_read_b64 v[34:35], v26 offset:16
    ds_read_b64 v[36:37], v26 offset:24
    ds_read_b64 v[38:39], v26 offset:32
    s_lshr_b32 s72, s3, 1
    s_mul_i32 s72, s72, 13312
    s_add_u32 s72, s72, 65536
    s_and_b32 s73, s3, 1
    s_mul_i32 s73, s73, 4160
    s_add_u32 s73, s73, s72
    s_bitcmp1_b32 s3, 1
    s_cselect_b32 s74, 0, 16
    s_lshl_b32 s74, s49, s74
    s_and_b32 s74, s74, 0xffff0000
    s_mov_b64 exec, 1
    v_add_f32 v112, s74, v112
    s_mov_b64 exec, -1
    v_sub_u32 v52, 1008, v8
    v_add_u32 v52, s73, v52
    v_min_u32 v53, 624, v8
    s_add_u32 s74, s72, 8160
    v_add_u32 v53, s74, v53
    v_mov_b32 v104, 0
    v_mov_b32 v105, 0
    v_mov_b32 v106, 0
    v_cvt_pk_bf16_f32 v108, v124, v125
    v_lshl_add_u32 v109, v1, 1, s72
    ds_write_b16 v109, v108 offset:128
    ds_write_b16_d16_hi v109, v108 offset:256
    s_add_u32 s74, s72, 0xffffffe0
    s_mov_b64 exec, 0x3ff
    v_add_u32 v53, s74, v8
    s_mov_b64 exec, -1
    s_add_u32 s74, s73, 0x1000
    s_mov_b64 exec, 3
    v_add_u32 v53, s74, v8
    s_mov_b64 exec, -1
    s_add_u32 s74, s73, 0x400
    s_bfm_b64 exec, 4, 60
    v_add_u32 v53, s74, v8
    s_mov_b64 exec, -1
    s_bitcmp1_b32 s3, 0
    s_cselect_b64 s[74:75], -1, 0
    s_and_b64 exec, s[74:75], 1
    v_cvt_pk_bf16_f32 v104, v112, v105
    s_mov_b64 exec, -1
    s_bfm_b64 exec, 1, 63
    v_cvt_pk_bf16_f32 v106, v123, v123
    s_mov_b64 exec, -1
    v_mov_b32 v107, v106
    v_and_b32 v110, 0xffff0000, v106
    v_cndmask_b32 v105, v110, v105, s[74:75]
    ds_write_b128 v53, v[104:107]
    v_cvt_pk_bf16_f32 v96, v123, v123
    v_cndmask_b32 v110, v122, v123, s[74:75]
    v_cvt_pk_bf16_f32 v97, v110, v122
    v_cndmask_b32 v111, v121, v122, s[74:75]
    v_cvt_pk_bf16_f32 v98, v122, v111
    v_cvt_pk_bf16_f32 v99, v121, v121
    ds_write_b128 v52, v[96:99] offset:2048
    v_cndmask_b32 v110, v119, v120, s[74:75]
    v_cndmask_b32 v111, v118, v119, s[74:75]
    v_cvt_pk_bf16_f32 v100, v110, v111
    v_cndmask_b32 v110, v117, v118, s[74:75]
    v_cndmask_b32 v111, v116, v117, s[74:75]
    v_cvt_pk_bf16_f32 v101, v110, v111
    v_cndmask_b32 v110, v115, v116, s[74:75]
    v_cndmask_b32 v111, v114, v115, s[74:75]
    v_cvt_pk_bf16_f32 v102, v110, v111
    v_cndmask_b32 v110, v113, v114, s[74:75]
    v_cndmask_b32 v111, v112, v113, s[74:75]
    v_cvt_pk_bf16_f32 v103, v110, v111
    ds_write_b128 v52, v[100:103] offset:3072
    s_lshl_b32 s72, s3, 10
    s_add_u32 s72, s72, 65536
    v_lshl_add_u32 v52, v1, 1, s72
    s_waitcnt vmcnt(10)
    ds_write_b16 v52, v160 offset:8800
    ds_write_b16_d16_hi v52, v160 offset:22112
    s_waitcnt vmcnt(9)
    ds_write_b16 v52, v164 offset:8928
    ds_write_b16_d16_hi v52, v164 offset:22240
    s_waitcnt vmcnt(8)
    ds_write_b16 v52, v168 offset:9056
    ds_write_b16_d16_hi v52, v168 offset:22368
    s_waitcnt vmcnt(7)
    ds_write_b16 v52, v172 offset:9184
    ds_write_b16_d16_hi v52, v172 offset:22496
    s_waitcnt vmcnt(6)
    ds_write_b16 v52, v176 offset:9312
    ds_write_b16_d16_hi v52, v176 offset:22624
    s_waitcnt vmcnt(5)
    ds_write_b16 v52, v180 offset:9440
    ds_write_b16_d16_hi v52, v180 offset:22752
    s_waitcnt vmcnt(4)
    ds_write_b16 v52, v184 offset:9568
    ds_write_b16_d16_hi v52, v184 offset:22880
    s_waitcnt vmcnt(3)
    ds_write_b16 v52, v188 offset:9696
    ds_write_b16_d16_hi v52, v188 offset:23008
    s_lshl_b32 s69, s44, 13
    s_lshl_b32 s72, s3, 11
    s_add_u32 s69, s69, s72
    s_add_u32 s69, s69, 4898816
    s_add_u32 s11, s69, 1024
    s_mul_i32 s10, s51, 327680
    s_lshl2_add_u32 s72, s50, s3
    s_mul_i32 s72, s72, 64
    s_add_u32 s10, s10, s72
    s_add_u32 s10, s10, 4898816
    s_lshl3_add_u32 s12, s50, s3
    s_lshl_b32 s12, s12, 9
    s_add_u32 s12, s12, 14614528
    s_add_u32 s13, s12, 2048
    s_and_b32 s14, s50, 24
    s_add_u32 s14, s14, s51
    s_lshl_b32 s14, s14, 11
    s_add_u32 s14, s14, 14745600
    s_cmp_eq_u32 s3, 3
    s_cselect_b32 s70, 5, 6
    s_cmp_eq_u32 s3, 0
    s_cselect_b32 s71, 5, 6
    s_waitcnt lgkmcnt(0)
    s_lshl_b32 s68, s51, 10
    s_add_u32 s68, s68, 32768
    v_min_u32 v28, 53, v1
    v_lshlrev_b32 v28, 4, v28
    buffer_load_dword v24, v28, s[32:35], s68 offen sc1
    s_waitcnt vmcnt(0)
    v_cmp_ne_u32 vcc, v25, v24
    s_cbranch_vccnz c3l_slow
c3l_ok:
    s_mov_b32 s60, 134217728
    s_add_u32 s66, s54, 81920
    buffer_load_dwordx4 a[192:195], v8, s[32:35], s66 offen offset:0 sc1
    buffer_load_dwordx4 a[196:199], v8, s[32:35], s66 offen offset:1024 sc1
    buffer_load_dwordx4 a[200:203], v8, s[32:35], s66 offen offset:2048 sc1
    buffer_load_dwordx4 a[204:207], v8, s[32:35], s66 offen offset:3072 sc1
    s_add_u32 s66, s66, 4096
    buffer_load_dwordx4 a[208:211], v8, s[32:35], s66 offen offset:0 sc1
    s_add_u32 s66, s54, 122880
    buffer_load_dwordx4 a[212:215], v8, s[32:35], s66 offen offset:0 sc1
    buffer_load_dwordx4 a[216:219], v8, s[32:35], s66 offen offset:1024 sc1
    buffer_load_dwordx4 a[220:223], v8, s[32:35], s66 offen offset:2048 sc1
    buffer_load_dwordx4 a[224:227], v8, s[32:35], s66 offen offset:3072 sc1
    s_add_u32 s66, s66, 4096
    buffer_load_dwordx4 a[228:231], v8, s[32:35], s66 offen offset:0 sc1
    s_add_u32 s66, s54, 163840
    buffer_load_dwordx4 a[232:235], v8, s[32:35], s66 offen offset:0 sc1
    buffer_load_dwordx4 a[236:239], v8, s[32:35], s66 offen offset:1024 sc1
    buffer_load_dwordx4 a[240:243], v8, s[32:35], s66 offen offset:2048 sc1
    buffer_load_dwordx4 a[244:247], v8, s[32:35], s66 offen offset:3072 sc1
    s_add_u32 s66, s66, 4096
    buffer_load_dwordx4 a[248:251], v8, s[32:35], s66 offen offset:0 sc1
    s_add_u32 s66, s54, 204800
    buffer_load_dwordx4 v[88:91], v8, s[32:35], s66 offen offset:0 sc1
    buffer_load_dwordx4 v[92:95], v8, s[32:35], s66 offen offset:1024 sc1
    buffer_load_dwordx4 v[96:99], v8, s[32:35], s66 offen offset:2048 sc1
    buffer_load_dwordx4 v[100:103], v8, s[32:35], s66 offen offset:3072 sc1
    s_add_u32 s66, s66, 4096
    buffer_load_dwordx4 v[104:107], v8, s[32:35], s66 offen offset:0 sc1
    s_add_u32 s66, s54, 245760
    s_or_b32 s66, s66, s56
    buffer_load_dwordx4 v[108:111], v8, s[32:35], s66 offen offset:0 sc1
    buffer_load_dwordx4 v[112:115], v8, s[32:35], s66 offen offset:1024 sc1
    buffer_load_dwordx4 v[116:119], v8, s[32:35], s66 offen offset:2048 sc1
    buffer_load_dwordx4 v[120:123], v8, s[32:35], s66 offen offset:3072 sc1
    s_add_u32 s66, s66, 4096
    buffer_load_dwordx4 v[124:127], v8, s[32:35], s66 offen offset:0 sc1
    s_add_u32 s66, s54, 0
    buffer_load_dwordx4 v[48:51], v8, s[32:35], s66 offen offset:0 sc1
    buffer_load_dwordx4 v[52:55], v8, s[32:35], s66 offen offset:1024 sc1
    buffer_load_dwordx4 v[56:59], v8, s[32:35], s66 offen offset:2048 sc1
    buffer_load_dwordx4 v[60:63], v8, s[32:35], s66 offen offset:3072 sc1
    s_add_u32 s66, s66, 4096
    buffer_load_dwordx4 v[64:67], v8, s[32:35], s66 offen offset:0 sc1
    s_add_u32 s66, s54, 40960
    buffer_load_dwordx4 v[68:71], v8, s[32:35], s66 offen offset:0 sc1
    buffer_load_dwordx4 v[72:75], v8, s[32:35], s66 offen offset:1024 sc1
    buffer_load_dwordx4 v[76:79], v8, s[32:35], s66 offen offset:2048 sc1
    buffer_load_dwordx4 v[80:83], v8, s[32:35], s66 offen offset:3072 sc1
    s_add_u32 s66, s66, 4096
    buffer_load_dwordx4 v[84:87], v8, s[32:35], s66 offen offset:0 sc1
    s_add_u32 s66, s55, 0
    buffer_load_dwordx4 a[0:3], v8, s[32:35], s66 offen offset:0 sc1
    buffer_load_dwordx4 a[4:7], v8, s[32:35], s66 offen offset:1024 sc1
    buffer_load_dwordx4 a[8:11], v8, s[32:35], s66 offen offset:2048 sc1
    buffer_load_dwordx4 a[12:15], v8, s[32:35], s66 offen offset:3072 sc1
    s_add_u32 s66, s66, 4096
    buffer_load_dwordx4 a[16:19], v8, s[32:35], s66 offen offset:0 sc1
    s_add_u32 s66, s55, 40960
    buffer_load_dwordx4 a[20:23], v8, s[32:35], s66 offen offset:0 sc1
    buffer_load_dwordx4 a[24:27], v8, s[32:35], s66 offen offset:1024 sc1
    buffer_load_dwordx4 a[28:31], v8, s[32:35], s66 offen offset:2048 sc1
    buffer_load_dwordx4 a[32:35], v8, s[32:35], s66 offen offset:3072 sc1
    s_add_u32 s66, s66, 4096
    buffer_load_dwordx4 a[36:39], v8, s[32:35], s66 offen offset:0 sc1
    s_add_u32 s66, s55, 81920
    buffer_load_dwordx4 a[40:43], v8, s[32:35], s66 offen offset:0 sc1
    buffer_load_dwordx4 a[44:47], v8, s[32:35], s66 offen offset:1024 sc1
    buffer_load_dwordx4 a[48:51], v8, s[32:35], s66 offen offset:2048 sc1
    buffer_load_dwordx4 a[52:55], v8, s[32:35], s66 offen offset:3072 sc1
    s_add_u32 s66, s66, 4096
    buffer_load_dwordx4 a[56:59], v8, s[32:35], s66 offen offset:0 sc1
    s_add_u32 s66, s55, 122880
    buffer_load_dwordx4 v[128:131], v8, s[32:35], s66 offen offset:0 sc1
    buffer_load_dwordx4 v[132:135], v8, s[32:35], s66 offen offset:1024 sc1
    buffer_load_dwordx4 v[136:139], v8, s[32:35], s66 offen offset:2048 sc1
    buffer_load_dwordx4 v[140:143], v8, s[32:35], s66 offen offset:3072 sc1
    s_barrier
    s_and_b32 s76, s3, 1
    s_mul_i32 s76, s76, 768
    v_add_u32 v9, s76, v20
    ds_read_b128 a[80:83], v20 offset:192
    ds_read2_b32 a[64:65], v16 offset0:176 offset1:177
    ds_read2_b32 a[66:67], v16 offset0:178 offset1:179
    ds_read_b128 a[164:167], v9 offset:192
    ds_read_b128 a[168:171], v9 offset:176
    ds_read_b128 a[84:87], v20 offset:704
    ds_read2_b32 a[68:69], v16 offset0:48 offset1:49
    ds_read2_b32 a[70:71], v16 offset0:50 offset1:51
    ds_read_b128 a[88:91], v20 offset:1216
    ds_read2_b32 a[72:73], v17 offset0:176 offset1:177
    ds_read2_b32 a[74:75], v17 offset0:178 offset1:179
    ds_read_b128 a[92:95], v20 offset:1728
    ds_read2_b32 a[76:77], v17 offset0:48 offset1:49
    ds_read2_b32 a[78:79], v17 offset0:50 offset1:51
    s_waitcnt lgkmcnt(0)
    s_branch join
c1_slow:
    s_mov_b32 s17, 0
c1_spin:
    s_lshl_b64 vcc, vcc, 56
    s_bcnt1_i32_b64 vcc_lo, vcc
    s_cmp_lt_u32 vcc_lo, 5
    s_cbranch_scc1 c1_near
    s_sleep 1
c1_near:
    buffer_load_dword v24, v28, s[32:35], s65 offen sc1
    s_waitcnt vmcnt(0)
    v_cmp_ne_u32 vcc, v25, v24
    s_cbranch_vccz c1_ok
    s_add_u32 s17, s17, 1
    s_cmp_lt_u32 s17, 400000
    s_cbranch_scc1 c1_spin
    s_branch c1_ok
c2_slow:
    s_mov_b32 s17, 0
c2_spin:
    s_lshl_b64 vcc, vcc, 0
    s_bcnt1_i32_b64 vcc_lo, vcc
    s_cmp_lt_u32 vcc_lo, 44
    s_cbranch_scc1 c2_near
    s_sleep 7
c2_near:
    buffer_load_dword v24, v28, s[32:35], s68 offen sc1
    s_waitcnt vmcnt(0)
    v_cmp_ne_u32 vcc, v25, v24
    s_cbranch_vccz c2_ok
    s_add_u32 s17, s17, 1
    s_cmp_lt_u32 s17, 400000
    s_cbranch_scc1 c2_spin
    s_branch c2_ok
c3_slow:
    s_mov_b32 s17, 0
c3_spin:
    s_lshl_b64 vcc, vcc, 10
    s_bcnt1_i32_b64 vcc_lo, vcc
    s_cmp_lt_u32 vcc_lo, 37
    s_cbranch_scc1 c3_near
    s_sleep 7
c3_near:
    buffer_load_dword v24, v28, s[32:35], s68 offen sc1
    s_waitcnt vmcnt(0)
    v_cmp_ne_u32 vcc, v25, v24
    s_cbranch_vccz c3_ok
    s_add_u32 s17, s17, 1
    s_cmp_lt_u32 s17, 400000
    s_cbranch_scc1 c3_spin
    s_branch c3_ok
c4_slow:
    s_mov_b32 s17, 0
c4_spin:
    s_lshl_b64 vcc, vcc, 57
    s_bcnt1_i32_b64 vcc_lo, vcc
    s_cmp_lt_u32 vcc_lo, 4
    s_cbranch_scc1 c4_near
    s_sleep 7
c4_near:
    buffer_load_dword v24, v28, s[32:35], s12 offen sc1
    s_waitcnt vmcnt(0)
    v_cmp_ne_u32 vcc, v25, v24
    s_cbranch_vccz c4_ok
    s_add_u32 s17, s17, 1
    s_cmp_lt_u32 s17, 400000
    s_cbranch_scc1 c4_spin
    s_branch c4_ok
c5_slow:
    s_mov_b32 s17, 0
c5_spin:
    s_lshl_b64 vcc, vcc, 57
    s_bcnt1_i32_b64 vcc_lo, vcc
    s_cmp_lt_u32 vcc_lo, 4
    s_cbranch_scc1 c5_near
    s_sleep 7
c5_near:
    buffer_load_dword v24, v28, s[32:35], s13 offen sc1
    s_waitcnt vmcnt(0)
    v_cmp_ne_u32 vcc, v25, v24
    s_cbranch_vccz c5_ok
    s_add_u32 s17, s17, 1
    s_cmp_lt_u32 s17, 400000
    s_cbranch_scc1 c5_spin
    s_branch c5_ok
c6_slow:
    s_mov_b32 s17, 0
c6_spin:
    s_lshl_b64 vcc, vcc, 24
    s_bcnt1_i32_b64 vcc_lo, vcc
    s_cmp_lt_u32 vcc_lo, 28
    s_cbranch_scc1 c6_near
    s_sleep 7
c6_near:
    buffer_load_dword v24, v28, s[32:35], s14 offen sc1
    s_waitcnt vmcnt(0)
    v_cmp_ne_u32 vcc, v25, v24
    s_cbranch_vccz c6_ok
    s_add_u32 s17, s17, 1
    s_cmp_lt_u32 s17, 400000
    s_cbranch_scc1 c6_spin
    s_branch c6_ok
c2h_slow:
    s_mov_b32 s17, 0
c2h_spin:
    s_lshl_b64 vcc, vcc, 0
    s_bcnt1_i32_b64 vcc_lo, vcc
    s_cmp_lt_u32 vcc_lo, 44
    s_cbranch_scc1 c2h_near
    s_sleep 7
c2h_near:
    buffer_load_dword v24, v28, s[32:35], s65 offen sc1
    s_waitcnt vmcnt(0)
    v_cmp_ne_u32 vcc, v25, v24
    s_cbranch_vccz c2h_ok
    s_add_u32 s17, s17, 1
    s_cmp_lt_u32 s17, 400000
    s_cbranch_scc1 c2h_spin
    s_branch c2h_ok
c3h_slow:
    s_mov_b32 s17, 0
c3h_spin:
    s_lshl_b64 vcc, vcc, 10
    s_bcnt1_i32_b64 vcc_lo, vcc
    s_cmp_lt_u32 vcc_lo, 37
    s_cbranch_scc1 c3h_near
    s_sleep 7
c3h_near:
    buffer_load_dword v24, v28, s[32:35], s65 offen sc1
    s_waitcnt vmcnt(0)
    v_cmp_ne_u32 vcc, v25, v24
    s_cbranch_vccz c3h_ok
    s_add_u32 s17, s17, 1
    s_cmp_lt_u32 s17, 400000
    s_cbranch_scc1 c3h_spin
    s_branch c3h_ok
c2l_slow:
    s_mov_b32 s17, 0
c2l_spin:
    s_lshl_b64 vcc, vcc, 0
    s_bcnt1_i32_b64 vcc_lo, vcc
    s_cmp_lt_u32 vcc_lo, 44
    s_cbranch_scc1 c2l_near
    s_sleep 7
c2l_near:
    buffer_load_dword v24, v28, s[32:35], s68 offen sc1
    s_waitcnt vmcnt(0)
    v_cmp_ne_u32 vcc, v25, v24
    s_cbranch_vccz c2l_ok
    s_add_u32 s17, s17, 1
    s_cmp_lt_u32 s17, 400000
    s_cbranch_scc1 c2l_spin
    s_branch c2l_ok
c3l_slow:
    s_mov_b32 s17, 0
c3l_spin:
    s_lshl_b64 vcc, vcc, 10
    s_bcnt1_i32_b64 vcc_lo, vcc
    s_cmp_lt_u32 vcc_lo, 37
    s_cbranch_scc1 c3l_near
    s_sleep 7
c3l_near:
    buffer_load_dword v24, v28, s[32:35], s68 offen sc1
    s_waitcnt vmcnt(0)
    v_cmp_ne_u32 vcc, v25, v24
    s_cbranch_vccz c3l_ok
    s_add_u32 s17, s17, 1
    s_cmp_lt_u32 s17, 400000
    s_cbranch_scc1 c3l_spin
    s_branch c3l_ok
k_end:
    s_endpgm
.section .rodata,"a"
.p2align 6
.amdhsa_kernel recurrent_scan__ssm_conv_s4d__glu_gated_glu__prompt_kernel
  .amdhsa_next_free_vgpr 512
  .amdhsa_next_free_sgpr 102
  .amdhsa_accum_offset 256
  .amdhsa_group_segment_fixed_size 0
  .amdhsa_kernarg_size 112
  .amdhsa_user_sgpr_count 2
  .amdhsa_user_sgpr_kernarg_segment_ptr 1
  .amdhsa_system_sgpr_workgroup_id_x 1
.end_amdhsa_kernel
```
